```python
import torch

def _softmax(x, axis=-1):
    return torch.softmax(x, dim=axis)
def _gelu(x):
    return torch.nn.functional.gelu(x, approximate="tanh")
def _silu(x):
    return torch.nn.functional.silu(x)
def _sigmoid(x):
    return torch.sigmoid(x)
def _layernorm(x, axis=-1, eps=1e-5):
    m = x.mean(dim=axis, keepdim=True)
    v = x.var(dim=axis, keepdim=True, unbiased=False)
    return (x - m) / torch.sqrt(v + eps)
def _scatter_add(tgt, idx, src, axis=0):
    return tgt.clone().index_add_(axis, idx, src)
def _segment_sum(src, seg, n):
    out = torch.zeros((n,) + src.shape[1:], dtype=src.dtype)
    return out.index_add_(0, seg, src)
def _pad(x, pw):
    flat = tuple(v for pair in reversed(pw) for v in pair)
    return torch.nn.functional.pad(x, flat)

kernel_name = 'concat_heads__mha_block_cached__mha_block_cached__near_ridge'

def setup_inputs():

    _w = (lambda a: (lambda t: t.to(torch.bfloat16) if t.is_floating_point() else t)(torch.as_tensor(a)))
    def _A_setup():
        B, Sq, D = 8, 160, 448
        H, Sk, Dh = 16, 512, 256
        return {
            "x": _w((lambda *s: torch.randn(*s, dtype=torch.bfloat16) * 0.8)(B, Sq, D)),
            "k_cache": _w((lambda *s: torch.randn(*s, dtype=torch.bfloat16) * 0.8)(B, H, Sk, Dh)),
            "v_cache": _w((lambda *s: torch.randn(*s, dtype=torch.bfloat16) * 0.05)(B, H, Sk, Dh)),
            "wq": _w((lambda *s: torch.randn(*s, dtype=torch.bfloat16) * 0.8)(D, H * Dh) * (D ** -0.5)),
            "wo": _w((lambda *s: torch.randn(*s, dtype=torch.bfloat16) * 0.05)(H * Dh, D) * ((H * Dh) ** -0.5)),
        }
    _A_in = _A_setup()

    def _B_setup():
        B, Sq, D = 8, 160, 448
        H, Sk, Dh = 16, 512, 256
        return {
            "x": _w((lambda *s: torch.randn(*s, dtype=torch.bfloat16) * 0.8)(B, Sq, D)),
            "k_cache": _w((lambda *s: torch.randn(*s, dtype=torch.bfloat16) * 0.8)(B, H, Sk, Dh)),
            "v_cache": _w((lambda *s: torch.randn(*s, dtype=torch.bfloat16) * 0.05)(B, H, Sk, Dh)),
            "wq": _w((lambda *s: torch.randn(*s, dtype=torch.bfloat16) * 0.8)(D, H * Dh) * (D ** -0.5)),
            "wo": _w((lambda *s: torch.randn(*s, dtype=torch.bfloat16) * 0.05)(H * Dh, D) * ((H * Dh) ** -0.5)),
        }
    _B_in = _B_setup()

    return {
        "A_x": _A_in["x"],
        "A_k_cache": _A_in["k_cache"],
        "A_v_cache": _A_in["v_cache"],
        "A_wq": _A_in["wq"],
        "A_wo": _A_in["wo"],
        "B_x": _B_in["x"],
        "B_k_cache": _B_in["k_cache"],
        "B_v_cache": _B_in["v_cache"],
        "B_wq": _B_in["wq"],
        "B_wo": _B_in["wo"],
    }

def reference(A_x, A_k_cache, A_v_cache, A_wq, A_wo, B_x, B_k_cache, B_v_cache, B_wq, B_wo):
    def _A_ref(x, k_cache, v_cache, wq, wo):
        B, Sq, D = x.shape
        H, Dh = 16, 256
        q = (lambda x, *d: x.permute(*d))((x @ wq).reshape(B, Sq, H, Dh), 0, 2, 1, 3)
        scores = torch.einsum("bhqd,bhkd->bhqk", q, k_cache) * (Dh ** -0.5)
        p = _softmax(scores, axis=-1)
        o = torch.einsum("bhqk,bhkd->bhqd", p, v_cache)
        return (lambda x, *d: x.permute(*d))(o, 0, 2, 1, 3).reshape(B, Sq, H * Dh) @ wo

    def _B_ref(x, k_cache, v_cache, wq, wo):
        B, Sq, D = x.shape
        H, Dh = 16, 256
        q = (lambda x, *d: x.permute(*d))((x @ wq).reshape(B, Sq, H, Dh), 0, 2, 1, 3)
        scores = torch.einsum("bhqd,bhkd->bhqk", q, k_cache) * (Dh ** -0.5)
        p = _softmax(scores, axis=-1)
        o = torch.einsum("bhqk,bhkd->bhqd", p, v_cache)
        return (lambda x, *d: x.permute(*d))(o, 0, 2, 1, 3).reshape(B, Sq, H * Dh) @ wo

    a = _A_ref(A_x, A_k_cache, A_v_cache, A_wq, A_wo)
    b = _B_ref(B_x, B_k_cache, B_v_cache, B_wq, B_wo)
    return torch.concatenate([a, b], axis=-1)
```

```asm
; @launch grid=(256,1,1) block=(256,1,1) lds=163840
.amdgcn_target "amdgcn-amd-amdhsa--gfx950"
.text
.globl concat_heads__mha_block_cached__mha_block_cached__near_ridge_kernel
.p2align 8
.type concat_heads__mha_block_cached__mha_block_cached__near_ridge_kernel,@function
concat_heads__mha_block_cached__mha_block_cached__near_ridge_kernel:
    s_cmp_ge_u32 s2, 256
    s_cbranch_scc1 L_k1_end
    s_getpc_b64 s[36:37]
L_pc:
    v_lshrrev_b32 v2, 6, v0
    s_lshr_b32 s38, s2, 3
    s_lshl_b32 s38, s38, 2
    v_add_u32 v2, s38, v2
    v_and_b32 v3, 3, v0
    v_mad_u32_u24 v2, v2, 4, v3
    v_lshlrev_b32 v2, 7, v2
    s_mov_b32 s38, L_k1_end-L_pc-4
    v_min_u32 v2, s38, v2
    v_and_b32 v2, -4, v2
    global_load_dword v17, v2, s[36:37]
    s_load_dwordx16 s[36:51], s[0:1], 0
    s_load_dwordx4 s[52:55], s[0:1], 64
    s_load_dwordx2 s[56:57], s[0:1], 96
    s_memrealtime s[78:79]
    s_load_dwordx2 s[90:91], s[0:1], 80
    s_and_b32 s58, s2, 7
    s_lshr_b32 s59, s2, 3
    s_and_b32 s60, s58, 3
    s_lshl_b32 s60, s60, 2
    s_and_b32 s61, s59, 3
    s_add_u32 s60, s60, s61
    s_lshr_b32 s61, s59, 2
    s_lshr_b32 s62, s58, 2
    s_and_b32 s58, s60, 3
    s_lshl_b32 s58, s58, 1
    s_add_u32 s58, s58, s61
    s_cmp_ge_u32 s58, 7
    s_cselect_b32 s59, 7, 0
    s_sub_u32 s58, s58, s59
    s_cmp_ge_u32 s58, 7
    s_cselect_b32 s59, 7, 0
    s_sub_u32 s58, s58, s59
    s_add_u32 s59, s58, 0
    s_cmp_ge_u32 s59, 7
    s_cselect_b32 s63, 7, 0
    s_sub_u32 s59, s59, s63
    s_lshl_b32 s64, s59, 7
    s_lshl_b32 s71, s59, 19
    s_add_u32 s59, s58, 1
    s_cmp_ge_u32 s59, 7
    s_cselect_b32 s63, 7, 0
    s_sub_u32 s59, s59, s63
    s_lshl_b32 s65, s59, 7
    s_lshl_b32 s72, s59, 19
    s_add_u32 s59, s58, 2
    s_cmp_ge_u32 s59, 7
    s_cselect_b32 s63, 7, 0
    s_sub_u32 s59, s59, s63
    s_lshl_b32 s66, s59, 7
    s_lshl_b32 s73, s59, 19
    s_add_u32 s59, s58, 3
    s_cmp_ge_u32 s59, 7
    s_cselect_b32 s63, 7, 0
    s_sub_u32 s59, s59, s63
    s_lshl_b32 s67, s59, 7
    s_lshl_b32 s74, s59, 19
    s_add_u32 s59, s58, 4
    s_cmp_ge_u32 s59, 7
    s_cselect_b32 s63, 7, 0
    s_sub_u32 s59, s59, s63
    s_lshl_b32 s68, s59, 7
    s_lshl_b32 s75, s59, 19
    s_add_u32 s59, s58, 5
    s_cmp_ge_u32 s59, 7
    s_cselect_b32 s63, 7, 0
    s_sub_u32 s59, s59, s63
    s_lshl_b32 s69, s59, 7
    s_lshl_b32 s76, s59, 19
    s_add_u32 s59, s58, 6
    s_cmp_ge_u32 s59, 7
    s_cselect_b32 s63, 7, 0
    s_sub_u32 s59, s59, s63
    s_lshl_b32 s70, s59, 7
    s_lshl_b32 s77, s59, 19
    v_lshrrev_b32 v32, 6, v0
    s_nop 0
    v_readfirstlane_b32 s28, v32
    s_mov_b32 s35, 0
    s_nop 1
    s_lshl_b32 s29, s28, 14
    s_add_u32 s29, s29, 98304
    s_mul_i32 s30, s28, 12288
    s_mul_i32 s31, s28, 5120
    s_add_u32 s31, s31, 49152
    s_mov_b32 s34, 0x3db8aa3b
    v_and_b32 v1, 63, v0
    v_and_b32 v32, 15, v1
    v_lshrrev_b32 v33, 4, v1
    v_bfe_u32 v34, v1, 2, 2
    v_and_b32 v35, 3, v1
    v_lshrrev_b32 v36, 3, v1
    v_and_b32 v37, 7, v1
    v_mov_b32 v40, s28
    s_mov_b32 s63, 896
    v_mad_u32_u24 v38, v40, 5, 0
    v_and_b32 v39, 1, v38
    v_lshl_add_u32 v39, v39, 2, v33
    v_xor_b32 v39, v39, v37
    v_lshlrev_b32 v39, 4, v39
    v_lshl_add_u32 v38, v38, 3, v36
    v_mad_u32_u24 v158, v38, s63, v39
    v_mad_u32_u24 v38, v40, 5, 1
    v_and_b32 v39, 1, v38
    v_lshl_add_u32 v39, v39, 2, v33
    v_xor_b32 v39, v39, v37
    v_lshlrev_b32 v39, 4, v39
    v_lshl_add_u32 v38, v38, 3, v36
    v_mad_u32_u24 v159, v38, s63, v39
    v_subrev_u32 v159, 1024, v159
    v_mad_u32_u24 v38, v40, 5, 2
    v_and_b32 v39, 1, v38
    v_lshl_add_u32 v39, v39, 2, v33
    v_xor_b32 v39, v39, v37
    v_lshlrev_b32 v39, 4, v39
    v_lshl_add_u32 v38, v38, 3, v36
    v_mad_u32_u24 v160, v38, s63, v39
    v_subrev_u32 v160, 2048, v160
    v_mad_u32_u24 v38, v40, 5, 3
    v_and_b32 v39, 1, v38
    v_lshl_add_u32 v39, v39, 2, v33
    v_xor_b32 v39, v39, v37
    v_lshlrev_b32 v39, 4, v39
    v_lshl_add_u32 v38, v38, 3, v36
    v_mad_u32_u24 v161, v38, s63, v39
    v_subrev_u32 v161, 3072, v161
    v_mad_u32_u24 v38, v40, 5, 4
    v_and_b32 v39, 1, v38
    v_lshl_add_u32 v39, v39, 2, v33
    v_xor_b32 v39, v39, v37
    v_lshlrev_b32 v39, 4, v39
    v_lshl_add_u32 v38, v38, 3, v36
    v_mad_u32_u24 v162, v38, s63, v39
    v_bfe_u32 v39, v36, 1, 1
    v_lshlrev_b32 v39, 1, v39
    v_xor_b32 v39, v39, v37
    v_lshlrev_b32 v39, 4, v39
    v_lshl_add_u32 v39, v40, 7, v39
    v_lshlrev_b32 v38, 13, v36
    v_add_u32 v163, v38, v39
    v_bfe_u32 v39, v36, 1, 1
    v_or_b32 v39, 2, v39
    v_lshlrev_b32 v39, 1, v39
    v_xor_b32 v39, v39, v37
    v_lshlrev_b32 v39, 4, v39
    v_lshl_add_u32 v39, v40, 7, v39
    v_lshlrev_b32 v38, 13, v36
    v_add_u32 v164, v38, v39
    v_add_u32 v165, 129024, v163
    v_add_u32 v166, 193536, v164
    v_add_u32 v164, 64512, v164
    s_waitcnt lgkmcnt(0)
    s_cmp_eq_u32 s62, 0
    s_cselect_b32 s36, s36, s46
    s_cselect_b32 s37, s37, s47
    s_cselect_b32 s42, s42, s52
    s_cselect_b32 s43, s43, s53
    s_cselect_b32 s38, s38, s48
    s_cselect_b32 s39, s39, s49
    s_cselect_b32 s40, s40, s50
    s_cselect_b32 s41, s41, s51
    s_cselect_b32 s44, s44, s54
    s_cselect_b32 s45, s45, s55
    s_mul_i32 s58, s61, 143360
    s_add_u32 s4, s36, s58
    s_addc_u32 s5, s37, 0
    s_mov_b32 s6, 143360
    s_mov_b32 s7, 0x00020000
    s_lshl_b32 s59, s60, 9
    s_sub_u32 s58, 3670016, s59
    s_add_u32 s16, s42, s59
    s_addc_u32 s17, s43, 0
    s_mov_b32 s18, s58
    s_mov_b32 s19, 0x00020000
    s_add_u32 m0, s31, 0
    s_add_u32 s32, s64, 0
    buffer_load_dwordx4 v158, s[4:7], s32 offen lds
    buffer_load_dwordx4 v159, s[4:7], s32 offen offset:1024 lds
    buffer_load_dwordx4 v160, s[4:7], s32 offen offset:2048 lds
    buffer_load_dwordx4 v161, s[4:7], s32 offen offset:3072 lds
    s_add_u32 m0, s31, 4096
    s_nop 0
    buffer_load_dwordx4 v162, s[4:7], s32 offen lds
    s_add_u32 m0, s30, 0
    s_add_u32 s33, s71, 0
    buffer_load_dwordx4 v163, s[16:19], s33 offen lds
    buffer_load_dwordx4 v164, s[16:19], s33 offen offset:1024 lds
    buffer_load_dwordx4 v165, s[16:19], s33 offen offset:2048 lds
    buffer_load_dwordx4 v166, s[16:19], s33 offen offset:3072 lds
    s_lshl_b32 s58, s61, 4
    s_add_u32 s58, s58, s60
    s_lshl_b32 s59, s58, 18
    s_add_u32 s8, s38, s59
    s_addc_u32 s9, s39, 0
    s_mov_b32 s10, 262144
    s_mov_b32 s11, 0x00020000
    s_add_u32 s12, s40, s59
    s_addc_u32 s13, s41, 0
    s_mov_b32 s14, 262144
    s_mov_b32 s15, 0x00020000
    s_lshl_b32 s59, s62, 7
    s_add_u32 s58, s58, s59
    s_mul_i32 s59, s58, 143360
    s_add_u32 s24, s56, s59
    s_addc_u32 s25, s57, 0
    s_mov_b32 s26, 143360
    s_mov_b32 s27, 0x00020000
    s_mul_i32 s59, s60, 229376
    s_add_u32 s20, s44, s59
    s_addc_u32 s21, s45, 0
    s_mov_b32 s22, 229376
    s_mov_b32 s23, 0x00020000
    s_add_u32 s96, s56, 0x3000000
    s_addc_u32 s97, s57, 0
    s_mov_b32 s98, 131072
    s_mov_b32 s99, 0x00020000
    s_lshl_b32 s59, s62, 3
    s_add_u32 s59, s59, s61
    s_lshl_b32 s100, s59, 13
    s_branch L_first
L_restart:
    v_and_b32 v32, 15, v1
    v_lshrrev_b32 v33, 4, v1
    v_bfe_u32 v34, v1, 2, 2
    v_and_b32 v35, 3, v1
    v_lshrrev_b32 v36, 3, v1
    v_and_b32 v37, 7, v1
    v_mov_b32 v40, s28
    s_mov_b32 s63, 896
    v_mad_u32_u24 v38, v40, 5, 0
    v_and_b32 v39, 1, v38
    v_lshl_add_u32 v39, v39, 2, v33
    v_xor_b32 v39, v39, v37
    v_lshlrev_b32 v39, 4, v39
    v_lshl_add_u32 v38, v38, 3, v36
    v_mad_u32_u24 v158, v38, s63, v39
    v_mad_u32_u24 v38, v40, 5, 1
    v_and_b32 v39, 1, v38
    v_lshl_add_u32 v39, v39, 2, v33
    v_xor_b32 v39, v39, v37
    v_lshlrev_b32 v39, 4, v39
    v_lshl_add_u32 v38, v38, 3, v36
    v_mad_u32_u24 v159, v38, s63, v39
    v_subrev_u32 v159, 1024, v159
    v_mad_u32_u24 v38, v40, 5, 2
    v_and_b32 v39, 1, v38
    v_lshl_add_u32 v39, v39, 2, v33
    v_xor_b32 v39, v39, v37
    v_lshlrev_b32 v39, 4, v39
    v_lshl_add_u32 v38, v38, 3, v36
    v_mad_u32_u24 v160, v38, s63, v39
    v_subrev_u32 v160, 2048, v160
    v_mad_u32_u24 v38, v40, 5, 3
    v_and_b32 v39, 1, v38
    v_lshl_add_u32 v39, v39, 2, v33
    v_xor_b32 v39, v39, v37
    v_lshlrev_b32 v39, 4, v39
    v_lshl_add_u32 v38, v38, 3, v36
    v_mad_u32_u24 v161, v38, s63, v39
    v_subrev_u32 v161, 3072, v161
    v_mad_u32_u24 v38, v40, 5, 4
    v_and_b32 v39, 1, v38
    v_lshl_add_u32 v39, v39, 2, v33
    v_xor_b32 v39, v39, v37
    v_lshlrev_b32 v39, 4, v39
    v_lshl_add_u32 v38, v38, 3, v36
    v_mad_u32_u24 v162, v38, s63, v39
    v_bfe_u32 v39, v36, 1, 1
    v_lshlrev_b32 v39, 1, v39
    v_xor_b32 v39, v39, v37
    v_lshlrev_b32 v39, 4, v39
    v_lshl_add_u32 v39, v40, 7, v39
    v_lshlrev_b32 v38, 13, v36
    v_add_u32 v163, v38, v39
    v_bfe_u32 v39, v36, 1, 1
    v_or_b32 v39, 2, v39
    v_lshlrev_b32 v39, 1, v39
    v_xor_b32 v39, v39, v37
    v_lshlrev_b32 v39, 4, v39
    v_lshl_add_u32 v39, v40, 7, v39
    v_lshlrev_b32 v38, 13, v36
    v_add_u32 v164, v38, v39
    v_add_u32 v165, 129024, v163
    v_add_u32 v166, 193536, v164
    v_add_u32 v164, 64512, v164
    s_add_u32 m0, s31, 0
    s_add_u32 s32, s64, 0
    buffer_load_dwordx4 v158, s[4:7], s32 offen lds
    buffer_load_dwordx4 v159, s[4:7], s32 offen offset:1024 lds
    buffer_load_dwordx4 v160, s[4:7], s32 offen offset:2048 lds
    buffer_load_dwordx4 v161, s[4:7], s32 offen offset:3072 lds
    s_add_u32 m0, s31, 4096
    s_nop 0
    buffer_load_dwordx4 v162, s[4:7], s32 offen lds
    s_add_u32 m0, s30, 0
    s_add_u32 s33, s71, 0
    buffer_load_dwordx4 v163, s[16:19], s33 offen lds
    buffer_load_dwordx4 v164, s[16:19], s33 offen offset:1024 lds
    buffer_load_dwordx4 v165, s[16:19], s33 offen offset:2048 lds
    buffer_load_dwordx4 v166, s[16:19], s33 offen offset:3072 lds
L_first:
    v_add_u32 v39, 0, v33
    v_xor_b32 v39, v39, v37
    v_lshlrev_b32 v39, 4, v39
    v_lshl_add_u32 v38, v40, 5, v36
    v_lshlrev_b32 v38, 9, v38
    v_add_u32 v10, v38, v39
    v_add_u32 v39, 4, v33
    v_xor_b32 v39, v39, v37
    v_lshlrev_b32 v39, 4, v39
    v_lshl_add_u32 v38, v40, 5, v36
    v_lshlrev_b32 v38, 9, v38
    v_add_u32 v11, v38, v39
    v_add_u32 v12, 6144, v10
    v_add_u32 v13, 9216, v11
    v_add_u32 v11, 3072, v11
    v_bfe_u32 v39, v36, 1, 2
    v_lshlrev_b32 v39, 1, v39
    v_xor_b32 v39, v39, v37
    v_lshlrev_b32 v41, 4, v39
    v_lshlrev_b32 v39, 9, v36
    v_add_u32 v39, v39, v41
    v_lshl_add_u32 v14, v40, 7, v39
    s_mov_b32 s58, 224
    v_mad_u32_u24 v39, v36, s63, v41
    v_mad_u32_u24 v15, v40, s58, v39
    v_lshlrev_b32 v38, 4, v1
    v_add_u32 v2, 16384, v38
    v_add_u32 v3, 57344, v38
    v_lshrrev_b32 v39, 1, v32
    v_add_u32 v38, 0, v33
    v_xor_b32 v38, v38, v39
    v_lshlrev_b32 v38, 4, v38
    v_lshl_add_u32 v38, v32, 7, v38
    v_add_u32 v152, 49152, v38
    v_add_u32 v4, s29, v38
    v_add_u32 v38, 4, v33
    v_xor_b32 v38, v38, v39
    v_lshlrev_b32 v38, 4, v38
    v_lshl_add_u32 v38, v32, 7, v38
    v_add_u32 v153, 49152, v38
    v_add_u32 v5, s29, v38
    v_lshrrev_b32 v39, 1, v34
    v_and_b32 v38, 1, v33
    v_lshl_or_b32 v42, v38, 1, v39
    v_lshl_add_u32 v43, v33, 1, v39
    v_and_b32 v43, 3, v43
    v_lshl_add_u32 v44, v33, 3, v34
    v_lshlrev_b32 v44, 7, v44
    v_lshl_add_u32 v44, v35, 3, v44
    v_add_u32 v44, s30, v44
    v_xor_b32 v38, 0, v42
    v_lshl_add_u32 v154, v38, 5, v44
    v_xor_b32 v38, 1, v42
    v_lshl_add_u32 v155, v38, 5, v44
    v_xor_b32 v38, 2, v42
    v_lshl_add_u32 v156, v38, 5, v44
    v_xor_b32 v38, 3, v42
    v_lshl_add_u32 v157, v38, 5, v44
    v_lshl_add_u32 v44, v33, 2, v34
    v_lshlrev_b32 v44, 7, v44
    v_lshl_add_u32 v44, v35, 3, v44
    v_add_u32 v44, s29, v44
    v_xor_b32 v38, 0, v43
    v_lshl_add_u32 v6, v38, 5, v44
    v_xor_b32 v38, 1, v43
    v_lshl_add_u32 v7, v38, 5, v44
    v_xor_b32 v38, 2, v43
    v_lshl_add_u32 v8, v38, 5, v44
    v_xor_b32 v38, 3, v43
    v_lshl_add_u32 v9, v38, 5, v44
    s_mul_i32 s59, s28, 20480
    s_add_u32 s59, s59, 16384
    v_lshrrev_b32 v38, 1, v33
    v_and_b32 v39, 1, v33
    v_lshl_or_b32 v38, v39, 1, v38
    v_lshlrev_b32 v38, 8, v38
    v_lshl_add_u32 v38, v32, 4, v38
    v_add_u32 v167, s59, v38
    v_lshlrev_b32 v38, 4, v1
    s_mul_i32 s59, s28, 10240
    s_add_u32 s59, s59, 16384
    v_add_u32 v16, s59, v38
    s_lshl_b32 s59, s28, 10
    v_add_u32 v20, s59, v38
    v_lshlrev_b32 v19, 4, v32
    s_lshl_b32 s59, s28, 2
    v_add_u32 v18, s59, v19
    v_lshlrev_b32 v38, 2, v1
    v_add_u32 v38, 8192, v38
    v_cmp_eq_u32 vcc, 0, v33
    s_nop 1
    v_cndmask_b32 v31, v38, v18, vcc
    v_mov_b32 v21, 0xff800000
    v_mov_b32 v22, 0xff800000
    v_mov_b32 v23, 0xff800000
    v_mov_b32 v24, 0xff800000
    v_mov_b32 v25, 0xff800000
    v_mov_b32 v26, 0xff800000
    v_mov_b32 v27, 0xff800000
    v_mov_b32 v28, 0xff800000
    v_mov_b32 v29, 0xff800000
    v_mov_b32 v30, 0xff800000
    s_add_u32 m0, s30, 4096
    s_add_u32 s33, s71, 262144
    buffer_load_dwordx4 v163, s[16:19], s33 offen lds
    buffer_load_dwordx4 v164, s[16:19], s33 offen offset:1024 lds
    buffer_load_dwordx4 v165, s[16:19], s33 offen offset:2048 lds
    buffer_load_dwordx4 v166, s[16:19], s33 offen offset:3072 lds
    s_waitcnt vmcnt(4)
    s_barrier
    ds_read_b64_tr_b16 a[96:97], v154
    ds_read_b64_tr_b16 a[98:99], v154 offset:512
    ds_read_b64_tr_b16 a[100:101], v155
    ds_read_b64_tr_b16 a[102:103], v155 offset:512
    ds_read_b64_tr_b16 a[104:105], v156
    ds_read_b64_tr_b16 a[106:107], v156 offset:512
    ds_read_b64_tr_b16 a[108:109], v157
    ds_read_b64_tr_b16 a[110:111], v157 offset:512
    ds_read_b128 a[0:3], v152
    ds_read_b128 a[4:7], v152 offset:2048
    ds_read_b128 a[8:11], v152 offset:4096
    ds_read_b128 a[12:15], v152 offset:6144
    ds_read_b128 a[16:19], v152 offset:8192
    ds_read_b128 a[20:23], v152 offset:10240
    ds_read_b128 a[24:27], v152 offset:12288
    ds_read_b128 a[28:31], v152 offset:14336
    s_waitcnt lgkmcnt(4)
    v_mfma_f32_16x16x32_bf16 v[32:35], a[96:99], a[0:3], 0
    s_add_u32 m0, s30, 8192
    s_add_u32 s33, s72, 0
    buffer_load_dwordx4 v163, s[16:19], s33 offen lds
    v_mfma_f32_16x16x32_bf16 v[36:39], a[100:103], a[0:3], 0
    v_mfma_f32_16x16x32_bf16 v[40:43], a[104:107], a[0:3], 0
    buffer_load_dwordx4 v164, s[16:19], s33 offen offset:1024 lds
    v_mfma_f32_16x16x32_bf16 v[44:47], a[108:111], a[0:3], 0
    ds_read_b128 a[0:3], v152 offset:16384
    v_mfma_f32_16x16x32_bf16 v[48:51], a[96:99], a[4:7], 0
    buffer_load_dwordx4 v165, s[16:19], s33 offen offset:2048 lds
    v_mfma_f32_16x16x32_bf16 v[52:55], a[100:103], a[4:7], 0
    v_mfma_f32_16x16x32_bf16 v[56:59], a[104:107], a[4:7], 0
    buffer_load_dwordx4 v166, s[16:19], s33 offen offset:3072 lds
    v_mfma_f32_16x16x32_bf16 v[60:63], a[108:111], a[4:7], 0
    ds_read_b128 a[4:7], v152 offset:18432
    v_mfma_f32_16x16x32_bf16 v[64:67], a[96:99], a[8:11], 0
    s_add_u32 m0, s31, 20480
    s_add_u32 s32, s65, 0
    buffer_load_dwordx4 v158, s[4:7], s32 offen lds
    v_mfma_f32_16x16x32_bf16 v[68:71], a[100:103], a[8:11], 0
    v_mfma_f32_16x16x32_bf16 v[72:75], a[104:107], a[8:11], 0
    v_mfma_f32_16x16x32_bf16 v[76:79], a[108:111], a[8:11], 0
    buffer_load_dwordx4 v159, s[4:7], s32 offen offset:1024 lds
    ds_read_b128 a[8:11], v153
    v_mfma_f32_16x16x32_bf16 v[80:83], a[96:99], a[12:15], 0
    v_mfma_f32_16x16x32_bf16 v[84:87], a[100:103], a[12:15], 0
    v_mfma_f32_16x16x32_bf16 v[88:91], a[104:107], a[12:15], 0
    buffer_load_dwordx4 v160, s[4:7], s32 offen offset:2048 lds
    v_mfma_f32_16x16x32_bf16 v[92:95], a[108:111], a[12:15], 0
    ds_read_b128 a[12:15], v153 offset:2048
    s_waitcnt lgkmcnt(4)
    v_mfma_f32_16x16x32_bf16 v[96:99], a[96:99], a[16:19], 0
    v_mfma_f32_16x16x32_bf16 v[100:103], a[100:103], a[16:19], 0
    buffer_load_dwordx4 v161, s[4:7], s32 offen offset:3072 lds
    v_mfma_f32_16x16x32_bf16 v[104:107], a[104:107], a[16:19], 0
    v_mfma_f32_16x16x32_bf16 v[108:111], a[108:111], a[16:19], 0
    ds_read_b128 a[16:19], v153 offset:4096
    v_mfma_f32_16x16x32_bf16 v[112:115], a[96:99], a[20:23], 0
    s_add_u32 m0, s31, 24576
    s_nop 0
    buffer_load_dwordx4 v162, s[4:7], s32 offen lds
    v_mfma_f32_16x16x32_bf16 v[116:119], a[100:103], a[20:23], 0
    s_waitcnt vmcnt(9)
    v_mfma_f32_16x16x32_bf16 v[120:123], a[104:107], a[20:23], 0
    ds_read_b64_tr_b16 a[112:113], v154 offset:4096
    ds_read_b64_tr_b16 a[114:115], v154 offset:4608
    v_mfma_f32_16x16x32_bf16 v[124:127], a[108:111], a[20:23], 0
    ds_read_b64_tr_b16 a[116:117], v155 offset:4096
    ds_read_b128 a[20:23], v153 offset:6144
    v_mfma_f32_16x16x32_bf16 v[128:131], a[96:99], a[24:27], 0
    s_add_u32 m0, s30, 0
    s_add_u32 s33, s72, 262144
    buffer_load_dwordx4 v163, s[16:19], s33 offen lds
    v_mfma_f32_16x16x32_bf16 v[132:135], a[100:103], a[24:27], 0
    v_mfma_f32_16x16x32_bf16 v[136:139], a[104:107], a[24:27], 0
    ds_read_b64_tr_b16 a[118:119], v155 offset:4608
    ds_read_b64_tr_b16 a[120:121], v156 offset:4096
    v_mfma_f32_16x16x32_bf16 v[140:143], a[108:111], a[24:27], 0
    buffer_load_dwordx4 v164, s[16:19], s33 offen offset:1024 lds
    ds_read_b128 a[24:27], v153 offset:8192
    v_mfma_f32_16x16x32_bf16 v[144:147], a[96:99], a[28:31], 0
    v_mfma_f32_16x16x32_bf16 v[148:151], a[100:103], a[28:31], 0
    ds_read_b64_tr_b16 a[122:123], v156 offset:4608
    ds_read_b64_tr_b16 a[124:125], v157 offset:4096
    v_mfma_f32_16x16x32_bf16 v[176:179], a[104:107], a[28:31], 0
    buffer_load_dwordx4 v165, s[16:19], s33 offen offset:2048 lds
    v_mfma_f32_16x16x32_bf16 v[180:183], a[108:111], a[28:31], 0
    ds_read_b128 a[28:31], v153 offset:10240
    s_waitcnt lgkmcnt(11)
    v_mfma_f32_16x16x32_bf16 v[184:187], a[96:99], a[0:3], 0
    v_mfma_f32_16x16x32_bf16 v[188:191], a[100:103], a[0:3], 0
    buffer_load_dwordx4 v166, s[16:19], s33 offen offset:3072 lds
    v_mfma_f32_16x16x32_bf16 v[192:195], a[104:107], a[0:3], 0
    v_mfma_f32_16x16x32_bf16 v[196:199], a[108:111], a[0:3], 0
    ds_read_b64_tr_b16 a[126:127], v157 offset:4608
    ds_read_b128 a[0:3], v153 offset:12288
    v_mfma_f32_16x16x32_bf16 v[200:203], a[96:99], a[4:7], 0
    v_mfma_f32_16x16x32_bf16 v[204:207], a[100:103], a[4:7], 0
    v_mfma_f32_16x16x32_bf16 v[208:211], a[104:107], a[4:7], 0
    v_mfma_f32_16x16x32_bf16 v[212:215], a[108:111], a[4:7], 0
    ds_read_b128 a[4:7], v153 offset:14336
    s_waitcnt lgkmcnt(11)
    v_mfma_f32_16x16x32_bf16 v[32:35], a[112:115], a[8:11], v[32:35]
    s_waitcnt lgkmcnt(8)
    v_mfma_f32_16x16x32_bf16 v[36:39], a[116:119], a[8:11], v[36:39]
    s_waitcnt lgkmcnt(5)
    v_mfma_f32_16x16x32_bf16 v[40:43], a[120:123], a[8:11], v[40:43]
    s_waitcnt lgkmcnt(2)
    v_mfma_f32_16x16x32_bf16 v[44:47], a[124:127], a[8:11], v[44:47]
    s_add_u32 m0, s30, 4096
    s_add_u32 s33, s73, 0
    buffer_load_dwordx4 v163, s[16:19], s33 offen lds
    ds_read_b128 a[8:11], v153 offset:16384
    v_mfma_f32_16x16x32_bf16 v[48:51], a[112:115], a[12:15], v[48:51]
    v_mfma_f32_16x16x32_bf16 v[52:55], a[116:119], a[12:15], v[52:55]
    v_mfma_f32_16x16x32_bf16 v[56:59], a[120:123], a[12:15], v[56:59]
    buffer_load_dwordx4 v164, s[16:19], s33 offen offset:1024 lds
    v_mfma_f32_16x16x32_bf16 v[60:63], a[124:127], a[12:15], v[60:63]
    ds_read_b128 a[12:15], v153 offset:18432
    v_mfma_f32_16x16x32_bf16 v[64:67], a[112:115], a[16:19], v[64:67]
    v_mfma_f32_16x16x32_bf16 v[68:71], a[116:119], a[16:19], v[68:71]
    buffer_load_dwordx4 v165, s[16:19], s33 offen offset:2048 lds
    v_mfma_f32_16x16x32_bf16 v[72:75], a[120:123], a[16:19], v[72:75]
    v_mfma_f32_16x16x32_bf16 v[76:79], a[124:127], a[16:19], v[76:79]
    s_waitcnt vmcnt(7)
    s_waitcnt lgkmcnt(0)
    s_barrier
    ds_read_b128 a[16:19], v152 offset:20480
    v_mfma_f32_16x16x32_bf16 v[80:83], a[112:115], a[20:23], v[80:83]
    buffer_load_dwordx4 v166, s[16:19], s33 offen offset:3072 lds
    v_mfma_f32_16x16x32_bf16 v[84:87], a[116:119], a[20:23], v[84:87]
    v_mfma_f32_16x16x32_bf16 v[88:91], a[120:123], a[20:23], v[88:91]
    v_mfma_f32_16x16x32_bf16 v[92:95], a[124:127], a[20:23], v[92:95]
    ds_read_b128 a[20:23], v152 offset:22528
    v_mfma_f32_16x16x32_bf16 v[96:99], a[112:115], a[24:27], v[96:99]
    v_mfma_f32_16x16x32_bf16 v[100:103], a[116:119], a[24:27], v[100:103]
    v_mfma_f32_16x16x32_bf16 v[104:107], a[120:123], a[24:27], v[104:107]
    v_mfma_f32_16x16x32_bf16 v[108:111], a[124:127], a[24:27], v[108:111]
    s_add_u32 m0, s31, 0
    s_add_u32 s32, s66, 0
    buffer_load_dwordx4 v158, s[4:7], s32 offen lds
    ds_read_b128 a[24:27], v152 offset:24576
    v_mfma_f32_16x16x32_bf16 v[112:115], a[112:115], a[28:31], v[112:115]
    v_mfma_f32_16x16x32_bf16 v[116:119], a[116:119], a[28:31], v[116:119]
    ds_read_b64_tr_b16 a[96:97], v154 offset:8192
    v_mfma_f32_16x16x32_bf16 v[120:123], a[120:123], a[28:31], v[120:123]
    buffer_load_dwordx4 v159, s[4:7], s32 offen offset:1024 lds
    v_mfma_f32_16x16x32_bf16 v[124:127], a[124:127], a[28:31], v[124:127]
    ds_read_b128 a[28:31], v152 offset:26624
    v_mfma_f32_16x16x32_bf16 v[128:131], a[112:115], a[0:3], v[128:131]
    v_mfma_f32_16x16x32_bf16 v[132:135], a[116:119], a[0:3], v[132:135]
    buffer_load_dwordx4 v160, s[4:7], s32 offen offset:2048 lds
    v_mfma_f32_16x16x32_bf16 v[136:139], a[120:123], a[0:3], v[136:139]
    v_mfma_f32_16x16x32_bf16 v[140:143], a[124:127], a[0:3], v[140:143]
    ds_read_b64_tr_b16 a[98:99], v154 offset:8704
    ds_read_b128 a[0:3], v152 offset:28672
    v_mfma_f32_16x16x32_bf16 v[144:147], a[112:115], a[4:7], v[144:147]
    buffer_load_dwordx4 v161, s[4:7], s32 offen offset:3072 lds
    v_mfma_f32_16x16x32_bf16 v[148:151], a[116:119], a[4:7], v[148:151]
    v_mfma_f32_16x16x32_bf16 v[176:179], a[120:123], a[4:7], v[176:179]
    ds_read_b64_tr_b16 a[100:101], v155 offset:8192
    ds_read_b64_tr_b16 a[102:103], v155 offset:8704
    v_mfma_f32_16x16x32_bf16 v[180:183], a[124:127], a[4:7], v[180:183]
    s_add_u32 m0, s31, 4096
    s_nop 0
    buffer_load_dwordx4 v162, s[4:7], s32 offen lds
    ds_read_b128 a[4:7], v152 offset:30720
    v_mfma_f32_16x16x32_bf16 v[184:187], a[112:115], a[8:11], v[184:187]
    v_mfma_f32_16x16x32_bf16 v[188:191], a[116:119], a[8:11], v[188:191]
    ds_read_b64_tr_b16 a[104:105], v156 offset:8192
    ds_read_b64_tr_b16 a[106:107], v156 offset:8704
    v_mfma_f32_16x16x32_bf16 v[192:195], a[120:123], a[8:11], v[192:195]
    ds_read_b64_tr_b16 a[108:109], v157 offset:8192
    ds_read_b64_tr_b16 a[110:111], v157 offset:8704
    v_mfma_f32_16x16x32_bf16 v[196:199], a[124:127], a[8:11], v[196:199]
    ds_read_b128 a[8:11], v152 offset:32768
    v_mfma_f32_16x16x32_bf16 v[200:203], a[112:115], a[12:15], v[200:203]
    v_mfma_f32_16x16x32_bf16 v[204:207], a[116:119], a[12:15], v[204:207]
    v_mfma_f32_16x16x32_bf16 v[208:211], a[120:123], a[12:15], v[208:211]
    v_mfma_f32_16x16x32_bf16 v[212:215], a[124:127], a[12:15], v[212:215]
    ds_read_b128 a[12:15], v152 offset:34816
    s_waitcnt lgkmcnt(11)
    s_waitcnt lgkmcnt(10)
    v_mfma_f32_16x16x32_bf16 v[32:35], a[96:99], a[16:19], v[32:35]
    s_waitcnt lgkmcnt(7)
    v_mfma_f32_16x16x32_bf16 v[36:39], a[100:103], a[16:19], v[36:39]
    s_waitcnt lgkmcnt(4)
    v_mfma_f32_16x16x32_bf16 v[40:43], a[104:107], a[16:19], v[40:43]
    s_waitcnt lgkmcnt(2)
    v_mfma_f32_16x16x32_bf16 v[44:47], a[108:111], a[16:19], v[44:47]
    s_add_u32 m0, s30, 8192
    s_add_u32 s33, s73, 262144
    buffer_load_dwordx4 v163, s[16:19], s33 offen lds
    ds_read_b128 a[16:19], v152 offset:36864
    v_mfma_f32_16x16x32_bf16 v[48:51], a[96:99], a[20:23], v[48:51]
    v_mfma_f32_16x16x32_bf16 v[52:55], a[100:103], a[20:23], v[52:55]
    v_mfma_f32_16x16x32_bf16 v[56:59], a[104:107], a[20:23], v[56:59]
    buffer_load_dwordx4 v164, s[16:19], s33 offen offset:1024 lds
    v_mfma_f32_16x16x32_bf16 v[60:63], a[108:111], a[20:23], v[60:63]
    ds_read_b128 a[20:23], v152 offset:38912
    v_mfma_f32_16x16x32_bf16 v[64:67], a[96:99], a[24:27], v[64:67]
    v_mfma_f32_16x16x32_bf16 v[68:71], a[100:103], a[24:27], v[68:71]
    buffer_load_dwordx4 v165, s[16:19], s33 offen offset:2048 lds
    v_mfma_f32_16x16x32_bf16 v[72:75], a[104:107], a[24:27], v[72:75]
    v_mfma_f32_16x16x32_bf16 v[76:79], a[108:111], a[24:27], v[76:79]
    ds_read_b128 a[24:27], v153 offset:20480
    v_mfma_f32_16x16x32_bf16 v[80:83], a[96:99], a[28:31], v[80:83]
    buffer_load_dwordx4 v166, s[16:19], s33 offen offset:3072 lds
    v_mfma_f32_16x16x32_bf16 v[84:87], a[100:103], a[28:31], v[84:87]
    v_mfma_f32_16x16x32_bf16 v[88:91], a[104:107], a[28:31], v[88:91]
    v_mfma_f32_16x16x32_bf16 v[92:95], a[108:111], a[28:31], v[92:95]
    ds_read_b128 a[28:31], v153 offset:22528
    s_waitcnt lgkmcnt(4)
    v_mfma_f32_16x16x32_bf16 v[96:99], a[96:99], a[0:3], v[96:99]
    v_mfma_f32_16x16x32_bf16 v[100:103], a[100:103], a[0:3], v[100:103]
    v_mfma_f32_16x16x32_bf16 v[104:107], a[104:107], a[0:3], v[104:107]
    v_mfma_f32_16x16x32_bf16 v[108:111], a[108:111], a[0:3], v[108:111]
    ds_read_b128 a[0:3], v153 offset:24576
    v_mfma_f32_16x16x32_bf16 v[112:115], a[96:99], a[4:7], v[112:115]
    s_waitcnt vmcnt(13)
    ds_read_b64_tr_b16 a[112:113], v154
    v_mfma_f32_16x16x32_bf16 v[116:119], a[100:103], a[4:7], v[116:119]
    ds_read_b64_tr_b16 a[114:115], v154 offset:512
    ds_read_b64_tr_b16 a[116:117], v155
    v_mfma_f32_16x16x32_bf16 v[120:123], a[104:107], a[4:7], v[120:123]
    s_add_u32 m0, s29, 0
    s_mov_b32 s32, 0
    buffer_load_dwordx4 v10, s[8:11], s32 offen nt lds
    v_mfma_f32_16x16x32_bf16 v[124:127], a[108:111], a[4:7], v[124:127]
    ds_read_b128 a[4:7], v153 offset:26624
    v_mfma_f32_16x16x32_bf16 v[128:131], a[96:99], a[8:11], v[128:131]
    ds_read_b64_tr_b16 a[118:119], v155 offset:512
    v_mfma_f32_16x16x32_bf16 v[132:135], a[100:103], a[8:11], v[132:135]
    buffer_load_dwordx4 v11, s[8:11], s32 offen offset:1024 nt lds
    v_mfma_f32_16x16x32_bf16 v[136:139], a[104:107], a[8:11], v[136:139]
    v_mfma_f32_16x16x32_bf16 v[140:143], a[108:111], a[8:11], v[140:143]
    ds_read_b64_tr_b16 a[120:121], v156
    ds_read_b128 a[8:11], v153 offset:28672
    v_mfma_f32_16x16x32_bf16 v[144:147], a[96:99], a[12:15], v[144:147]
    buffer_load_dwordx4 v12, s[8:11], s32 offen offset:2048 nt lds
    v_mfma_f32_16x16x32_bf16 v[148:151], a[100:103], a[12:15], v[148:151]
    v_mfma_f32_16x16x32_bf16 v[176:179], a[104:107], a[12:15], v[176:179]
    ds_read_b64_tr_b16 a[122:123], v156 offset:512
    ds_read_b64_tr_b16 a[124:125], v157
    v_mfma_f32_16x16x32_bf16 v[180:183], a[108:111], a[12:15], v[180:183]
    buffer_load_dwordx4 v13, s[8:11], s32 offen offset:3072 nt lds
    ds_read_b128 a[12:15], v153 offset:30720
    s_waitcnt lgkmcnt(11)
    v_mfma_f32_16x16x32_bf16 v[184:187], a[96:99], a[16:19], v[184:187]
    v_mfma_f32_16x16x32_bf16 v[188:191], a[100:103], a[16:19], v[188:191]
    ds_read_b64_tr_b16 a[126:127], v157 offset:512
    v_mfma_f32_16x16x32_bf16 v[192:195], a[104:107], a[16:19], v[192:195]
    v_mfma_f32_16x16x32_bf16 v[196:199], a[108:111], a[16:19], v[196:199]
    ds_read_b128 a[16:19], v153 offset:32768
    v_mfma_f32_16x16x32_bf16 v[200:203], a[96:99], a[20:23], v[200:203]
    v_mfma_f32_16x16x32_bf16 v[204:207], a[100:103], a[20:23], v[204:207]
    v_mfma_f32_16x16x32_bf16 v[208:211], a[104:107], a[20:23], v[208:211]
    v_mfma_f32_16x16x32_bf16 v[212:215], a[108:111], a[20:23], v[212:215]
    ds_read_b128 a[20:23], v153 offset:34816
    s_waitcnt lgkmcnt(11)
    v_mfma_f32_16x16x32_bf16 v[32:35], a[112:115], a[24:27], v[32:35]
    s_waitcnt lgkmcnt(8)
    v_mfma_f32_16x16x32_bf16 v[36:39], a[116:119], a[24:27], v[36:39]
    s_waitcnt lgkmcnt(5)
    v_mfma_f32_16x16x32_bf16 v[40:43], a[120:123], a[24:27], v[40:43]
    s_waitcnt lgkmcnt(2)
    v_mfma_f32_16x16x32_bf16 v[44:47], a[124:127], a[24:27], v[44:47]
    s_add_u32 m0, s30, 0
    s_add_u32 s33, s74, 0
    buffer_load_dwordx4 v163, s[16:19], s33 offen lds
    ds_read_b128 a[24:27], v153 offset:36864
    v_mfma_f32_16x16x32_bf16 v[48:51], a[112:115], a[28:31], v[48:51]
    v_mfma_f32_16x16x32_bf16 v[52:55], a[116:119], a[28:31], v[52:55]
    v_mfma_f32_16x16x32_bf16 v[56:59], a[120:123], a[28:31], v[56:59]
    buffer_load_dwordx4 v164, s[16:19], s33 offen offset:1024 lds
    v_mfma_f32_16x16x32_bf16 v[60:63], a[124:127], a[28:31], v[60:63]
    ds_read_b128 a[28:31], v153 offset:38912
    v_mfma_f32_16x16x32_bf16 v[64:67], a[112:115], a[0:3], v[64:67]
    v_mfma_f32_16x16x32_bf16 v[68:71], a[116:119], a[0:3], v[68:71]
    buffer_load_dwordx4 v165, s[16:19], s33 offen offset:2048 lds
    v_mfma_f32_16x16x32_bf16 v[72:75], a[120:123], a[0:3], v[72:75]
    v_mfma_f32_16x16x32_bf16 v[76:79], a[124:127], a[0:3], v[76:79]
    s_waitcnt vmcnt(11)
    s_waitcnt lgkmcnt(0)
    s_barrier
    ds_read_b128 a[0:3], v152
    v_mfma_f32_16x16x32_bf16 v[80:83], a[112:115], a[4:7], v[80:83]
    buffer_load_dwordx4 v166, s[16:19], s33 offen offset:3072 lds
    v_mfma_f32_16x16x32_bf16 v[84:87], a[116:119], a[4:7], v[84:87]
    v_mfma_f32_16x16x32_bf16 v[88:91], a[120:123], a[4:7], v[88:91]
    v_mfma_f32_16x16x32_bf16 v[92:95], a[124:127], a[4:7], v[92:95]
    ds_read_b128 a[4:7], v152 offset:2048
    v_mfma_f32_16x16x32_bf16 v[96:99], a[112:115], a[8:11], v[96:99]
    v_mfma_f32_16x16x32_bf16 v[100:103], a[116:119], a[8:11], v[100:103]
    v_mfma_f32_16x16x32_bf16 v[104:107], a[120:123], a[8:11], v[104:107]
    v_mfma_f32_16x16x32_bf16 v[108:111], a[124:127], a[8:11], v[108:111]
    s_add_u32 m0, s31, 20480
    s_add_u32 s32, s67, 0
    buffer_load_dwordx4 v158, s[4:7], s32 offen lds
    ds_read_b128 a[8:11], v152 offset:4096
    v_mfma_f32_16x16x32_bf16 v[112:115], a[112:115], a[12:15], v[112:115]
    v_mfma_f32_16x16x32_bf16 v[116:119], a[116:119], a[12:15], v[116:119]
    ds_read_b64_tr_b16 a[96:97], v154 offset:4096
    ds_read_b64_tr_b16 a[98:99], v154 offset:4608
    v_mfma_f32_16x16x32_bf16 v[120:123], a[120:123], a[12:15], v[120:123]
    buffer_load_dwordx4 v159, s[4:7], s32 offen offset:1024 lds
    v_mfma_f32_16x16x32_bf16 v[124:127], a[124:127], a[12:15], v[124:127]
    ds_read_b128 a[12:15], v152 offset:6144
    v_mfma_f32_16x16x32_bf16 v[128:131], a[112:115], a[16:19], v[128:131]
    ds_read_b64_tr_b16 a[100:101], v155 offset:4096
    v_mfma_f32_16x16x32_bf16 v[132:135], a[116:119], a[16:19], v[132:135]
    buffer_load_dwordx4 v160, s[4:7], s32 offen offset:2048 lds
    v_mfma_f32_16x16x32_bf16 v[136:139], a[120:123], a[16:19], v[136:139]
    ds_read_b64_tr_b16 a[102:103], v155 offset:4608
    v_mfma_f32_16x16x32_bf16 v[140:143], a[124:127], a[16:19], v[140:143]
    ds_read_b128 a[16:19], v152 offset:8192
    v_mfma_f32_16x16x32_bf16 v[144:147], a[112:115], a[20:23], v[144:147]
    buffer_load_dwordx4 v161, s[4:7], s32 offen offset:3072 lds
    v_mfma_f32_16x16x32_bf16 v[148:151], a[116:119], a[20:23], v[148:151]
    ds_read_b64_tr_b16 a[104:105], v156 offset:4096
    v_mfma_f32_16x16x32_bf16 v[176:179], a[120:123], a[20:23], v[176:179]
    ds_read_b64_tr_b16 a[106:107], v156 offset:4608
    v_mfma_f32_16x16x32_bf16 v[180:183], a[124:127], a[20:23], v[180:183]
    s_add_u32 m0, s31, 24576
    s_nop 0
    buffer_load_dwordx4 v162, s[4:7], s32 offen lds
    ds_read_b128 a[20:23], v152 offset:10240
    v_mfma_f32_16x16x32_bf16 v[184:187], a[112:115], a[24:27], v[184:187]
    ds_read_b64_tr_b16 a[108:109], v157 offset:4096
    v_mfma_f32_16x16x32_bf16 v[188:191], a[116:119], a[24:27], v[188:191]
    ds_read_b64_tr_b16 a[110:111], v157 offset:4608
    v_mfma_f32_16x16x32_bf16 v[192:195], a[120:123], a[24:27], v[192:195]
    v_mfma_f32_16x16x32_bf16 v[196:199], a[124:127], a[24:27], v[196:199]
    ds_read_b128 a[24:27], v152 offset:12288
    v_mfma_f32_16x16x32_bf16 v[200:203], a[112:115], a[28:31], v[200:203]
    v_mfma_f32_16x16x32_bf16 v[204:207], a[116:119], a[28:31], v[204:207]
    v_mfma_f32_16x16x32_bf16 v[208:211], a[120:123], a[28:31], v[208:211]
    v_mfma_f32_16x16x32_bf16 v[212:215], a[124:127], a[28:31], v[212:215]
    ds_read_b128 a[28:31], v152 offset:14336
    s_waitcnt lgkmcnt(10)
    v_mfma_f32_16x16x32_bf16 v[32:35], a[96:99], a[0:3], v[32:35]
    s_waitcnt lgkmcnt(8)
    v_mfma_f32_16x16x32_bf16 v[36:39], a[100:103], a[0:3], v[36:39]
    s_waitcnt lgkmcnt(5)
    v_mfma_f32_16x16x32_bf16 v[40:43], a[104:107], a[0:3], v[40:43]
    s_waitcnt lgkmcnt(2)
    v_mfma_f32_16x16x32_bf16 v[44:47], a[108:111], a[0:3], v[44:47]
    s_add_u32 m0, s30, 4096
    s_add_u32 s33, s74, 262144
    buffer_load_dwordx4 v163, s[16:19], s33 offen lds
    ds_read_b128 a[0:3], v152 offset:16384
    v_mfma_f32_16x16x32_bf16 v[48:51], a[96:99], a[4:7], v[48:51]
    v_mfma_f32_16x16x32_bf16 v[52:55], a[100:103], a[4:7], v[52:55]
    v_mfma_f32_16x16x32_bf16 v[56:59], a[104:107], a[4:7], v[56:59]
    buffer_load_dwordx4 v164, s[16:19], s33 offen offset:1024 lds
    v_mfma_f32_16x16x32_bf16 v[60:63], a[108:111], a[4:7], v[60:63]
    ds_read_b128 a[4:7], v152 offset:18432
    v_mfma_f32_16x16x32_bf16 v[64:67], a[96:99], a[8:11], v[64:67]
    v_mfma_f32_16x16x32_bf16 v[68:71], a[100:103], a[8:11], v[68:71]
    buffer_load_dwordx4 v165, s[16:19], s33 offen offset:2048 lds
    v_mfma_f32_16x16x32_bf16 v[72:75], a[104:107], a[8:11], v[72:75]
    v_mfma_f32_16x16x32_bf16 v[76:79], a[108:111], a[8:11], v[76:79]
    ds_read_b128 a[8:11], v153
    v_mfma_f32_16x16x32_bf16 v[80:83], a[96:99], a[12:15], v[80:83]
    buffer_load_dwordx4 v166, s[16:19], s33 offen offset:3072 lds
    v_mfma_f32_16x16x32_bf16 v[84:87], a[100:103], a[12:15], v[84:87]
    v_mfma_f32_16x16x32_bf16 v[88:91], a[104:107], a[12:15], v[88:91]
    v_mfma_f32_16x16x32_bf16 v[92:95], a[108:111], a[12:15], v[92:95]
    ds_read_b128 a[12:15], v153 offset:2048
    s_waitcnt lgkmcnt(4)
    v_mfma_f32_16x16x32_bf16 v[96:99], a[96:99], a[16:19], v[96:99]
    v_mfma_f32_16x16x32_bf16 v[100:103], a[100:103], a[16:19], v[100:103]
    v_mfma_f32_16x16x32_bf16 v[104:107], a[104:107], a[16:19], v[104:107]
    v_mfma_f32_16x16x32_bf16 v[108:111], a[108:111], a[16:19], v[108:111]
    ds_read_b128 a[16:19], v153 offset:4096
    v_mfma_f32_16x16x32_bf16 v[112:115], a[96:99], a[20:23], v[112:115]
    s_waitcnt vmcnt(17)
    ds_read_b64_tr_b16 a[112:113], v154 offset:8192
    v_mfma_f32_16x16x32_bf16 v[116:119], a[100:103], a[20:23], v[116:119]
    ds_read_b64_tr_b16 a[114:115], v154 offset:8704
    ds_read_b64_tr_b16 a[116:117], v155 offset:8192
    v_mfma_f32_16x16x32_bf16 v[120:123], a[104:107], a[20:23], v[120:123]
    s_add_u32 m0, s29, 4096
    s_mov_b32 s32, 128
    buffer_load_dwordx4 v10, s[8:11], s32 offen nt lds
    v_mfma_f32_16x16x32_bf16 v[124:127], a[108:111], a[20:23], v[124:127]
    ds_read_b128 a[20:23], v153 offset:6144
    v_mfma_f32_16x16x32_bf16 v[128:131], a[96:99], a[24:27], v[128:131]
    ds_read_b64_tr_b16 a[118:119], v155 offset:8704
    v_mfma_f32_16x16x32_bf16 v[132:135], a[100:103], a[24:27], v[132:135]
    buffer_load_dwordx4 v11, s[8:11], s32 offen offset:1024 nt lds
    v_mfma_f32_16x16x32_bf16 v[136:139], a[104:107], a[24:27], v[136:139]
    ds_read_b64_tr_b16 a[120:121], v156 offset:8192
    v_mfma_f32_16x16x32_bf16 v[140:143], a[108:111], a[24:27], v[140:143]
    ds_read_b128 a[24:27], v153 offset:8192
    v_mfma_f32_16x16x32_bf16 v[144:147], a[96:99], a[28:31], v[144:147]
    buffer_load_dwordx4 v12, s[8:11], s32 offen offset:2048 nt lds
    v_mfma_f32_16x16x32_bf16 v[148:151], a[100:103], a[28:31], v[148:151]
    ds_read_b64_tr_b16 a[122:123], v156 offset:8704
    v_mfma_f32_16x16x32_bf16 v[176:179], a[104:107], a[28:31], v[176:179]
    ds_read_b64_tr_b16 a[124:125], v157 offset:8192
    v_mfma_f32_16x16x32_bf16 v[180:183], a[108:111], a[28:31], v[180:183]
    buffer_load_dwordx4 v13, s[8:11], s32 offen offset:3072 nt lds
    ds_read_b128 a[28:31], v153 offset:10240
    s_waitcnt lgkmcnt(11)
    v_mfma_f32_16x16x32_bf16 v[184:187], a[96:99], a[0:3], v[184:187]
    ds_read_b64_tr_b16 a[126:127], v157 offset:8704
    v_mfma_f32_16x16x32_bf16 v[188:191], a[100:103], a[0:3], v[188:191]
    v_mfma_f32_16x16x32_bf16 v[192:195], a[104:107], a[0:3], v[192:195]
    v_mfma_f32_16x16x32_bf16 v[196:199], a[108:111], a[0:3], v[196:199]
    ds_read_b128 a[0:3], v153 offset:12288
    v_mfma_f32_16x16x32_bf16 v[200:203], a[96:99], a[4:7], v[200:203]
    v_mfma_f32_16x16x32_bf16 v[204:207], a[100:103], a[4:7], v[204:207]
    v_mfma_f32_16x16x32_bf16 v[208:211], a[104:107], a[4:7], v[208:211]
    v_mfma_f32_16x16x32_bf16 v[212:215], a[108:111], a[4:7], v[212:215]
    ds_read_b128 a[4:7], v153 offset:14336
    s_waitcnt lgkmcnt(11)
    v_mfma_f32_16x16x32_bf16 v[32:35], a[112:115], a[8:11], v[32:35]
    s_waitcnt lgkmcnt(8)
    v_mfma_f32_16x16x32_bf16 v[36:39], a[116:119], a[8:11], v[36:39]
    s_waitcnt lgkmcnt(5)
    v_mfma_f32_16x16x32_bf16 v[40:43], a[120:123], a[8:11], v[40:43]
    s_waitcnt lgkmcnt(2)
    v_mfma_f32_16x16x32_bf16 v[44:47], a[124:127], a[8:11], v[44:47]
    s_add_u32 m0, s30, 8192
    s_add_u32 s33, s75, 0
    buffer_load_dwordx4 v163, s[16:19], s33 offen lds
    ds_read_b128 a[8:11], v153 offset:16384
    v_mfma_f32_16x16x32_bf16 v[48:51], a[112:115], a[12:15], v[48:51]
    v_mfma_f32_16x16x32_bf16 v[52:55], a[116:119], a[12:15], v[52:55]
    v_mfma_f32_16x16x32_bf16 v[56:59], a[120:123], a[12:15], v[56:59]
    buffer_load_dwordx4 v164, s[16:19], s33 offen offset:1024 lds
    v_mfma_f32_16x16x32_bf16 v[60:63], a[124:127], a[12:15], v[60:63]
    ds_read_b128 a[12:15], v153 offset:18432
    v_mfma_f32_16x16x32_bf16 v[64:67], a[112:115], a[16:19], v[64:67]
    v_mfma_f32_16x16x32_bf16 v[68:71], a[116:119], a[16:19], v[68:71]
    buffer_load_dwordx4 v165, s[16:19], s33 offen offset:2048 lds
    v_mfma_f32_16x16x32_bf16 v[72:75], a[120:123], a[16:19], v[72:75]
    v_mfma_f32_16x16x32_bf16 v[76:79], a[124:127], a[16:19], v[76:79]
    s_waitcnt vmcnt(11)
    s_waitcnt lgkmcnt(0)
    s_barrier
    ds_read_b128 a[16:19], v152 offset:20480
    v_mfma_f32_16x16x32_bf16 v[80:83], a[112:115], a[20:23], v[80:83]
    buffer_load_dwordx4 v166, s[16:19], s33 offen offset:3072 lds
    v_mfma_f32_16x16x32_bf16 v[84:87], a[116:119], a[20:23], v[84:87]
    v_mfma_f32_16x16x32_bf16 v[88:91], a[120:123], a[20:23], v[88:91]
    v_mfma_f32_16x16x32_bf16 v[92:95], a[124:127], a[20:23], v[92:95]
    ds_read_b128 a[20:23], v152 offset:22528
    v_mfma_f32_16x16x32_bf16 v[96:99], a[112:115], a[24:27], v[96:99]
    v_mfma_f32_16x16x32_bf16 v[100:103], a[116:119], a[24:27], v[100:103]
    v_mfma_f32_16x16x32_bf16 v[104:107], a[120:123], a[24:27], v[104:107]
    v_mfma_f32_16x16x32_bf16 v[108:111], a[124:127], a[24:27], v[108:111]
    s_add_u32 m0, s31, 0
    s_add_u32 s32, s68, 0
    buffer_load_dwordx4 v158, s[4:7], s32 offen lds
    ds_read_b128 a[24:27], v152 offset:24576
    v_mfma_f32_16x16x32_bf16 v[112:115], a[112:115], a[28:31], v[112:115]
    v_mfma_f32_16x16x32_bf16 v[116:119], a[116:119], a[28:31], v[116:119]
    ds_read_b64_tr_b16 a[96:97], v154
    ds_read_b64_tr_b16 a[98:99], v154 offset:512
    v_mfma_f32_16x16x32_bf16 v[120:123], a[120:123], a[28:31], v[120:123]
    buffer_load_dwordx4 v159, s[4:7], s32 offen offset:1024 lds
    v_mfma_f32_16x16x32_bf16 v[124:127], a[124:127], a[28:31], v[124:127]
    ds_read_b128 a[28:31], v152 offset:26624
    v_mfma_f32_16x16x32_bf16 v[128:131], a[112:115], a[0:3], v[128:131]
    ds_read_b64_tr_b16 a[100:101], v155
    v_mfma_f32_16x16x32_bf16 v[132:135], a[116:119], a[0:3], v[132:135]
    buffer_load_dwordx4 v160, s[4:7], s32 offen offset:2048 lds
    v_mfma_f32_16x16x32_bf16 v[136:139], a[120:123], a[0:3], v[136:139]
    ds_read_b64_tr_b16 a[102:103], v155 offset:512
    v_mfma_f32_16x16x32_bf16 v[140:143], a[124:127], a[0:3], v[140:143]
    ds_read_b128 a[0:3], v152 offset:28672
    v_mfma_f32_16x16x32_bf16 v[144:147], a[112:115], a[4:7], v[144:147]
    buffer_load_dwordx4 v161, s[4:7], s32 offen offset:3072 lds
    v_mfma_f32_16x16x32_bf16 v[148:151], a[116:119], a[4:7], v[148:151]
    ds_read_b64_tr_b16 a[104:105], v156
    v_mfma_f32_16x16x32_bf16 v[176:179], a[120:123], a[4:7], v[176:179]
    ds_read_b64_tr_b16 a[106:107], v156 offset:512
    v_mfma_f32_16x16x32_bf16 v[180:183], a[124:127], a[4:7], v[180:183]
    s_add_u32 m0, s31, 4096
    s_nop 0
    buffer_load_dwordx4 v162, s[4:7], s32 offen lds
    ds_read_b128 a[4:7], v152 offset:30720
    v_mfma_f32_16x16x32_bf16 v[184:187], a[112:115], a[8:11], v[184:187]
    ds_read_b64_tr_b16 a[108:109], v157
    v_mfma_f32_16x16x32_bf16 v[188:191], a[116:119], a[8:11], v[188:191]
    ds_read_b64_tr_b16 a[110:111], v157 offset:512
    v_mfma_f32_16x16x32_bf16 v[192:195], a[120:123], a[8:11], v[192:195]
    v_mfma_f32_16x16x32_bf16 v[196:199], a[124:127], a[8:11], v[196:199]
    ds_read_b128 a[8:11], v152 offset:32768
    v_mfma_f32_16x16x32_bf16 v[200:203], a[112:115], a[12:15], v[200:203]
    v_mfma_f32_16x16x32_bf16 v[204:207], a[116:119], a[12:15], v[204:207]
    v_mfma_f32_16x16x32_bf16 v[208:211], a[120:123], a[12:15], v[208:211]
    v_mfma_f32_16x16x32_bf16 v[212:215], a[124:127], a[12:15], v[212:215]
    ds_read_b128 a[12:15], v152 offset:34816
    s_waitcnt lgkmcnt(10)
    v_mfma_f32_16x16x32_bf16 v[32:35], a[96:99], a[16:19], v[32:35]
    s_waitcnt lgkmcnt(8)
    v_mfma_f32_16x16x32_bf16 v[36:39], a[100:103], a[16:19], v[36:39]
    s_waitcnt lgkmcnt(5)
    v_mfma_f32_16x16x32_bf16 v[40:43], a[104:107], a[16:19], v[40:43]
    s_waitcnt lgkmcnt(2)
    v_mfma_f32_16x16x32_bf16 v[44:47], a[108:111], a[16:19], v[44:47]
    s_add_u32 m0, s30, 0
    s_add_u32 s33, s75, 262144
    buffer_load_dwordx4 v163, s[16:19], s33 offen lds
    ds_read_b128 a[16:19], v152 offset:36864
    v_mfma_f32_16x16x32_bf16 v[48:51], a[96:99], a[20:23], v[48:51]
    v_mfma_f32_16x16x32_bf16 v[52:55], a[100:103], a[20:23], v[52:55]
    v_mfma_f32_16x16x32_bf16 v[56:59], a[104:107], a[20:23], v[56:59]
    buffer_load_dwordx4 v164, s[16:19], s33 offen offset:1024 lds
    v_mfma_f32_16x16x32_bf16 v[60:63], a[108:111], a[20:23], v[60:63]
    ds_read_b128 a[20:23], v152 offset:38912
    v_mfma_f32_16x16x32_bf16 v[64:67], a[96:99], a[24:27], v[64:67]
    v_mfma_f32_16x16x32_bf16 v[68:71], a[100:103], a[24:27], v[68:71]
    buffer_load_dwordx4 v165, s[16:19], s33 offen offset:2048 lds
    v_mfma_f32_16x16x32_bf16 v[72:75], a[104:107], a[24:27], v[72:75]
    v_mfma_f32_16x16x32_bf16 v[76:79], a[108:111], a[24:27], v[76:79]
    ds_read_b128 a[24:27], v153 offset:20480
    v_mfma_f32_16x16x32_bf16 v[80:83], a[96:99], a[28:31], v[80:83]
    buffer_load_dwordx4 v166, s[16:19], s33 offen offset:3072 lds
    v_mfma_f32_16x16x32_bf16 v[84:87], a[100:103], a[28:31], v[84:87]
    v_mfma_f32_16x16x32_bf16 v[88:91], a[104:107], a[28:31], v[88:91]
    v_mfma_f32_16x16x32_bf16 v[92:95], a[108:111], a[28:31], v[92:95]
    ds_read_b128 a[28:31], v153 offset:22528
    s_waitcnt lgkmcnt(4)
    v_mfma_f32_16x16x32_bf16 v[96:99], a[96:99], a[0:3], v[96:99]
    v_mfma_f32_16x16x32_bf16 v[100:103], a[100:103], a[0:3], v[100:103]
    v_mfma_f32_16x16x32_bf16 v[104:107], a[104:107], a[0:3], v[104:107]
    v_mfma_f32_16x16x32_bf16 v[108:111], a[108:111], a[0:3], v[108:111]
    ds_read_b128 a[0:3], v153 offset:24576
    v_mfma_f32_16x16x32_bf16 v[112:115], a[96:99], a[4:7], v[112:115]
    s_waitcnt vmcnt(17)
    ds_read_b64_tr_b16 a[112:113], v154 offset:4096
    v_mfma_f32_16x16x32_bf16 v[116:119], a[100:103], a[4:7], v[116:119]
    ds_read_b64_tr_b16 a[114:115], v154 offset:4608
    ds_read_b64_tr_b16 a[116:117], v155 offset:4096
    v_mfma_f32_16x16x32_bf16 v[120:123], a[104:107], a[4:7], v[120:123]
    s_add_u32 m0, s29, 8192
    s_mov_b32 s32, 256
    buffer_load_dwordx4 v10, s[8:11], s32 offen nt lds
    v_mfma_f32_16x16x32_bf16 v[124:127], a[108:111], a[4:7], v[124:127]
    ds_read_b128 a[4:7], v153 offset:26624
    v_mfma_f32_16x16x32_bf16 v[128:131], a[96:99], a[8:11], v[128:131]
    ds_read_b64_tr_b16 a[118:119], v155 offset:4608
    ds_read_b64_tr_b16 a[120:121], v156 offset:4096
    v_mfma_f32_16x16x32_bf16 v[132:135], a[100:103], a[8:11], v[132:135]
    buffer_load_dwordx4 v11, s[8:11], s32 offen offset:1024 nt lds
    v_mfma_f32_16x16x32_bf16 v[136:139], a[104:107], a[8:11], v[136:139]
    ds_read_b64_tr_b16 a[122:123], v156 offset:4608
    v_mfma_f32_16x16x32_bf16 v[140:143], a[108:111], a[8:11], v[140:143]
    ds_read_b64_tr_b16 a[124:125], v157 offset:4096
    ds_read_b128 a[8:11], v153 offset:28672
    v_mfma_f32_16x16x32_bf16 v[144:147], a[96:99], a[12:15], v[144:147]
    buffer_load_dwordx4 v12, s[8:11], s32 offen offset:2048 nt lds
    v_mfma_f32_16x16x32_bf16 v[148:151], a[100:103], a[12:15], v[148:151]
    ds_read_b64_tr_b16 a[126:127], v157 offset:4608
    v_mfma_f32_16x16x32_bf16 v[176:179], a[104:107], a[12:15], v[176:179]
    v_mfma_f32_16x16x32_bf16 v[180:183], a[108:111], a[12:15], v[180:183]
    buffer_load_dwordx4 v13, s[8:11], s32 offen offset:3072 nt lds
    ds_read_b128 a[12:15], v153 offset:30720
    s_waitcnt lgkmcnt(12)
    v_mfma_f32_16x16x32_bf16 v[184:187], a[96:99], a[16:19], v[184:187]
    v_mfma_f32_16x16x32_bf16 v[188:191], a[100:103], a[16:19], v[188:191]
    v_mfma_f32_16x16x32_bf16 v[192:195], a[104:107], a[16:19], v[192:195]
    v_mfma_f32_16x16x32_bf16 v[196:199], a[108:111], a[16:19], v[196:199]
    ds_read_b128 a[16:19], v153 offset:32768
    v_mfma_f32_16x16x32_bf16 v[200:203], a[96:99], a[20:23], v[200:203]
    v_mfma_f32_16x16x32_bf16 v[204:207], a[100:103], a[20:23], v[204:207]
    v_mfma_f32_16x16x32_bf16 v[208:211], a[104:107], a[20:23], v[208:211]
    v_mfma_f32_16x16x32_bf16 v[212:215], a[108:111], a[20:23], v[212:215]
    ds_read_b128 a[20:23], v153 offset:34816
    s_waitcnt lgkmcnt(11)
    v_mfma_f32_16x16x32_bf16 v[32:35], a[112:115], a[24:27], v[32:35]
    s_waitcnt lgkmcnt(8)
    v_mfma_f32_16x16x32_bf16 v[36:39], a[116:119], a[24:27], v[36:39]
    s_waitcnt lgkmcnt(6)
    v_mfma_f32_16x16x32_bf16 v[40:43], a[120:123], a[24:27], v[40:43]
    s_waitcnt lgkmcnt(3)
    v_mfma_f32_16x16x32_bf16 v[44:47], a[124:127], a[24:27], v[44:47]
    s_add_u32 m0, s30, 4096
    s_add_u32 s33, s76, 0
    buffer_load_dwordx4 v163, s[16:19], s33 offen lds
    ds_read_b128 a[24:27], v153 offset:36864
    v_mfma_f32_16x16x32_bf16 v[48:51], a[112:115], a[28:31], v[48:51]
    v_mfma_f32_16x16x32_bf16 v[52:55], a[116:119], a[28:31], v[52:55]
    v_mfma_f32_16x16x32_bf16 v[56:59], a[120:123], a[28:31], v[56:59]
    buffer_load_dwordx4 v164, s[16:19], s33 offen offset:1024 lds
    v_mfma_f32_16x16x32_bf16 v[60:63], a[124:127], a[28:31], v[60:63]
    ds_read_b128 a[28:31], v153 offset:38912
    s_waitcnt lgkmcnt(4)
    v_mfma_f32_16x16x32_bf16 v[64:67], a[112:115], a[0:3], v[64:67]
    v_mfma_f32_16x16x32_bf16 v[68:71], a[116:119], a[0:3], v[68:71]
    buffer_load_dwordx4 v165, s[16:19], s33 offen offset:2048 lds
    v_mfma_f32_16x16x32_bf16 v[72:75], a[120:123], a[0:3], v[72:75]
    v_mfma_f32_16x16x32_bf16 v[76:79], a[124:127], a[0:3], v[76:79]
    s_waitcnt vmcnt(11)
    s_waitcnt lgkmcnt(0)
    s_barrier
    ds_read_b128 a[0:3], v152
    v_mfma_f32_16x16x32_bf16 v[80:83], a[112:115], a[4:7], v[80:83]
    buffer_load_dwordx4 v166, s[16:19], s33 offen offset:3072 lds
    v_mfma_f32_16x16x32_bf16 v[84:87], a[116:119], a[4:7], v[84:87]
    v_mfma_f32_16x16x32_bf16 v[88:91], a[120:123], a[4:7], v[88:91]
    v_mfma_f32_16x16x32_bf16 v[92:95], a[124:127], a[4:7], v[92:95]
    ds_read_b128 a[4:7], v152 offset:2048
    v_mfma_f32_16x16x32_bf16 v[96:99], a[112:115], a[8:11], v[96:99]
    v_mfma_f32_16x16x32_bf16 v[100:103], a[116:119], a[8:11], v[100:103]
    v_mfma_f32_16x16x32_bf16 v[104:107], a[120:123], a[8:11], v[104:107]
    v_mfma_f32_16x16x32_bf16 v[108:111], a[124:127], a[8:11], v[108:111]
    s_add_u32 m0, s31, 20480
    s_add_u32 s32, s69, 0
    buffer_load_dwordx4 v158, s[4:7], s32 offen lds
    ds_read_b128 a[8:11], v152 offset:4096
    v_mfma_f32_16x16x32_bf16 v[112:115], a[112:115], a[12:15], v[112:115]
    v_mfma_f32_16x16x32_bf16 v[116:119], a[116:119], a[12:15], v[116:119]
    ds_read_b64_tr_b16 a[96:97], v154 offset:8192
    ds_read_b64_tr_b16 a[98:99], v154 offset:8704
    v_mfma_f32_16x16x32_bf16 v[120:123], a[120:123], a[12:15], v[120:123]
    buffer_load_dwordx4 v159, s[4:7], s32 offen offset:1024 lds
    v_mfma_f32_16x16x32_bf16 v[124:127], a[124:127], a[12:15], v[124:127]
    ds_read_b128 a[12:15], v152 offset:6144
    v_mfma_f32_16x16x32_bf16 v[128:131], a[112:115], a[16:19], v[128:131]
    ds_read_b64_tr_b16 a[100:101], v155 offset:8192
    v_mfma_f32_16x16x32_bf16 v[132:135], a[116:119], a[16:19], v[132:135]
    buffer_load_dwordx4 v160, s[4:7], s32 offen offset:2048 lds
    v_mfma_f32_16x16x32_bf16 v[136:139], a[120:123], a[16:19], v[136:139]
    ds_read_b64_tr_b16 a[102:103], v155 offset:8704
    v_mfma_f32_16x16x32_bf16 v[140:143], a[124:127], a[16:19], v[140:143]
    ds_read_b64_tr_b16 a[104:105], v156 offset:8192
    ds_read_b128 a[16:19], v152 offset:8192
    v_mfma_f32_16x16x32_bf16 v[144:147], a[112:115], a[20:23], v[144:147]
    buffer_load_dwordx4 v161, s[4:7], s32 offen offset:3072 lds
    v_mfma_f32_16x16x32_bf16 v[148:151], a[116:119], a[20:23], v[148:151]
    ds_read_b64_tr_b16 a[106:107], v156 offset:8704
    v_mfma_f32_16x16x32_bf16 v[176:179], a[120:123], a[20:23], v[176:179]
    ds_read_b64_tr_b16 a[108:109], v157 offset:8192
    ds_read_b64_tr_b16 a[110:111], v157 offset:8704
    v_mfma_f32_16x16x32_bf16 v[180:183], a[124:127], a[20:23], v[180:183]
    s_add_u32 m0, s31, 24576
    s_nop 0
    buffer_load_dwordx4 v162, s[4:7], s32 offen lds
    ds_read_b128 a[20:23], v152 offset:10240
    v_mfma_f32_16x16x32_bf16 v[184:187], a[112:115], a[24:27], v[184:187]
    v_mfma_f32_16x16x32_bf16 v[188:191], a[116:119], a[24:27], v[188:191]
    v_mfma_f32_16x16x32_bf16 v[192:195], a[120:123], a[24:27], v[192:195]
    v_mfma_f32_16x16x32_bf16 v[196:199], a[124:127], a[24:27], v[196:199]
    ds_read_b128 a[24:27], v152 offset:12288
    v_mfma_f32_16x16x32_bf16 v[200:203], a[112:115], a[28:31], v[200:203]
    v_mfma_f32_16x16x32_bf16 v[204:207], a[116:119], a[28:31], v[204:207]
    v_mfma_f32_16x16x32_bf16 v[208:211], a[120:123], a[28:31], v[208:211]
    v_mfma_f32_16x16x32_bf16 v[212:215], a[124:127], a[28:31], v[212:215]
    ds_read_b128 a[28:31], v152 offset:14336
    s_waitcnt lgkmcnt(10)
    v_mfma_f32_16x16x32_bf16 v[32:35], a[96:99], a[0:3], v[32:35]
    s_waitcnt lgkmcnt(8)
    v_mfma_f32_16x16x32_bf16 v[36:39], a[100:103], a[0:3], v[36:39]
    s_waitcnt lgkmcnt(5)
    v_mfma_f32_16x16x32_bf16 v[40:43], a[104:107], a[0:3], v[40:43]
    ds_read_b128 a[32:35], v4
    s_waitcnt lgkmcnt(4)
    v_mfma_f32_16x16x32_bf16 v[44:47], a[108:111], a[0:3], v[44:47]
    s_add_u32 m0, s30, 8192
    s_add_u32 s33, s76, 262144
    buffer_load_dwordx4 v163, s[16:19], s33 offen lds
    ds_read_b128 a[0:3], v152 offset:16384
    v_mfma_f32_16x16x32_bf16 v[48:51], a[96:99], a[4:7], v[48:51]
    ds_read_b128 a[36:39], v4 offset:2048
    v_mfma_f32_16x16x32_bf16 v[52:55], a[100:103], a[4:7], v[52:55]
    ds_read_b128 a[40:43], v5
    ds_read_b128 a[44:47], v5 offset:2048
    v_mfma_f32_16x16x32_bf16 v[56:59], a[104:107], a[4:7], v[56:59]
    buffer_load_dwordx4 v164, s[16:19], s33 offen offset:1024 lds
    v_mfma_f32_16x16x32_bf16 v[60:63], a[108:111], a[4:7], v[60:63]
    ds_read_b128 a[4:7], v152 offset:18432
    v_mfma_f32_16x16x32_bf16 v[64:67], a[96:99], a[8:11], v[64:67]
    v_mfma_f32_16x16x32_bf16 v[68:71], a[100:103], a[8:11], v[68:71]
    buffer_load_dwordx4 v165, s[16:19], s33 offen offset:2048 lds
    v_mfma_f32_16x16x32_bf16 v[72:75], a[104:107], a[8:11], v[72:75]
    v_mfma_f32_16x16x32_bf16 v[76:79], a[108:111], a[8:11], v[76:79]
    ds_read_b128 a[8:11], v153
    v_mfma_f32_16x16x32_bf16 v[80:83], a[96:99], a[12:15], v[80:83]
    buffer_load_dwordx4 v166, s[16:19], s33 offen offset:3072 lds
    v_mfma_f32_16x16x32_bf16 v[84:87], a[100:103], a[12:15], v[84:87]
    v_mfma_f32_16x16x32_bf16 v[88:91], a[104:107], a[12:15], v[88:91]
    v_mfma_f32_16x16x32_bf16 v[92:95], a[108:111], a[12:15], v[92:95]
    ds_read_b128 a[12:15], v153 offset:2048
    s_waitcnt lgkmcnt(8)
    v_mfma_f32_16x16x32_bf16 v[96:99], a[96:99], a[16:19], v[96:99]
    v_mfma_f32_16x16x32_bf16 v[100:103], a[100:103], a[16:19], v[100:103]
    v_mfma_f32_16x16x32_bf16 v[104:107], a[104:107], a[16:19], v[104:107]
    v_mfma_f32_16x16x32_bf16 v[108:111], a[108:111], a[16:19], v[108:111]
    ds_read_b128 a[16:19], v153 offset:4096
    v_mfma_f32_16x16x32_bf16 v[112:115], a[96:99], a[20:23], v[112:115]
    s_waitcnt vmcnt(17)
    ds_read_b64_tr_b16 a[112:113], v154
    ds_read_b64_tr_b16 a[114:115], v154 offset:512
    v_mfma_f32_16x16x32_bf16 v[116:119], a[100:103], a[20:23], v[116:119]
    ds_read_b64_tr_b16 a[116:117], v155
    ds_read_b64_tr_b16 a[118:119], v155 offset:512
    ds_read_b64_tr_b16 a[120:121], v156
    v_mfma_f32_16x16x32_bf16 v[120:123], a[104:107], a[20:23], v[120:123]
    s_add_u32 m0, s29, 12288
    s_mov_b32 s32, 384
    buffer_load_dwordx4 v10, s[8:11], s32 offen nt lds
    s_waitcnt lgkmcnt(8)
    s_add_u32 m0, s29, 0
    s_mov_b32 s32, 65536
    buffer_load_dwordx4 v10, s[8:11], s32 offen nt lds
    v_mfma_f32_16x16x32_bf16 v[124:127], a[108:111], a[20:23], v[124:127]
    ds_read_b128 a[20:23], v153 offset:6144
    v_mfma_f32_16x16x32_bf16 v[128:131], a[96:99], a[24:27], v[128:131]
    ds_read_b64_tr_b16 a[122:123], v156 offset:512
    ds_read_b64_tr_b16 a[124:125], v157
    v_mfma_f32_16x16x32_bf16 v[132:135], a[100:103], a[24:27], v[132:135]
    s_add_u32 m0, s29, 12288
    s_mov_b32 s32, 384
    buffer_load_dwordx4 v11, s[8:11], s32 offen offset:1024 nt lds
    s_add_u32 m0, s29, 0
    s_mov_b32 s32, 65536
    buffer_load_dwordx4 v11, s[8:11], s32 offen offset:1024 nt lds
    v_mfma_f32_16x16x32_bf16 v[136:139], a[104:107], a[24:27], v[136:139]
    ds_read_b64_tr_b16 a[126:127], v157 offset:512
    v_mfma_f32_16x16x32_bf16 v[140:143], a[108:111], a[24:27], v[140:143]
    ds_read_b128 a[24:27], v153 offset:8192
    v_mfma_f32_16x16x32_bf16 v[144:147], a[96:99], a[28:31], v[144:147]
    s_add_u32 m0, s29, 12288
    s_mov_b32 s32, 384
    buffer_load_dwordx4 v12, s[8:11], s32 offen offset:2048 nt lds
    s_add_u32 m0, s29, 0
    s_mov_b32 s32, 65536
    buffer_load_dwordx4 v12, s[8:11], s32 offen offset:2048 nt lds
    v_mfma_f32_16x16x32_bf16 v[148:151], a[100:103], a[28:31], v[148:151]
    v_mfma_f32_16x16x32_bf16 v[176:179], a[104:107], a[28:31], v[176:179]
    v_mfma_f32_16x16x32_bf16 v[180:183], a[108:111], a[28:31], v[180:183]
    s_add_u32 m0, s29, 12288
    s_mov_b32 s32, 384
    buffer_load_dwordx4 v13, s[8:11], s32 offen offset:3072 nt lds
    s_add_u32 m0, s29, 0
    s_mov_b32 s32, 65536
    buffer_load_dwordx4 v13, s[8:11], s32 offen offset:3072 nt lds
    ds_read_b128 a[28:31], v153 offset:10240
    s_waitcnt lgkmcnt(12)
    v_mfma_f32_16x16x32_bf16 v[184:187], a[96:99], a[0:3], v[184:187]
    v_mfma_f32_16x16x32_bf16 v[188:191], a[100:103], a[0:3], v[188:191]
    v_mfma_f32_16x16x32_bf16 v[192:195], a[104:107], a[0:3], v[192:195]
    v_mfma_f32_16x16x32_bf16 v[196:199], a[108:111], a[0:3], v[196:199]
    ds_read_b128 a[0:3], v153 offset:12288
    v_mfma_f32_16x16x32_bf16 v[200:203], a[96:99], a[4:7], v[200:203]
    v_mfma_f32_16x16x32_bf16 v[204:207], a[100:103], a[4:7], v[204:207]
    v_mfma_f32_16x16x32_bf16 v[208:211], a[104:107], a[4:7], v[208:211]
    v_mfma_f32_16x16x32_bf16 v[212:215], a[108:111], a[4:7], v[212:215]
    ds_read_b128 a[4:7], v153 offset:14336
    s_waitcnt lgkmcnt(11)
    v_mfma_f32_16x16x32_bf16 v[32:35], a[112:115], a[8:11], v[32:35]
    s_waitcnt lgkmcnt(9)
    v_mfma_f32_16x16x32_bf16 v[36:39], a[116:119], a[8:11], v[36:39]
    s_waitcnt lgkmcnt(6)
    v_mfma_f32_16x16x32_bf16 v[40:43], a[120:123], a[8:11], v[40:43]
    s_waitcnt lgkmcnt(4)
    v_mfma_f32_16x16x32_bf16 v[44:47], a[124:127], a[8:11], v[44:47]
    s_add_u32 m0, s30, 0
    s_add_u32 s33, s77, 0
    buffer_load_dwordx4 v163, s[16:19], s33 offen lds
    ds_read_b128 a[8:11], v153 offset:16384
    v_mfma_f32_16x16x32_bf16 v[48:51], a[112:115], a[12:15], v[48:51]
    v_mfma_f32_16x16x32_bf16 v[52:55], a[116:119], a[12:15], v[52:55]
    v_mfma_f32_16x16x32_bf16 v[56:59], a[120:123], a[12:15], v[56:59]
    buffer_load_dwordx4 v164, s[16:19], s33 offen offset:1024 lds
    v_mfma_f32_16x16x32_bf16 v[60:63], a[124:127], a[12:15], v[60:63]
    ds_read_b128 a[12:15], v153 offset:18432
    s_waitcnt lgkmcnt(4)
    v_mfma_f32_16x16x32_bf16 v[64:67], a[112:115], a[16:19], v[64:67]
    v_mfma_f32_16x16x32_bf16 v[68:71], a[116:119], a[16:19], v[68:71]
    buffer_load_dwordx4 v165, s[16:19], s33 offen offset:2048 lds
    v_mfma_f32_16x16x32_bf16 v[72:75], a[120:123], a[16:19], v[72:75]
    v_mfma_f32_16x16x32_bf16 v[76:79], a[124:127], a[16:19], v[76:79]
    s_waitcnt vmcnt(15)
    s_waitcnt lgkmcnt(0)
    s_barrier
    ds_read_b128 a[16:19], v152 offset:20480
    v_mfma_f32_16x16x32_bf16 v[80:83], a[112:115], a[20:23], v[80:83]
    buffer_load_dwordx4 v166, s[16:19], s33 offen offset:3072 lds
    v_mfma_f32_16x16x32_bf16 v[84:87], a[116:119], a[20:23], v[84:87]
    v_mfma_f32_16x16x32_bf16 v[88:91], a[120:123], a[20:23], v[88:91]
    v_mfma_f32_16x16x32_bf16 v[92:95], a[124:127], a[20:23], v[92:95]
    ds_read_b128 a[20:23], v152 offset:22528
    v_mfma_f32_16x16x32_bf16 v[96:99], a[112:115], a[24:27], v[96:99]
    v_mfma_f32_16x16x32_bf16 v[100:103], a[116:119], a[24:27], v[100:103]
    v_mfma_f32_16x16x32_bf16 v[104:107], a[120:123], a[24:27], v[104:107]
    v_mfma_f32_16x16x32_bf16 v[108:111], a[124:127], a[24:27], v[108:111]
    s_add_u32 m0, s31, 0
    s_add_u32 s32, s70, 0
    buffer_load_dwordx4 v158, s[4:7], s32 offen lds
    ds_read_b128 a[24:27], v152 offset:24576
    v_mfma_f32_16x16x32_bf16 v[112:115], a[112:115], a[28:31], v[112:115]
    v_mfma_f32_16x16x32_bf16 v[116:119], a[116:119], a[28:31], v[116:119]
    ds_read_b64_tr_b16 a[96:97], v154 offset:4096
    ds_read_b64_tr_b16 a[98:99], v154 offset:4608
    v_mfma_f32_16x16x32_bf16 v[120:123], a[120:123], a[28:31], v[120:123]
    buffer_load_dwordx4 v159, s[4:7], s32 offen offset:1024 lds
    v_mfma_f32_16x16x32_bf16 v[124:127], a[124:127], a[28:31], v[124:127]
    ds_read_b128 a[28:31], v152 offset:26624
    v_mfma_f32_16x16x32_bf16 v[128:131], a[112:115], a[0:3], v[128:131]
    ds_read_b64_tr_b16 a[100:101], v155 offset:4096
    v_mfma_f32_16x16x32_bf16 v[132:135], a[116:119], a[0:3], v[132:135]
    buffer_load_dwordx4 v160, s[4:7], s32 offen offset:2048 lds
    v_mfma_f32_16x16x32_bf16 v[136:139], a[120:123], a[0:3], v[136:139]
    ds_read_b64_tr_b16 a[102:103], v155 offset:4608
    v_mfma_f32_16x16x32_bf16 v[140:143], a[124:127], a[0:3], v[140:143]
    ds_read_b64_tr_b16 a[104:105], v156 offset:4096
    ds_read_b128 a[0:3], v152 offset:28672
    v_mfma_f32_16x16x32_bf16 v[144:147], a[112:115], a[4:7], v[144:147]
    buffer_load_dwordx4 v161, s[4:7], s32 offen offset:3072 lds
    v_mfma_f32_16x16x32_bf16 v[148:151], a[116:119], a[4:7], v[148:151]
    ds_read_b64_tr_b16 a[106:107], v156 offset:4608
    v_mfma_f32_16x16x32_bf16 v[176:179], a[120:123], a[4:7], v[176:179]
    ds_read_b64_tr_b16 a[108:109], v157 offset:4096
    ds_read_b64_tr_b16 a[110:111], v157 offset:4608
    v_mfma_f32_16x16x32_bf16 v[180:183], a[124:127], a[4:7], v[180:183]
    s_add_u32 m0, s31, 4096
    s_nop 0
    buffer_load_dwordx4 v162, s[4:7], s32 offen lds
    ds_read_b128 a[4:7], v152 offset:30720
    v_mfma_f32_16x16x32_bf16 v[184:187], a[112:115], a[8:11], v[184:187]
    v_mfma_f32_16x16x32_bf16 v[188:191], a[116:119], a[8:11], v[188:191]
    v_mfma_f32_16x16x32_bf16 v[192:195], a[120:123], a[8:11], v[192:195]
    v_mfma_f32_16x16x32_bf16 v[196:199], a[124:127], a[8:11], v[196:199]
    ds_read_b128 a[8:11], v152 offset:32768
    v_mfma_f32_16x16x32_bf16 v[200:203], a[112:115], a[12:15], v[200:203]
    v_mfma_f32_16x16x32_bf16 v[204:207], a[116:119], a[12:15], v[204:207]
    v_mfma_f32_16x16x32_bf16 v[208:211], a[120:123], a[12:15], v[208:211]
    v_mfma_f32_16x16x32_bf16 v[212:215], a[124:127], a[12:15], v[212:215]
    ds_read_b128 a[12:15], v152 offset:34816
    s_waitcnt lgkmcnt(10)
    v_mfma_f32_16x16x32_bf16 v[32:35], a[96:99], a[16:19], v[32:35]
    s_waitcnt lgkmcnt(8)
    v_mfma_f32_16x16x32_bf16 v[36:39], a[100:103], a[16:19], v[36:39]
    s_waitcnt lgkmcnt(5)
    v_mfma_f32_16x16x32_bf16 v[40:43], a[104:107], a[16:19], v[40:43]
    ds_read_b128 a[48:51], v4 offset:4096
    ds_read_b128 a[52:55], v4 offset:6144
    s_waitcnt lgkmcnt(5)
    v_mfma_f32_16x16x32_bf16 v[44:47], a[108:111], a[16:19], v[44:47]
    s_add_u32 m0, s30, 4096
    s_add_u32 s33, s77, 262144
    buffer_load_dwordx4 v163, s[16:19], s33 offen lds
    ds_read_b128 a[16:19], v152 offset:36864
    v_mfma_f32_16x16x32_bf16 v[48:51], a[96:99], a[20:23], v[48:51]
    ds_read_b128 a[56:59], v5 offset:4096
    v_mfma_f32_16x16x32_bf16 v[52:55], a[100:103], a[20:23], v[52:55]
    ds_read_b128 a[60:63], v5 offset:6144
    v_mfma_f32_16x16x32_bf16 v[56:59], a[104:107], a[20:23], v[56:59]
    buffer_load_dwordx4 v164, s[16:19], s33 offen offset:1024 lds
    v_mfma_f32_16x16x32_bf16 v[60:63], a[108:111], a[20:23], v[60:63]
    ds_read_b128 a[20:23], v152 offset:38912
    v_mfma_f32_16x16x32_bf16 v[64:67], a[96:99], a[24:27], v[64:67]
    v_mfma_f32_16x16x32_bf16 v[68:71], a[100:103], a[24:27], v[68:71]
    buffer_load_dwordx4 v165, s[16:19], s33 offen offset:2048 lds
    v_mfma_f32_16x16x32_bf16 v[72:75], a[104:107], a[24:27], v[72:75]
    v_mfma_f32_16x16x32_bf16 v[76:79], a[108:111], a[24:27], v[76:79]
    ds_read_b128 a[24:27], v153 offset:20480
    v_mfma_f32_16x16x32_bf16 v[80:83], a[96:99], a[28:31], v[80:83]
    buffer_load_dwordx4 v166, s[16:19], s33 offen offset:3072 lds
    v_mfma_f32_16x16x32_bf16 v[84:87], a[100:103], a[28:31], v[84:87]
    v_mfma_f32_16x16x32_bf16 v[88:91], a[104:107], a[28:31], v[88:91]
    v_mfma_f32_16x16x32_bf16 v[92:95], a[108:111], a[28:31], v[92:95]
    ds_read_b128 a[28:31], v153 offset:22528
    s_waitcnt lgkmcnt(8)
    v_mfma_f32_16x16x32_bf16 v[96:99], a[96:99], a[0:3], v[96:99]
    v_mfma_f32_16x16x32_bf16 v[100:103], a[100:103], a[0:3], v[100:103]
    v_mfma_f32_16x16x32_bf16 v[104:107], a[104:107], a[0:3], v[104:107]
    v_mfma_f32_16x16x32_bf16 v[108:111], a[108:111], a[0:3], v[108:111]
    ds_read_b128 a[0:3], v153 offset:24576
    v_mfma_f32_16x16x32_bf16 v[112:115], a[96:99], a[4:7], v[112:115]
    s_waitcnt vmcnt(21)
    ds_read_b64_tr_b16 a[112:113], v154 offset:8192
    ds_read_b64_tr_b16 a[114:115], v154 offset:8704
    v_mfma_f32_16x16x32_bf16 v[116:119], a[100:103], a[4:7], v[116:119]
    ds_read_b64_tr_b16 a[116:117], v155 offset:8192
    ds_read_b64_tr_b16 a[118:119], v155 offset:8704
    v_mfma_f32_16x16x32_bf16 v[120:123], a[104:107], a[4:7], v[120:123]
    s_waitcnt lgkmcnt(8)
    s_add_u32 m0, s29, 4096
    s_mov_b32 s32, 65664
    buffer_load_dwordx4 v10, s[8:11], s32 offen nt lds
    v_mfma_f32_16x16x32_bf16 v[124:127], a[108:111], a[4:7], v[124:127]
    ds_read_b128 a[4:7], v153 offset:26624
    v_mfma_f32_16x16x32_bf16 v[128:131], a[96:99], a[8:11], v[128:131]
    ds_read_b64_tr_b16 a[120:121], v156 offset:8192
    ds_read_b64_tr_b16 a[122:123], v156 offset:8704
    v_mfma_f32_16x16x32_bf16 v[132:135], a[100:103], a[8:11], v[132:135]
    buffer_load_dwordx4 v11, s[8:11], s32 offen offset:1024 nt lds
    v_mfma_f32_16x16x32_bf16 v[136:139], a[104:107], a[8:11], v[136:139]
    ds_read_b64_tr_b16 a[124:125], v157 offset:8192
    v_mfma_f32_16x16x32_bf16 v[140:143], a[108:111], a[8:11], v[140:143]
    ds_read_b64_tr_b16 a[126:127], v157 offset:8704
    ds_read_b128 a[8:11], v153 offset:28672
    v_mfma_f32_16x16x32_bf16 v[144:147], a[96:99], a[12:15], v[144:147]
    buffer_load_dwordx4 v12, s[8:11], s32 offen offset:2048 nt lds
    v_mfma_f32_16x16x32_bf16 v[148:151], a[100:103], a[12:15], v[148:151]
    v_mfma_f32_16x16x32_bf16 v[176:179], a[104:107], a[12:15], v[176:179]
    v_mfma_f32_16x16x32_bf16 v[180:183], a[108:111], a[12:15], v[180:183]
    buffer_load_dwordx4 v13, s[8:11], s32 offen offset:3072 nt lds
    ds_read_b128 a[12:15], v153 offset:30720
    s_waitcnt lgkmcnt(12)
    v_mfma_f32_16x16x32_bf16 v[184:187], a[96:99], a[16:19], v[184:187]
    v_mfma_f32_16x16x32_bf16 v[188:191], a[100:103], a[16:19], v[188:191]
    v_mfma_f32_16x16x32_bf16 v[192:195], a[104:107], a[16:19], v[192:195]
    v_mfma_f32_16x16x32_bf16 v[196:199], a[108:111], a[16:19], v[196:199]
    ds_read_b128 a[16:19], v153 offset:32768
    v_mfma_f32_16x16x32_bf16 v[200:203], a[96:99], a[20:23], v[200:203]
    v_mfma_f32_16x16x32_bf16 v[204:207], a[100:103], a[20:23], v[204:207]
    v_mfma_f32_16x16x32_bf16 v[208:211], a[104:107], a[20:23], v[208:211]
    v_mfma_f32_16x16x32_bf16 v[212:215], a[108:111], a[20:23], v[212:215]
    ds_read_b128 a[20:23], v153 offset:34816
    s_waitcnt lgkmcnt(11)
    v_mfma_f32_16x16x32_bf16 v[32:35], a[112:115], a[24:27], v[32:35]
    s_waitcnt lgkmcnt(9)
    v_mfma_f32_16x16x32_bf16 v[36:39], a[116:119], a[24:27], v[36:39]
    ds_read_b128 a[64:67], v4 offset:8192
    ds_read_b128 a[68:71], v4 offset:10240
    s_waitcnt lgkmcnt(8)
    v_mfma_f32_16x16x32_bf16 v[40:43], a[120:123], a[24:27], v[40:43]
    ds_read_b128 a[72:75], v5 offset:8192
    ds_read_b128 a[76:79], v5 offset:10240
    s_waitcnt lgkmcnt(8)
    v_mfma_f32_16x16x32_bf16 v[44:47], a[124:127], a[24:27], v[44:47]
    ds_read_b128 a[24:27], v153 offset:36864
    v_mfma_f32_16x16x32_bf16 v[48:51], a[112:115], a[28:31], v[48:51]
    v_mfma_f32_16x16x32_bf16 v[52:55], a[116:119], a[28:31], v[52:55]
    v_mfma_f32_16x16x32_bf16 v[56:59], a[120:123], a[28:31], v[56:59]
    v_mfma_f32_16x16x32_bf16 v[60:63], a[124:127], a[28:31], v[60:63]
    ds_read_b128 a[28:31], v153 offset:38912
    s_waitcnt lgkmcnt(8)
    v_mfma_f32_16x16x32_bf16 v[64:67], a[112:115], a[0:3], v[64:67]
    s_waitcnt lgkmcnt(2)
    s_add_u32 m0, s29, 8192
    s_mov_b32 s32, 65792
    buffer_load_dwordx4 v10, s[8:11], s32 offen nt lds
    v_mfma_f32_16x16x32_bf16 v[68:71], a[116:119], a[0:3], v[68:71]
    v_mfma_f32_16x16x32_bf16 v[72:75], a[120:123], a[0:3], v[72:75]
    v_mfma_f32_16x16x32_bf16 v[76:79], a[124:127], a[0:3], v[76:79]
    buffer_load_dwordx4 v11, s[8:11], s32 offen offset:1024 nt lds
    s_waitcnt vmcnt(10)
    s_waitcnt lgkmcnt(0)
    s_barrier
    ds_read_b128 a[0:3], v152
    v_mfma_f32_16x16x32_bf16 v[80:83], a[112:115], a[4:7], v[80:83]
    v_mfma_f32_16x16x32_bf16 v[84:87], a[116:119], a[4:7], v[84:87]
    v_mfma_f32_16x16x32_bf16 v[88:91], a[120:123], a[4:7], v[88:91]
    buffer_load_dwordx4 v12, s[8:11], s32 offen offset:2048 nt lds
    v_mfma_f32_16x16x32_bf16 v[92:95], a[124:127], a[4:7], v[92:95]
    ds_read_b128 a[4:7], v152 offset:2048
    v_mfma_f32_16x16x32_bf16 v[96:99], a[112:115], a[8:11], v[96:99]
    v_mfma_f32_16x16x32_bf16 v[100:103], a[116:119], a[8:11], v[100:103]
    buffer_load_dwordx4 v13, s[8:11], s32 offen offset:3072 nt lds
    v_mfma_f32_16x16x32_bf16 v[104:107], a[120:123], a[8:11], v[104:107]
    v_mfma_f32_16x16x32_bf16 v[108:111], a[124:127], a[8:11], v[108:111]
    ds_read_b128 a[8:11], v152 offset:4096
    v_mfma_f32_16x16x32_bf16 v[112:115], a[112:115], a[12:15], v[112:115]
    ds_read_b64_tr_b16 a[96:97], v154
    ds_read_b64_tr_b16 a[98:99], v154 offset:512
    v_mfma_f32_16x16x32_bf16 v[116:119], a[116:119], a[12:15], v[116:119]
    ds_read_b128 a[80:83], v4 offset:12288
    ds_read_b128 a[84:87], v4 offset:14336
    v_mfma_f32_16x16x32_bf16 v[120:123], a[120:123], a[12:15], v[120:123]
    ds_read_b128 a[88:91], v5 offset:12288
    ds_read_b128 a[92:95], v5 offset:14336
    v_mfma_f32_16x16x32_bf16 v[124:127], a[124:127], a[12:15], v[124:127]
    ds_read_b128 a[12:15], v152 offset:6144
    v_mfma_f32_16x16x32_bf16 v[128:131], a[112:115], a[16:19], v[128:131]
    ds_read_b64_tr_b16 a[100:101], v155
    ds_read_b64_tr_b16 a[102:103], v155 offset:512
    ds_read_b64_tr_b16 a[104:105], v156
    v_mfma_f32_16x16x32_bf16 v[132:135], a[116:119], a[16:19], v[132:135]
    ds_read_b64_tr_b16 a[106:107], v156 offset:512
    ds_read_b64_tr_b16 a[108:109], v157
    v_mfma_f32_16x16x32_bf16 v[136:139], a[120:123], a[16:19], v[136:139]
    ds_read_b64_tr_b16 a[110:111], v157 offset:512
    v_mfma_f32_16x16x32_bf16 v[140:143], a[124:127], a[16:19], v[140:143]
    ds_read_b128 a[16:19], v152 offset:8192
    v_mfma_f32_16x16x32_bf16 v[144:147], a[112:115], a[20:23], v[144:147]
    s_waitcnt lgkmcnt(8)
    s_add_u32 m0, s29, 12288
    s_mov_b32 s32, 65920
    buffer_load_dwordx4 v10, s[8:11], s32 offen nt lds
    v_mfma_f32_16x16x32_bf16 v[148:151], a[116:119], a[20:23], v[148:151]
    v_mfma_f32_16x16x32_bf16 v[176:179], a[120:123], a[20:23], v[176:179]
    v_mfma_f32_16x16x32_bf16 v[180:183], a[124:127], a[20:23], v[180:183]
    buffer_load_dwordx4 v11, s[8:11], s32 offen offset:1024 nt lds
    ds_read_b128 a[20:23], v152 offset:10240
    v_mfma_f32_16x16x32_bf16 v[184:187], a[112:115], a[24:27], v[184:187]
    v_mfma_f32_16x16x32_bf16 v[188:191], a[116:119], a[24:27], v[188:191]
    v_mfma_f32_16x16x32_bf16 v[192:195], a[120:123], a[24:27], v[192:195]
    buffer_load_dwordx4 v12, s[8:11], s32 offen offset:2048 nt lds
    v_mfma_f32_16x16x32_bf16 v[196:199], a[124:127], a[24:27], v[196:199]
    ds_read_b128 a[24:27], v152 offset:12288
    v_mfma_f32_16x16x32_bf16 v[200:203], a[112:115], a[28:31], v[200:203]
    v_mfma_f32_16x16x32_bf16 v[204:207], a[116:119], a[28:31], v[204:207]
    buffer_load_dwordx4 v13, s[8:11], s32 offen offset:3072 nt lds
    v_mfma_f32_16x16x32_bf16 v[208:211], a[120:123], a[28:31], v[208:211]
    v_mfma_f32_16x16x32_bf16 v[212:215], a[124:127], a[28:31], v[212:215]
    ds_read_b128 a[28:31], v152 offset:14336
    s_waitcnt lgkmcnt(10)
    v_mfma_f32_16x16x32_bf16 v[32:35], a[96:99], a[0:3], v[32:35]
    s_waitcnt lgkmcnt(8)
    v_mfma_f32_16x16x32_bf16 v[36:39], a[100:103], a[0:3], v[36:39]
    s_waitcnt lgkmcnt(6)
    v_mfma_f32_16x16x32_bf16 v[40:43], a[104:107], a[0:3], v[40:43]
    ds_read_b128 a[136:139], v4
    ds_read_b128 a[140:143], v4 offset:2048
    s_waitcnt lgkmcnt(6)
    v_mfma_f32_16x16x32_bf16 v[44:47], a[108:111], a[0:3], v[44:47]
    ds_read_b128 a[144:147], v5
    ds_read_b128 a[148:151], v5 offset:2048
    ds_read_b128 a[0:3], v152 offset:16384
    v_mfma_f32_16x16x32_bf16 v[48:51], a[96:99], a[4:7], v[48:51]
    v_mfma_f32_16x16x32_bf16 v[52:55], a[100:103], a[4:7], v[52:55]
    v_mfma_f32_16x16x32_bf16 v[56:59], a[104:107], a[4:7], v[56:59]
    v_mfma_f32_16x16x32_bf16 v[60:63], a[108:111], a[4:7], v[60:63]
    ds_read_b128 a[4:7], v152 offset:18432
    v_mfma_f32_16x16x32_bf16 v[64:67], a[96:99], a[8:11], v[64:67]
    v_mfma_f32_16x16x32_bf16 v[68:71], a[100:103], a[8:11], v[68:71]
    v_mfma_f32_16x16x32_bf16 v[72:75], a[104:107], a[8:11], v[72:75]
    v_mfma_f32_16x16x32_bf16 v[76:79], a[108:111], a[8:11], v[76:79]
    ds_read_b128 a[8:11], v153
    v_mfma_f32_16x16x32_bf16 v[80:83], a[96:99], a[12:15], v[80:83]
    v_mfma_f32_16x16x32_bf16 v[84:87], a[100:103], a[12:15], v[84:87]
    v_mfma_f32_16x16x32_bf16 v[88:91], a[104:107], a[12:15], v[88:91]
    v_mfma_f32_16x16x32_bf16 v[92:95], a[108:111], a[12:15], v[92:95]
    ds_read_b128 a[12:15], v153 offset:2048
    s_waitcnt lgkmcnt(8)
    v_mfma_f32_16x16x32_bf16 v[96:99], a[96:99], a[16:19], v[96:99]
    v_mfma_f32_16x16x32_bf16 v[100:103], a[100:103], a[16:19], v[100:103]
    v_mfma_f32_16x16x32_bf16 v[104:107], a[104:107], a[16:19], v[104:107]
    v_mfma_f32_16x16x32_bf16 v[108:111], a[108:111], a[16:19], v[108:111]
    ds_read_b128 a[16:19], v153 offset:4096
    v_mfma_f32_16x16x32_bf16 v[112:115], a[96:99], a[20:23], v[112:115]
    s_waitcnt vmcnt(12)
    ds_read_b64_tr_b16 a[112:113], v154 offset:4096
    ds_read_b64_tr_b16 a[114:115], v154 offset:4608
    ds_read_b64_tr_b16 a[116:117], v155 offset:4096
    v_mfma_f32_16x16x32_bf16 v[116:119], a[100:103], a[20:23], v[116:119]
    ds_read_b64_tr_b16 a[118:119], v155 offset:4608
    ds_read_b64_tr_b16 a[120:121], v156 offset:4096
    ds_read_b64_tr_b16 a[122:123], v156 offset:4608
    ds_read_b64_tr_b16 a[124:125], v157 offset:4096
    v_mfma_f32_16x16x32_bf16 v[120:123], a[104:107], a[20:23], v[120:123]
    s_waitcnt lgkmcnt(11)
    s_add_u32 m0, s29, 0
    s_mov_b32 s32, 131072
    buffer_load_dwordx4 v10, s[8:11], s32 offen nt lds
    v_mfma_f32_16x16x32_bf16 v[124:127], a[108:111], a[20:23], v[124:127]
    ds_read_b64_tr_b16 a[126:127], v157 offset:4608
    ds_read_b128 a[20:23], v153 offset:6144
    v_mfma_f32_16x16x32_bf16 v[128:131], a[96:99], a[24:27], v[128:131]
    v_mfma_f32_16x16x32_bf16 v[132:135], a[100:103], a[24:27], v[132:135]
    buffer_load_dwordx4 v11, s[8:11], s32 offen offset:1024 nt lds
    v_mfma_f32_16x16x32_bf16 v[136:139], a[104:107], a[24:27], v[136:139]
    v_mfma_f32_16x16x32_bf16 v[140:143], a[108:111], a[24:27], v[140:143]
    ds_read_b128 a[24:27], v153 offset:8192
    v_mfma_f32_16x16x32_bf16 v[144:147], a[96:99], a[28:31], v[144:147]
    buffer_load_dwordx4 v12, s[8:11], s32 offen offset:2048 nt lds
    v_mfma_f32_16x16x32_bf16 v[148:151], a[100:103], a[28:31], v[148:151]
    v_mfma_f32_16x16x32_bf16 v[176:179], a[104:107], a[28:31], v[176:179]
    v_mfma_f32_16x16x32_bf16 v[180:183], a[108:111], a[28:31], v[180:183]
    buffer_load_dwordx4 v13, s[8:11], s32 offen offset:3072 nt lds
    ds_read_b128 a[28:31], v153 offset:10240
    s_waitcnt lgkmcnt(12)
    v_mfma_f32_16x16x32_bf16 v[184:187], a[96:99], a[0:3], v[184:187]
    v_mfma_f32_16x16x32_bf16 v[188:191], a[100:103], a[0:3], v[188:191]
    v_mfma_f32_16x16x32_bf16 v[192:195], a[104:107], a[0:3], v[192:195]
    v_mfma_f32_16x16x32_bf16 v[196:199], a[108:111], a[0:3], v[196:199]
    ds_read_b128 a[0:3], v153 offset:12288
    v_mfma_f32_16x16x32_bf16 v[200:203], a[96:99], a[4:7], v[200:203]
    v_mfma_f32_16x16x32_bf16 v[204:207], a[100:103], a[4:7], v[204:207]
    v_mfma_f32_16x16x32_bf16 v[208:211], a[104:107], a[4:7], v[208:211]
    v_mfma_f32_16x16x32_bf16 v[212:215], a[108:111], a[4:7], v[212:215]
    ds_read_b128 a[4:7], v153 offset:14336
    s_waitcnt lgkmcnt(11)
    v_mfma_f32_16x16x32_bf16 v[32:35], a[112:115], a[8:11], v[32:35]
    s_waitcnt lgkmcnt(9)
    v_mfma_f32_16x16x32_bf16 v[36:39], a[116:119], a[8:11], v[36:39]
    s_waitcnt lgkmcnt(7)
    v_mfma_f32_16x16x32_bf16 v[40:43], a[120:123], a[8:11], v[40:43]
    s_waitcnt vmcnt(12)
    ds_read_b128 a[152:155], v4 offset:4096
    ds_read_b128 a[156:159], v4 offset:6144
    ds_read_b128 a[160:163], v5 offset:4096
    ds_read_b128 a[164:167], v5 offset:6144
    s_waitcnt lgkmcnt(9)
    v_mfma_f32_16x16x32_bf16 v[44:47], a[124:127], a[8:11], v[44:47]
    ds_read_b128 a[8:11], v153 offset:16384
    v_mfma_f32_16x16x32_bf16 v[48:51], a[112:115], a[12:15], v[48:51]
    v_mfma_f32_16x16x32_bf16 v[52:55], a[116:119], a[12:15], v[52:55]
    v_mfma_f32_16x16x32_bf16 v[56:59], a[120:123], a[12:15], v[56:59]
    v_mfma_f32_16x16x32_bf16 v[60:63], a[124:127], a[12:15], v[60:63]
    ds_read_b128 a[12:15], v153 offset:18432
    s_waitcnt lgkmcnt(8)
    v_mfma_f32_16x16x32_bf16 v[64:67], a[112:115], a[16:19], v[64:67]
    v_mfma_f32_16x16x32_bf16 v[68:71], a[116:119], a[16:19], v[68:71]
    v_mfma_f32_16x16x32_bf16 v[72:75], a[120:123], a[16:19], v[72:75]
    v_mfma_f32_16x16x32_bf16 v[76:79], a[124:127], a[16:19], v[76:79]
    s_waitcnt lgkmcnt(0)
    s_barrier
    v_mfma_f32_16x16x32_bf16 v[80:83], a[112:115], a[20:23], v[80:83]
    v_cvt_pk_bf16_f32 v32, v32, v33
    v_cvt_pk_bf16_f32 v48, v48, v49
    v_cvt_pk_bf16_f32 v33, v34, v35
    v_cvt_pk_bf16_f32 v49, v50, v51
    v_cvt_pk_bf16_f32 v34, v36, v37
    v_cvt_pk_bf16_f32 v50, v52, v53
    v_cvt_pk_bf16_f32 v35, v38, v39
    v_cvt_pk_bf16_f32 v51, v54, v55
    v_mfma_f32_16x16x32_bf16 v[84:87], a[116:119], a[20:23], v[84:87]
    v_permlane16_swap_b32 v32, v34
    v_permlane16_swap_b32 v48, v50
    v_permlane16_swap_b32 v33, v35
    v_permlane16_swap_b32 v49, v51
    v_cvt_pk_bf16_f32 v40, v40, v41
    v_cvt_pk_bf16_f32 v56, v56, v57
    v_cvt_pk_bf16_f32 v41, v42, v43
    v_cvt_pk_bf16_f32 v57, v58, v59
    v_mfma_f32_16x16x32_bf16 v[88:91], a[120:123], a[20:23], v[88:91]
    v_cvt_pk_bf16_f32 v42, v44, v45
    v_cvt_pk_bf16_f32 v58, v60, v61
    v_cvt_pk_bf16_f32 v43, v46, v47
    v_cvt_pk_bf16_f32 v59, v62, v63
    v_permlane16_swap_b32 v40, v42
    v_permlane16_swap_b32 v56, v58
    v_permlane16_swap_b32 v41, v43
    v_permlane16_swap_b32 v57, v59
    v_mfma_f32_16x16x32_bf16 v[92:95], a[124:127], a[20:23], v[92:95]
    ds_write_b128 v167, v[32:35]
    v_mfma_f32_16x16x32_bf16 v[96:99], a[112:115], a[24:27], v[96:99]
    ds_write_b128 v167, v[48:51] offset:1024
    v_mfma_f32_16x16x32_bf16 v[100:103], a[116:119], a[24:27], v[100:103]
    ds_write_b128 v167, v[40:43] offset:10240
    v_mfma_f32_16x16x32_bf16 v[104:107], a[120:123], a[24:27], v[104:107]
    ds_write_b128 v167, v[56:59] offset:11264
    v_cvt_pk_bf16_f32 v64, v64, v65
    v_cvt_pk_bf16_f32 v65, v66, v67
    v_mfma_f32_16x16x32_bf16 v[108:111], a[124:127], a[24:27], v[108:111]
    v_cvt_pk_bf16_f32 v66, v68, v69
    v_cvt_pk_bf16_f32 v67, v70, v71
    s_nop 0
    v_permlane16_swap_b32 v64, v66
    v_permlane16_swap_b32 v65, v67
    v_cvt_pk_bf16_f32 v72, v72, v73
    v_cvt_pk_bf16_f32 v73, v74, v75
    v_cvt_pk_bf16_f32 v74, v76, v77
    v_cvt_pk_bf16_f32 v75, v78, v79
    v_mfma_f32_16x16x32_bf16 v[112:115], a[112:115], a[28:31], v[112:115]
    v_permlane16_swap_b32 v72, v74
    v_permlane16_swap_b32 v73, v75
    ds_write_b128 v167, v[64:67] offset:2048
    v_mfma_f32_16x16x32_bf16 v[116:119], a[116:119], a[28:31], v[116:119]
    ds_write_b128 v167, v[72:75] offset:12288
    v_cvt_pk_bf16_f32 v80, v80, v81
    v_cvt_pk_bf16_f32 v81, v82, v83
    v_mfma_f32_16x16x32_bf16 v[120:123], a[120:123], a[28:31], v[120:123]
    s_add_u32 m0, s29, 4096
    s_mov_b32 s32, 131200
    buffer_load_dwordx4 v10, s[8:11], s32 offen nt lds
    v_mfma_f32_16x16x32_bf16 v[124:127], a[124:127], a[28:31], v[124:127]
    v_cvt_pk_bf16_f32 v82, v84, v85
    v_cvt_pk_bf16_f32 v83, v86, v87
    s_nop 0
    v_permlane16_swap_b32 v80, v82
    v_permlane16_swap_b32 v81, v83
    v_cvt_pk_bf16_f32 v88, v88, v89
    v_cvt_pk_bf16_f32 v89, v90, v91
    v_cvt_pk_bf16_f32 v90, v92, v93
    v_mfma_f32_16x16x32_bf16 v[128:131], a[112:115], a[0:3], v[128:131]
    v_cvt_pk_bf16_f32 v91, v94, v95
    v_permlane16_swap_b32 v88, v90
    s_nop 0
    v_permlane16_swap_b32 v89, v91
    v_mfma_f32_16x16x32_bf16 v[132:135], a[116:119], a[0:3], v[132:135]
    buffer_load_dwordx4 v11, s[8:11], s32 offen offset:1024 nt lds
    v_mfma_f32_16x16x32_bf16 v[136:139], a[120:123], a[0:3], v[136:139]
    ds_write_b128 v167, v[80:83] offset:3072
    ds_write_b128 v167, v[88:91] offset:13312
    v_mfma_f32_16x16x32_bf16 v[140:143], a[124:127], a[0:3], v[140:143]
    v_cvt_pk_bf16_f32 v96, v96, v97
    v_cvt_pk_bf16_f32 v97, v98, v99
    v_cvt_pk_bf16_f32 v98, v100, v101
    v_cvt_pk_bf16_f32 v99, v102, v103
    s_nop 0
    v_permlane16_swap_b32 v96, v98
    v_permlane16_swap_b32 v97, v99
    v_cvt_pk_bf16_f32 v104, v104, v105
    v_cvt_pk_bf16_f32 v105, v106, v107
    v_cvt_pk_bf16_f32 v106, v108, v109
    v_mfma_f32_16x16x32_bf16 v[144:147], a[112:115], a[4:7], v[144:147]
    v_cvt_pk_bf16_f32 v107, v110, v111
    v_permlane16_swap_b32 v104, v106
    s_nop 0
    v_permlane16_swap_b32 v105, v107
    buffer_load_dwordx4 v12, s[8:11], s32 offen offset:2048 nt lds
    v_mfma_f32_16x16x32_bf16 v[148:151], a[116:119], a[4:7], v[148:151]
    ds_write_b128 v167, v[96:99] offset:4096
    v_mfma_f32_16x16x32_bf16 v[176:179], a[120:123], a[4:7], v[176:179]
    ds_write_b128 v167, v[104:107] offset:14336
    v_cvt_pk_bf16_f32 v112, v112, v113
    v_cvt_pk_bf16_f32 v113, v114, v115
    v_cvt_pk_bf16_f32 v114, v116, v117
    v_mfma_f32_16x16x32_bf16 v[180:183], a[124:127], a[4:7], v[180:183]
    v_cvt_pk_bf16_f32 v115, v118, v119
    v_permlane16_swap_b32 v112, v114
    s_nop 0
    v_permlane16_swap_b32 v113, v115
    buffer_load_dwordx4 v13, s[8:11], s32 offen offset:3072 nt lds
    v_mfma_f32_16x16x32_bf16 v[184:187], a[112:115], a[8:11], v[184:187]
    v_cvt_pk_bf16_f32 v120, v120, v121
    v_cvt_pk_bf16_f32 v121, v122, v123
    v_cvt_pk_bf16_f32 v122, v124, v125
    v_cvt_pk_bf16_f32 v123, v126, v127
    s_nop 0
    v_permlane16_swap_b32 v120, v122
    v_permlane16_swap_b32 v121, v123
    v_mfma_f32_16x16x32_bf16 v[188:191], a[116:119], a[8:11], v[188:191]
    ds_write_b128 v167, v[112:115] offset:5120
    v_mfma_f32_16x16x32_bf16 v[192:195], a[120:123], a[8:11], v[192:195]
    ds_write_b128 v167, v[120:123] offset:15360
    v_cvt_pk_bf16_f32 v128, v128, v129
    v_cvt_pk_bf16_f32 v129, v130, v131
    v_cvt_pk_bf16_f32 v130, v132, v133
    v_mfma_f32_16x16x32_bf16 v[196:199], a[124:127], a[8:11], v[196:199]
    v_cvt_pk_bf16_f32 v131, v134, v135
    v_permlane16_swap_b32 v128, v130
    s_nop 0
    v_permlane16_swap_b32 v129, v131
    v_cvt_pk_bf16_f32 v136, v136, v137
    v_cvt_pk_bf16_f32 v137, v138, v139
    v_cvt_pk_bf16_f32 v138, v140, v141
    v_cvt_pk_bf16_f32 v144, v144, v145
    v_cvt_pk_bf16_f32 v139, v142, v143
    v_cvt_pk_bf16_f32 v145, v146, v147
    v_mfma_f32_16x16x32_bf16 v[200:203], a[112:115], a[12:15], v[200:203]
    v_permlane16_swap_b32 v136, v138
    v_cvt_pk_bf16_f32 v146, v148, v149
    v_permlane16_swap_b32 v137, v139
    v_cvt_pk_bf16_f32 v147, v150, v151
    v_mfma_f32_16x16x32_bf16 v[204:207], a[116:119], a[12:15], v[204:207]
    ds_write_b128 v167, v[128:131] offset:6144
    v_permlane16_swap_b32 v144, v146
    v_permlane16_swap_b32 v145, v147
    v_cvt_pk_bf16_f32 v176, v176, v177
    v_cvt_pk_bf16_f32 v177, v178, v179
    v_mfma_f32_16x16x32_bf16 v[208:211], a[120:123], a[12:15], v[208:211]
    ds_write_b128 v167, v[136:139] offset:16384
    v_cvt_pk_bf16_f32 v178, v180, v181
    v_cvt_pk_bf16_f32 v179, v182, v183
    s_nop 0
    v_permlane16_swap_b32 v176, v178
    v_permlane16_swap_b32 v177, v179
    v_mfma_f32_16x16x32_bf16 v[212:215], a[124:127], a[12:15], v[212:215]
    ds_write_b128 v167, v[144:147] offset:7168
    ds_write_b128 v167, v[176:179] offset:17408
    v_cvt_pk_bf16_f32 v184, v184, v185
    v_cvt_pk_bf16_f32 v185, v186, v187
    v_cvt_pk_bf16_f32 v186, v188, v189
    v_cvt_pk_bf16_f32 v187, v190, v191
    s_nop 0
    v_permlane16_swap_b32 v184, v186
    v_permlane16_swap_b32 v185, v187
    v_cvt_pk_bf16_f32 v192, v192, v193
    v_cvt_pk_bf16_f32 v193, v194, v195
    v_cvt_pk_bf16_f32 v194, v196, v197
    v_cvt_pk_bf16_f32 v195, v198, v199
    s_nop 0
    v_permlane16_swap_b32 v192, v194
    v_permlane16_swap_b32 v193, v195
    ds_write_b128 v167, v[184:187] offset:8192
    ds_write_b128 v167, v[192:195] offset:18432
    v_cvt_pk_bf16_f32 v200, v200, v201
    v_cvt_pk_bf16_f32 v201, v202, v203
    v_cvt_pk_bf16_f32 v202, v204, v205
    v_cvt_pk_bf16_f32 v203, v206, v207
    s_nop 0
    v_permlane16_swap_b32 v200, v202
    v_permlane16_swap_b32 v201, v203
    v_cvt_pk_bf16_f32 v208, v208, v209
    v_cvt_pk_bf16_f32 v209, v210, v211
    v_cvt_pk_bf16_f32 v210, v212, v213
    v_cvt_pk_bf16_f32 v211, v214, v215
    s_nop 0
    v_permlane16_swap_b32 v208, v210
    v_permlane16_swap_b32 v209, v211
    ds_write_b128 v167, v[200:203] offset:9216
    ds_write_b128 v167, v[208:211] offset:19456
    v_mov_b32 v152, 0
    v_mov_b32 v153, 0
    v_mov_b32 v154, 0
    v_mov_b32 v155, 0
    v_mov_b32 v156, 0
    v_mov_b32 v157, 0
    v_mov_b32 v158, 0
    v_mov_b32 v159, 0
    v_mov_b32 v160, 0
    v_mov_b32 v161, 0
    s_waitcnt lgkmcnt(0)
    s_barrier
    s_cmp_eq_u32 s35, 0
    s_cbranch_scc1 L_nosweep
    s_waitcnt vmcnt(0)
    v_and_b32 v173, 15, v1
    v_lshlrev_b32 v173, 9, v173
    v_lshrrev_b32 v172, 4, v1
    v_lshl_add_u32 v172, v172, 4, v173
    s_lshl_b32 s37, s28, 14
    v_add_u32 v172, s37, v172
    s_mov_b32 s36, 0
L_sweep:
    s_add_u32 s38, s36, 0
    buffer_load_dwordx4 v[112:115], v172, s[8:11], s38 offen
    s_add_u32 s38, s36, 8192
    buffer_load_dwordx4 v[116:119], v172, s[8:11], s38 offen
    ds_read_b128 v[120:123], v2
    s_waitcnt lgkmcnt(0)
    s_waitcnt vmcnt(1)
    v_mfma_f32_16x16x32_bf16 v[32:35], v[112:115], v[120:123], 0
    s_waitcnt vmcnt(0)
    v_mfma_f32_16x16x32_bf16 v[36:39], v[116:119], v[120:123], 0
    s_nop 3
    ds_read_b128 v[120:123], v2 offset:1024
    s_waitcnt lgkmcnt(0)
    v_mfma_f32_16x16x32_bf16 v[40:43], v[112:115], v[120:123], 0
    v_mfma_f32_16x16x32_bf16 v[44:47], v[116:119], v[120:123], 0
    s_nop 3
    ds_read_b128 v[120:123], v2 offset:2048
    s_waitcnt lgkmcnt(0)
    v_mfma_f32_16x16x32_bf16 v[48:51], v[112:115], v[120:123], 0
    v_mfma_f32_16x16x32_bf16 v[52:55], v[116:119], v[120:123], 0
    s_nop 3
    ds_read_b128 v[120:123], v2 offset:3072
    s_waitcnt lgkmcnt(0)
    v_mfma_f32_16x16x32_bf16 v[56:59], v[112:115], v[120:123], 0
    v_mfma_f32_16x16x32_bf16 v[60:63], v[116:119], v[120:123], 0
    s_nop 3
    ds_read_b128 v[120:123], v2 offset:4096
    s_waitcnt lgkmcnt(0)
    v_mfma_f32_16x16x32_bf16 v[64:67], v[112:115], v[120:123], 0
    v_mfma_f32_16x16x32_bf16 v[68:71], v[116:119], v[120:123], 0
    s_nop 3
    ds_read_b128 v[120:123], v2 offset:5120
    s_waitcnt lgkmcnt(0)
    v_mfma_f32_16x16x32_bf16 v[72:75], v[112:115], v[120:123], 0
    v_mfma_f32_16x16x32_bf16 v[76:79], v[116:119], v[120:123], 0
    s_nop 3
    ds_read_b128 v[120:123], v2 offset:6144
    s_waitcnt lgkmcnt(0)
    v_mfma_f32_16x16x32_bf16 v[80:83], v[112:115], v[120:123], 0
    v_mfma_f32_16x16x32_bf16 v[84:87], v[116:119], v[120:123], 0
    s_nop 3
    ds_read_b128 v[120:123], v2 offset:7168
    s_waitcnt lgkmcnt(0)
    v_mfma_f32_16x16x32_bf16 v[88:91], v[112:115], v[120:123], 0
    v_mfma_f32_16x16x32_bf16 v[92:95], v[116:119], v[120:123], 0
    s_nop 3
    ds_read_b128 v[120:123], v2 offset:8192
    s_waitcnt lgkmcnt(0)
    v_mfma_f32_16x16x32_bf16 v[96:99], v[112:115], v[120:123], 0
    v_mfma_f32_16x16x32_bf16 v[100:103], v[116:119], v[120:123], 0
    s_nop 3
    ds_read_b128 v[120:123], v2 offset:9216
    s_waitcnt lgkmcnt(0)
    v_mfma_f32_16x16x32_bf16 v[104:107], v[112:115], v[120:123], 0
    v_mfma_f32_16x16x32_bf16 v[108:111], v[116:119], v[120:123], 0
    s_nop 3
    s_add_u32 s38, s36, 0
    buffer_load_dwordx4 v[112:115], v172, s[8:11], s38 offen offset:64
    s_add_u32 s38, s36, 8192
    buffer_load_dwordx4 v[116:119], v172, s[8:11], s38 offen offset:64
    ds_read_b128 v[120:123], v2 offset:10240
    s_waitcnt lgkmcnt(0)
    s_waitcnt vmcnt(1)
    v_mfma_f32_16x16x32_bf16 v[32:35], v[112:115], v[120:123], v[32:35]
    s_waitcnt vmcnt(0)
    v_mfma_f32_16x16x32_bf16 v[36:39], v[116:119], v[120:123], v[36:39]
    s_nop 3
    ds_read_b128 v[120:123], v2 offset:11264
    s_waitcnt lgkmcnt(0)
    v_mfma_f32_16x16x32_bf16 v[40:43], v[112:115], v[120:123], v[40:43]
    v_mfma_f32_16x16x32_bf16 v[44:47], v[116:119], v[120:123], v[44:47]
    s_nop 3
    ds_read_b128 v[120:123], v2 offset:12288
    s_waitcnt lgkmcnt(0)
    v_mfma_f32_16x16x32_bf16 v[48:51], v[112:115], v[120:123], v[48:51]
    v_mfma_f32_16x16x32_bf16 v[52:55], v[116:119], v[120:123], v[52:55]
    s_nop 3
    ds_read_b128 v[120:123], v2 offset:13312
    s_waitcnt lgkmcnt(0)
    v_mfma_f32_16x16x32_bf16 v[56:59], v[112:115], v[120:123], v[56:59]
    v_mfma_f32_16x16x32_bf16 v[60:63], v[116:119], v[120:123], v[60:63]
    s_nop 3
    ds_read_b128 v[120:123], v2 offset:14336
    s_waitcnt lgkmcnt(0)
    v_mfma_f32_16x16x32_bf16 v[64:67], v[112:115], v[120:123], v[64:67]
    v_mfma_f32_16x16x32_bf16 v[68:71], v[116:119], v[120:123], v[68:71]
    s_nop 3
    ds_read_b128 v[120:123], v2 offset:15360
    s_waitcnt lgkmcnt(0)
    v_mfma_f32_16x16x32_bf16 v[72:75], v[112:115], v[120:123], v[72:75]
    v_mfma_f32_16x16x32_bf16 v[76:79], v[116:119], v[120:123], v[76:79]
    s_nop 3
    ds_read_b128 v[120:123], v2 offset:16384
    s_waitcnt lgkmcnt(0)
    v_mfma_f32_16x16x32_bf16 v[80:83], v[112:115], v[120:123], v[80:83]
    v_mfma_f32_16x16x32_bf16 v[84:87], v[116:119], v[120:123], v[84:87]
    s_nop 3
    ds_read_b128 v[120:123], v2 offset:17408
    s_waitcnt lgkmcnt(0)
    v_mfma_f32_16x16x32_bf16 v[88:91], v[112:115], v[120:123], v[88:91]
    v_mfma_f32_16x16x32_bf16 v[92:95], v[116:119], v[120:123], v[92:95]
    s_nop 3
    ds_read_b128 v[120:123], v2 offset:18432
    s_waitcnt lgkmcnt(0)
    v_mfma_f32_16x16x32_bf16 v[96:99], v[112:115], v[120:123], v[96:99]
    v_mfma_f32_16x16x32_bf16 v[100:103], v[116:119], v[120:123], v[100:103]
    s_nop 3
    ds_read_b128 v[120:123], v2 offset:19456
    s_waitcnt lgkmcnt(0)
    v_mfma_f32_16x16x32_bf16 v[104:107], v[112:115], v[120:123], v[104:107]
    v_mfma_f32_16x16x32_bf16 v[108:111], v[116:119], v[120:123], v[108:111]
    s_nop 3
    s_add_u32 s38, s36, 0
    buffer_load_dwordx4 v[112:115], v172, s[8:11], s38 offen offset:128
    s_add_u32 s38, s36, 8192
    buffer_load_dwordx4 v[116:119], v172, s[8:11], s38 offen offset:128
    ds_read_b128 v[120:123], v2 offset:20480
    s_waitcnt lgkmcnt(0)
    s_waitcnt vmcnt(1)
    v_mfma_f32_16x16x32_bf16 v[32:35], v[112:115], v[120:123], v[32:35]
    s_waitcnt vmcnt(0)
    v_mfma_f32_16x16x32_bf16 v[36:39], v[116:119], v[120:123], v[36:39]
    s_nop 3
    ds_read_b128 v[120:123], v2 offset:21504
    s_waitcnt lgkmcnt(0)
    v_mfma_f32_16x16x32_bf16 v[40:43], v[112:115], v[120:123], v[40:43]
    v_mfma_f32_16x16x32_bf16 v[44:47], v[116:119], v[120:123], v[44:47]
    s_nop 3
    ds_read_b128 v[120:123], v2 offset:22528
    s_waitcnt lgkmcnt(0)
    v_mfma_f32_16x16x32_bf16 v[48:51], v[112:115], v[120:123], v[48:51]
    v_mfma_f32_16x16x32_bf16 v[52:55], v[116:119], v[120:123], v[52:55]
    s_nop 3
    ds_read_b128 v[120:123], v2 offset:23552
    s_waitcnt lgkmcnt(0)
    v_mfma_f32_16x16x32_bf16 v[56:59], v[112:115], v[120:123], v[56:59]
    v_mfma_f32_16x16x32_bf16 v[60:63], v[116:119], v[120:123], v[60:63]
    s_nop 3
    ds_read_b128 v[120:123], v2 offset:24576
    s_waitcnt lgkmcnt(0)
    v_mfma_f32_16x16x32_bf16 v[64:67], v[112:115], v[120:123], v[64:67]
    v_mfma_f32_16x16x32_bf16 v[68:71], v[116:119], v[120:123], v[68:71]
    s_nop 3
    ds_read_b128 v[120:123], v2 offset:25600
    s_waitcnt lgkmcnt(0)
    v_mfma_f32_16x16x32_bf16 v[72:75], v[112:115], v[120:123], v[72:75]
    v_mfma_f32_16x16x32_bf16 v[76:79], v[116:119], v[120:123], v[76:79]
    s_nop 3
    ds_read_b128 v[120:123], v2 offset:26624
    s_waitcnt lgkmcnt(0)
    v_mfma_f32_16x16x32_bf16 v[80:83], v[112:115], v[120:123], v[80:83]
    v_mfma_f32_16x16x32_bf16 v[84:87], v[116:119], v[120:123], v[84:87]
    s_nop 3
    ds_read_b128 v[120:123], v2 offset:27648
    s_waitcnt lgkmcnt(0)
    v_mfma_f32_16x16x32_bf16 v[88:91], v[112:115], v[120:123], v[88:91]
    v_mfma_f32_16x16x32_bf16 v[92:95], v[116:119], v[120:123], v[92:95]
    s_nop 3
    ds_read_b128 v[120:123], v2 offset:28672
    s_waitcnt lgkmcnt(0)
    v_mfma_f32_16x16x32_bf16 v[96:99], v[112:115], v[120:123], v[96:99]
    v_mfma_f32_16x16x32_bf16 v[100:103], v[116:119], v[120:123], v[100:103]
    s_nop 3
    ds_read_b128 v[120:123], v2 offset:29696
    s_waitcnt lgkmcnt(0)
    v_mfma_f32_16x16x32_bf16 v[104:107], v[112:115], v[120:123], v[104:107]
    v_mfma_f32_16x16x32_bf16 v[108:111], v[116:119], v[120:123], v[108:111]
    s_nop 3
    s_add_u32 s38, s36, 0
    buffer_load_dwordx4 v[112:115], v172, s[8:11], s38 offen offset:192
    s_add_u32 s38, s36, 8192
    buffer_load_dwordx4 v[116:119], v172, s[8:11], s38 offen offset:192
    ds_read_b128 v[120:123], v2 offset:30720
    s_waitcnt lgkmcnt(0)
    s_waitcnt vmcnt(1)
    v_mfma_f32_16x16x32_bf16 v[32:35], v[112:115], v[120:123], v[32:35]
    s_waitcnt vmcnt(0)
    v_mfma_f32_16x16x32_bf16 v[36:39], v[116:119], v[120:123], v[36:39]
    s_nop 3
    ds_read_b128 v[120:123], v2 offset:31744
    s_waitcnt lgkmcnt(0)
    v_mfma_f32_16x16x32_bf16 v[40:43], v[112:115], v[120:123], v[40:43]
    v_mfma_f32_16x16x32_bf16 v[44:47], v[116:119], v[120:123], v[44:47]
    s_nop 3
    ds_read_b128 v[120:123], v2 offset:32768
    s_waitcnt lgkmcnt(0)
    v_mfma_f32_16x16x32_bf16 v[48:51], v[112:115], v[120:123], v[48:51]
    v_mfma_f32_16x16x32_bf16 v[52:55], v[116:119], v[120:123], v[52:55]
    s_nop 3
    ds_read_b128 v[120:123], v2 offset:33792
    s_waitcnt lgkmcnt(0)
    v_mfma_f32_16x16x32_bf16 v[56:59], v[112:115], v[120:123], v[56:59]
    v_mfma_f32_16x16x32_bf16 v[60:63], v[116:119], v[120:123], v[60:63]
    s_nop 3
    ds_read_b128 v[120:123], v2 offset:34816
    s_waitcnt lgkmcnt(0)
    v_mfma_f32_16x16x32_bf16 v[64:67], v[112:115], v[120:123], v[64:67]
    v_mfma_f32_16x16x32_bf16 v[68:71], v[116:119], v[120:123], v[68:71]
    s_nop 3
    ds_read_b128 v[120:123], v2 offset:35840
    s_waitcnt lgkmcnt(0)
    v_mfma_f32_16x16x32_bf16 v[72:75], v[112:115], v[120:123], v[72:75]
    v_mfma_f32_16x16x32_bf16 v[76:79], v[116:119], v[120:123], v[76:79]
    s_nop 3
    ds_read_b128 v[120:123], v2 offset:36864
    s_waitcnt lgkmcnt(0)
    v_mfma_f32_16x16x32_bf16 v[80:83], v[112:115], v[120:123], v[80:83]
    v_mfma_f32_16x16x32_bf16 v[84:87], v[116:119], v[120:123], v[84:87]
    s_nop 3
    ds_read_b128 v[120:123], v2 offset:37888
    s_waitcnt lgkmcnt(0)
    v_mfma_f32_16x16x32_bf16 v[88:91], v[112:115], v[120:123], v[88:91]
    v_mfma_f32_16x16x32_bf16 v[92:95], v[116:119], v[120:123], v[92:95]
    s_nop 3
    ds_read_b128 v[120:123], v2 offset:38912
    s_waitcnt lgkmcnt(0)
    v_mfma_f32_16x16x32_bf16 v[96:99], v[112:115], v[120:123], v[96:99]
    v_mfma_f32_16x16x32_bf16 v[100:103], v[116:119], v[120:123], v[100:103]
    s_nop 3
    ds_read_b128 v[120:123], v2 offset:39936
    s_waitcnt lgkmcnt(0)
    v_mfma_f32_16x16x32_bf16 v[104:107], v[112:115], v[120:123], v[104:107]
    v_mfma_f32_16x16x32_bf16 v[108:111], v[116:119], v[120:123], v[108:111]
    s_nop 3
    s_add_u32 s38, s36, 0
    buffer_load_dwordx4 v[112:115], v172, s[8:11], s38 offen offset:256
    s_add_u32 s38, s36, 8192
    buffer_load_dwordx4 v[116:119], v172, s[8:11], s38 offen offset:256
    ds_read_b128 v[120:123], v3
    s_waitcnt lgkmcnt(0)
    s_waitcnt vmcnt(1)
    v_mfma_f32_16x16x32_bf16 v[32:35], v[112:115], v[120:123], v[32:35]
    s_waitcnt vmcnt(0)
    v_mfma_f32_16x16x32_bf16 v[36:39], v[116:119], v[120:123], v[36:39]
    s_nop 3
    ds_read_b128 v[120:123], v3 offset:1024
    s_waitcnt lgkmcnt(0)
    v_mfma_f32_16x16x32_bf16 v[40:43], v[112:115], v[120:123], v[40:43]
    v_mfma_f32_16x16x32_bf16 v[44:47], v[116:119], v[120:123], v[44:47]
    s_nop 3
    ds_read_b128 v[120:123], v3 offset:2048
    s_waitcnt lgkmcnt(0)
    v_mfma_f32_16x16x32_bf16 v[48:51], v[112:115], v[120:123], v[48:51]
    v_mfma_f32_16x16x32_bf16 v[52:55], v[116:119], v[120:123], v[52:55]
    s_nop 3
    ds_read_b128 v[120:123], v3 offset:3072
    s_waitcnt lgkmcnt(0)
    v_mfma_f32_16x16x32_bf16 v[56:59], v[112:115], v[120:123], v[56:59]
    v_mfma_f32_16x16x32_bf16 v[60:63], v[116:119], v[120:123], v[60:63]
    s_nop 3
    ds_read_b128 v[120:123], v3 offset:4096
    s_waitcnt lgkmcnt(0)
    v_mfma_f32_16x16x32_bf16 v[64:67], v[112:115], v[120:123], v[64:67]
    v_mfma_f32_16x16x32_bf16 v[68:71], v[116:119], v[120:123], v[68:71]
    s_nop 3
    ds_read_b128 v[120:123], v3 offset:5120
    s_waitcnt lgkmcnt(0)
    v_mfma_f32_16x16x32_bf16 v[72:75], v[112:115], v[120:123], v[72:75]
    v_mfma_f32_16x16x32_bf16 v[76:79], v[116:119], v[120:123], v[76:79]
    s_nop 3
    ds_read_b128 v[120:123], v3 offset:6144
    s_waitcnt lgkmcnt(0)
    v_mfma_f32_16x16x32_bf16 v[80:83], v[112:115], v[120:123], v[80:83]
    v_mfma_f32_16x16x32_bf16 v[84:87], v[116:119], v[120:123], v[84:87]
    s_nop 3
    ds_read_b128 v[120:123], v3 offset:7168
    s_waitcnt lgkmcnt(0)
    v_mfma_f32_16x16x32_bf16 v[88:91], v[112:115], v[120:123], v[88:91]
    v_mfma_f32_16x16x32_bf16 v[92:95], v[116:119], v[120:123], v[92:95]
    s_nop 3
    ds_read_b128 v[120:123], v3 offset:8192
    s_waitcnt lgkmcnt(0)
    v_mfma_f32_16x16x32_bf16 v[96:99], v[112:115], v[120:123], v[96:99]
    v_mfma_f32_16x16x32_bf16 v[100:103], v[116:119], v[120:123], v[100:103]
    s_nop 3
    ds_read_b128 v[120:123], v3 offset:9216
    s_waitcnt lgkmcnt(0)
    v_mfma_f32_16x16x32_bf16 v[104:107], v[112:115], v[120:123], v[104:107]
    v_mfma_f32_16x16x32_bf16 v[108:111], v[116:119], v[120:123], v[108:111]
    s_nop 3
    s_add_u32 s38, s36, 0
    buffer_load_dwordx4 v[112:115], v172, s[8:11], s38 offen offset:320
    s_add_u32 s38, s36, 8192
    buffer_load_dwordx4 v[116:119], v172, s[8:11], s38 offen offset:320
    ds_read_b128 v[120:123], v3 offset:10240
    s_waitcnt lgkmcnt(0)
    s_waitcnt vmcnt(1)
    v_mfma_f32_16x16x32_bf16 v[32:35], v[112:115], v[120:123], v[32:35]
    s_waitcnt vmcnt(0)
    v_mfma_f32_16x16x32_bf16 v[36:39], v[116:119], v[120:123], v[36:39]
    s_nop 3
    ds_read_b128 v[120:123], v3 offset:11264
    s_waitcnt lgkmcnt(0)
    v_mfma_f32_16x16x32_bf16 v[40:43], v[112:115], v[120:123], v[40:43]
    v_mfma_f32_16x16x32_bf16 v[44:47], v[116:119], v[120:123], v[44:47]
    s_nop 3
    ds_read_b128 v[120:123], v3 offset:12288
    s_waitcnt lgkmcnt(0)
    v_mfma_f32_16x16x32_bf16 v[48:51], v[112:115], v[120:123], v[48:51]
    v_mfma_f32_16x16x32_bf16 v[52:55], v[116:119], v[120:123], v[52:55]
    s_nop 3
    ds_read_b128 v[120:123], v3 offset:13312
    s_waitcnt lgkmcnt(0)
    v_mfma_f32_16x16x32_bf16 v[56:59], v[112:115], v[120:123], v[56:59]
    v_mfma_f32_16x16x32_bf16 v[60:63], v[116:119], v[120:123], v[60:63]
    s_nop 3
    ds_read_b128 v[120:123], v3 offset:14336
    s_waitcnt lgkmcnt(0)
    v_mfma_f32_16x16x32_bf16 v[64:67], v[112:115], v[120:123], v[64:67]
    v_mfma_f32_16x16x32_bf16 v[68:71], v[116:119], v[120:123], v[68:71]
    s_nop 3
    ds_read_b128 v[120:123], v3 offset:15360
    s_waitcnt lgkmcnt(0)
    v_mfma_f32_16x16x32_bf16 v[72:75], v[112:115], v[120:123], v[72:75]
    v_mfma_f32_16x16x32_bf16 v[76:79], v[116:119], v[120:123], v[76:79]
    s_nop 3
    ds_read_b128 v[120:123], v3 offset:16384
    s_waitcnt lgkmcnt(0)
    v_mfma_f32_16x16x32_bf16 v[80:83], v[112:115], v[120:123], v[80:83]
    v_mfma_f32_16x16x32_bf16 v[84:87], v[116:119], v[120:123], v[84:87]
    s_nop 3
    ds_read_b128 v[120:123], v3 offset:17408
    s_waitcnt lgkmcnt(0)
    v_mfma_f32_16x16x32_bf16 v[88:91], v[112:115], v[120:123], v[88:91]
    v_mfma_f32_16x16x32_bf16 v[92:95], v[116:119], v[120:123], v[92:95]
    s_nop 3
    ds_read_b128 v[120:123], v3 offset:18432
    s_waitcnt lgkmcnt(0)
    v_mfma_f32_16x16x32_bf16 v[96:99], v[112:115], v[120:123], v[96:99]
    v_mfma_f32_16x16x32_bf16 v[100:103], v[116:119], v[120:123], v[100:103]
    s_nop 3
    ds_read_b128 v[120:123], v3 offset:19456
    s_waitcnt lgkmcnt(0)
    v_mfma_f32_16x16x32_bf16 v[104:107], v[112:115], v[120:123], v[104:107]
    v_mfma_f32_16x16x32_bf16 v[108:111], v[116:119], v[120:123], v[108:111]
    s_nop 3
    s_add_u32 s38, s36, 0
    buffer_load_dwordx4 v[112:115], v172, s[8:11], s38 offen offset:384
    s_add_u32 s38, s36, 8192
    buffer_load_dwordx4 v[116:119], v172, s[8:11], s38 offen offset:384
    ds_read_b128 v[120:123], v3 offset:20480
    s_waitcnt lgkmcnt(0)
    s_waitcnt vmcnt(1)
    v_mfma_f32_16x16x32_bf16 v[32:35], v[112:115], v[120:123], v[32:35]
    s_waitcnt vmcnt(0)
    v_mfma_f32_16x16x32_bf16 v[36:39], v[116:119], v[120:123], v[36:39]
    s_nop 3
    ds_read_b128 v[120:123], v3 offset:21504
    s_waitcnt lgkmcnt(0)
    v_mfma_f32_16x16x32_bf16 v[40:43], v[112:115], v[120:123], v[40:43]
    v_mfma_f32_16x16x32_bf16 v[44:47], v[116:119], v[120:123], v[44:47]
    s_nop 3
    ds_read_b128 v[120:123], v3 offset:22528
    s_waitcnt lgkmcnt(0)
    v_mfma_f32_16x16x32_bf16 v[48:51], v[112:115], v[120:123], v[48:51]
    v_mfma_f32_16x16x32_bf16 v[52:55], v[116:119], v[120:123], v[52:55]
    s_nop 3
    ds_read_b128 v[120:123], v3 offset:23552
    s_waitcnt lgkmcnt(0)
    v_mfma_f32_16x16x32_bf16 v[56:59], v[112:115], v[120:123], v[56:59]
    v_mfma_f32_16x16x32_bf16 v[60:63], v[116:119], v[120:123], v[60:63]
    s_nop 3
    ds_read_b128 v[120:123], v3 offset:24576
    s_waitcnt lgkmcnt(0)
    v_mfma_f32_16x16x32_bf16 v[64:67], v[112:115], v[120:123], v[64:67]
    v_mfma_f32_16x16x32_bf16 v[68:71], v[116:119], v[120:123], v[68:71]
    s_nop 3
    ds_read_b128 v[120:123], v3 offset:25600
    s_waitcnt lgkmcnt(0)
    v_mfma_f32_16x16x32_bf16 v[72:75], v[112:115], v[120:123], v[72:75]
    v_mfma_f32_16x16x32_bf16 v[76:79], v[116:119], v[120:123], v[76:79]
    s_nop 3
    ds_read_b128 v[120:123], v3 offset:26624
    s_waitcnt lgkmcnt(0)
    v_mfma_f32_16x16x32_bf16 v[80:83], v[112:115], v[120:123], v[80:83]
    v_mfma_f32_16x16x32_bf16 v[84:87], v[116:119], v[120:123], v[84:87]
    s_nop 3
    ds_read_b128 v[120:123], v3 offset:27648
    s_waitcnt lgkmcnt(0)
    v_mfma_f32_16x16x32_bf16 v[88:91], v[112:115], v[120:123], v[88:91]
    v_mfma_f32_16x16x32_bf16 v[92:95], v[116:119], v[120:123], v[92:95]
    s_nop 3
    ds_read_b128 v[120:123], v3 offset:28672
    s_waitcnt lgkmcnt(0)
    v_mfma_f32_16x16x32_bf16 v[96:99], v[112:115], v[120:123], v[96:99]
    v_mfma_f32_16x16x32_bf16 v[100:103], v[116:119], v[120:123], v[100:103]
    s_nop 3
    ds_read_b128 v[120:123], v3 offset:29696
    s_waitcnt lgkmcnt(0)
    v_mfma_f32_16x16x32_bf16 v[104:107], v[112:115], v[120:123], v[104:107]
    v_mfma_f32_16x16x32_bf16 v[108:111], v[116:119], v[120:123], v[108:111]
    s_nop 3
    s_add_u32 s38, s36, 0
    buffer_load_dwordx4 v[112:115], v172, s[8:11], s38 offen offset:448
    s_add_u32 s38, s36, 8192
    buffer_load_dwordx4 v[116:119], v172, s[8:11], s38 offen offset:448
    ds_read_b128 v[120:123], v3 offset:30720
    s_waitcnt lgkmcnt(0)
    s_waitcnt vmcnt(1)
    v_mfma_f32_16x16x32_bf16 v[32:35], v[112:115], v[120:123], v[32:35]
    s_waitcnt vmcnt(0)
    v_mfma_f32_16x16x32_bf16 v[36:39], v[116:119], v[120:123], v[36:39]
    s_nop 3
    ds_read_b128 v[120:123], v3 offset:31744
    s_waitcnt lgkmcnt(0)
    v_mfma_f32_16x16x32_bf16 v[40:43], v[112:115], v[120:123], v[40:43]
    v_mfma_f32_16x16x32_bf16 v[44:47], v[116:119], v[120:123], v[44:47]
    s_nop 3
    ds_read_b128 v[120:123], v3 offset:32768
    s_waitcnt lgkmcnt(0)
    v_mfma_f32_16x16x32_bf16 v[48:51], v[112:115], v[120:123], v[48:51]
    v_mfma_f32_16x16x32_bf16 v[52:55], v[116:119], v[120:123], v[52:55]
    s_nop 3
    ds_read_b128 v[120:123], v3 offset:33792
    s_waitcnt lgkmcnt(0)
    v_mfma_f32_16x16x32_bf16 v[56:59], v[112:115], v[120:123], v[56:59]
    v_mfma_f32_16x16x32_bf16 v[60:63], v[116:119], v[120:123], v[60:63]
    s_nop 3
    ds_read_b128 v[120:123], v3 offset:34816
    s_waitcnt lgkmcnt(0)
    v_mfma_f32_16x16x32_bf16 v[64:67], v[112:115], v[120:123], v[64:67]
    v_mfma_f32_16x16x32_bf16 v[68:71], v[116:119], v[120:123], v[68:71]
    s_nop 3
    ds_read_b128 v[120:123], v3 offset:35840
    s_waitcnt lgkmcnt(0)
    v_mfma_f32_16x16x32_bf16 v[72:75], v[112:115], v[120:123], v[72:75]
    v_mfma_f32_16x16x32_bf16 v[76:79], v[116:119], v[120:123], v[76:79]
    s_nop 3
    ds_read_b128 v[120:123], v3 offset:36864
    s_waitcnt lgkmcnt(0)
    v_mfma_f32_16x16x32_bf16 v[80:83], v[112:115], v[120:123], v[80:83]
    v_mfma_f32_16x16x32_bf16 v[84:87], v[116:119], v[120:123], v[84:87]
    s_nop 3
    ds_read_b128 v[120:123], v3 offset:37888
    s_waitcnt lgkmcnt(0)
    v_mfma_f32_16x16x32_bf16 v[88:91], v[112:115], v[120:123], v[88:91]
    v_mfma_f32_16x16x32_bf16 v[92:95], v[116:119], v[120:123], v[92:95]
    s_nop 3
    ds_read_b128 v[120:123], v3 offset:38912
    s_waitcnt lgkmcnt(0)
    v_mfma_f32_16x16x32_bf16 v[96:99], v[112:115], v[120:123], v[96:99]
    v_mfma_f32_16x16x32_bf16 v[100:103], v[116:119], v[120:123], v[100:103]
    s_nop 3
    ds_read_b128 v[120:123], v3 offset:39936
    s_waitcnt lgkmcnt(0)
    v_mfma_f32_16x16x32_bf16 v[104:107], v[112:115], v[120:123], v[104:107]
    v_mfma_f32_16x16x32_bf16 v[108:111], v[116:119], v[120:123], v[108:111]
    s_nop 3
    v_max3_f32 v21, v21, v32, v33
    v_max3_f32 v21, v21, v34, v35
    v_max3_f32 v21, v21, v36, v37
    v_max3_f32 v21, v21, v38, v39
    v_max3_f32 v22, v22, v40, v41
    v_max3_f32 v22, v22, v42, v43
    v_max3_f32 v22, v22, v44, v45
    v_max3_f32 v22, v22, v46, v47
    v_max3_f32 v23, v23, v48, v49
    v_max3_f32 v23, v23, v50, v51
    v_max3_f32 v23, v23, v52, v53
    v_max3_f32 v23, v23, v54, v55
    v_max3_f32 v24, v24, v56, v57
    v_max3_f32 v24, v24, v58, v59
    v_max3_f32 v24, v24, v60, v61
    v_max3_f32 v24, v24, v62, v63
    v_max3_f32 v25, v25, v64, v65
    v_max3_f32 v25, v25, v66, v67
    v_max3_f32 v25, v25, v68, v69
    v_max3_f32 v25, v25, v70, v71
    v_max3_f32 v26, v26, v72, v73
    v_max3_f32 v26, v26, v74, v75
    v_max3_f32 v26, v26, v76, v77
    v_max3_f32 v26, v26, v78, v79
    v_max3_f32 v27, v27, v80, v81
    v_max3_f32 v27, v27, v82, v83
    v_max3_f32 v27, v27, v84, v85
    v_max3_f32 v27, v27, v86, v87
    v_max3_f32 v28, v28, v88, v89
    v_max3_f32 v28, v28, v90, v91
    v_max3_f32 v28, v28, v92, v93
    v_max3_f32 v28, v28, v94, v95
    v_max3_f32 v29, v29, v96, v97
    v_max3_f32 v29, v29, v98, v99
    v_max3_f32 v29, v29, v100, v101
    v_max3_f32 v29, v29, v102, v103
    v_max3_f32 v30, v30, v104, v105
    v_max3_f32 v30, v30, v106, v107
    v_max3_f32 v30, v30, v108, v109
    v_max3_f32 v30, v30, v110, v111
    s_add_u32 s36, s36, 65536
    s_cmp_lt_u32 s36, 0x40000
    s_cbranch_scc1 L_sweep
    s_nop 7
    v_mov_b32 v112, v21
    s_nop 1
    v_permlane32_swap_b32 v112, v21
    v_max_f32 v21, v112, v21
    v_mov_b32 v113, v22
    s_nop 1
    v_permlane32_swap_b32 v113, v22
    v_max_f32 v22, v113, v22
    v_mov_b32 v114, v23
    s_nop 1
    v_permlane32_swap_b32 v114, v23
    v_max_f32 v23, v114, v23
    v_mov_b32 v115, v24
    s_nop 1
    v_permlane32_swap_b32 v115, v24
    v_max_f32 v24, v115, v24
    v_mov_b32 v116, v25
    s_nop 1
    v_permlane32_swap_b32 v116, v25
    v_max_f32 v25, v116, v25
    v_mov_b32 v117, v26
    s_nop 1
    v_permlane32_swap_b32 v117, v26
    v_max_f32 v26, v117, v26
    v_mov_b32 v118, v27
    s_nop 1
    v_permlane32_swap_b32 v118, v27
    v_max_f32 v27, v118, v27
    v_mov_b32 v119, v28
    s_nop 1
    v_permlane32_swap_b32 v119, v28
    v_max_f32 v28, v119, v28
    v_mov_b32 v120, v29
    s_nop 1
    v_permlane32_swap_b32 v120, v29
    v_max_f32 v29, v120, v29
    v_mov_b32 v121, v30
    s_nop 1
    v_permlane32_swap_b32 v121, v30
    v_max_f32 v30, v121, v30
    v_mov_b32 v112, v21
    s_nop 1
    v_permlane16_swap_b32 v112, v21
    v_max_f32 v21, v112, v21
    v_mov_b32 v113, v22
    s_nop 1
    v_permlane16_swap_b32 v113, v22
    v_max_f32 v22, v113, v22
    v_mov_b32 v114, v23
    s_nop 1
    v_permlane16_swap_b32 v114, v23
    v_max_f32 v23, v114, v23
    v_mov_b32 v115, v24
    s_nop 1
    v_permlane16_swap_b32 v115, v24
    v_max_f32 v24, v115, v24
    v_mov_b32 v116, v25
    s_nop 1
    v_permlane16_swap_b32 v116, v25
    v_max_f32 v25, v116, v25
    v_mov_b32 v117, v26
    s_nop 1
    v_permlane16_swap_b32 v117, v26
    v_max_f32 v26, v117, v26
    v_mov_b32 v118, v27
    s_nop 1
    v_permlane16_swap_b32 v118, v27
    v_max_f32 v27, v118, v27
    v_mov_b32 v119, v28
    s_nop 1
    v_permlane16_swap_b32 v119, v28
    v_max_f32 v28, v119, v28
    v_mov_b32 v120, v29
    s_nop 1
    v_permlane16_swap_b32 v120, v29
    v_max_f32 v29, v120, v29
    v_mov_b32 v121, v30
    s_nop 1
    v_permlane16_swap_b32 v121, v30
    v_max_f32 v30, v121, v30
    s_nop 7
L_nosweep:
    ds_read_b128 a[0:3], v2
    ds_read_b128 a[4:7], v2 offset:1024
    ds_read_b128 a[8:11], v2 offset:2048
    ds_read_b128 a[12:15], v2 offset:3072
    ds_read_b128 a[16:19], v2 offset:4096
    ds_read_b128 a[20:23], v2 offset:5120
    ds_read_b128 a[24:27], v2 offset:6144
    ds_read_b128 a[28:31], v2 offset:7168
    s_waitcnt lgkmcnt(4)
    v_mfma_f32_16x16x32_bf16 v[32:35], a[32:35], a[0:3], 0
    v_mfma_f32_16x16x32_bf16 v[36:39], a[36:39], a[0:3], 0
    ds_read_b128 a[0:3], v2 offset:8192
    v_mfma_f32_16x16x32_bf16 v[40:43], a[32:35], a[4:7], 0
    v_mfma_f32_16x16x32_bf16 v[44:47], a[36:39], a[4:7], 0
    ds_read_b128 a[4:7], v2 offset:9216
    v_mfma_f32_16x16x32_bf16 v[48:51], a[32:35], a[8:11], 0
    v_mfma_f32_16x16x32_bf16 v[52:55], a[36:39], a[8:11], 0
    ds_read_b128 a[8:11], v2 offset:10240
    v_mfma_f32_16x16x32_bf16 v[56:59], a[32:35], a[12:15], 0
    v_mfma_f32_16x16x32_bf16 v[60:63], a[36:39], a[12:15], 0
    ds_read_b128 a[12:15], v2 offset:11264
    s_waitcnt lgkmcnt(4)
    v_mfma_f32_16x16x32_bf16 v[64:67], a[32:35], a[16:19], 0
    v_mfma_f32_16x16x32_bf16 v[68:71], a[36:39], a[16:19], 0
    ds_read_b128 a[16:19], v2 offset:12288
    v_mfma_f32_16x16x32_bf16 v[72:75], a[32:35], a[20:23], 0
    v_mfma_f32_16x16x32_bf16 v[76:79], a[36:39], a[20:23], 0
    ds_read_b128 a[20:23], v2 offset:13312
    v_mfma_f32_16x16x32_bf16 v[80:83], a[32:35], a[24:27], 0
    v_mfma_f32_16x16x32_bf16 v[84:87], a[36:39], a[24:27], 0
    ds_read_b128 a[24:27], v2 offset:14336
    v_mfma_f32_16x16x32_bf16 v[88:91], a[32:35], a[28:31], 0
    v_mfma_f32_16x16x32_bf16 v[92:95], a[36:39], a[28:31], 0
    ds_read_b128 a[28:31], v2 offset:15360
    s_waitcnt lgkmcnt(4)
    v_mfma_f32_16x16x32_bf16 v[96:99], a[32:35], a[0:3], 0
    v_mfma_f32_16x16x32_bf16 v[100:103], a[36:39], a[0:3], 0
    ds_read_b128 a[0:3], v2 offset:16384
    v_mfma_f32_16x16x32_bf16 v[104:107], a[32:35], a[4:7], 0
    v_mfma_f32_16x16x32_bf16 v[108:111], a[36:39], a[4:7], 0
    ds_read_b128 a[4:7], v2 offset:17408
    v_mfma_f32_16x16x32_bf16 v[32:35], a[40:43], a[8:11], v[32:35]
    v_mfma_f32_16x16x32_bf16 v[36:39], a[44:47], a[8:11], v[36:39]
    ds_read_b128 a[8:11], v2 offset:18432
    v_mfma_f32_16x16x32_bf16 v[40:43], a[40:43], a[12:15], v[40:43]
    v_mfma_f32_16x16x32_bf16 v[44:47], a[44:47], a[12:15], v[44:47]
    ds_read_b128 a[12:15], v2 offset:19456
    s_waitcnt lgkmcnt(4)
    v_mfma_f32_16x16x32_bf16 v[48:51], a[40:43], a[16:19], v[48:51]
    v_mfma_f32_16x16x32_bf16 v[52:55], a[44:47], a[16:19], v[52:55]
    ds_read_b128 a[16:19], v2 offset:20480
    v_mfma_f32_16x16x32_bf16 v[56:59], a[40:43], a[20:23], v[56:59]
    v_mfma_f32_16x16x32_bf16 v[60:63], a[44:47], a[20:23], v[60:63]
    ds_read_b128 a[20:23], v2 offset:21504
    v_mfma_f32_16x16x32_bf16 v[64:67], a[40:43], a[24:27], v[64:67]
    v_mfma_f32_16x16x32_bf16 v[68:71], a[44:47], a[24:27], v[68:71]
    ds_read_b128 a[24:27], v2 offset:22528
    v_mfma_f32_16x16x32_bf16 v[72:75], a[40:43], a[28:31], v[72:75]
    v_mfma_f32_16x16x32_bf16 v[76:79], a[44:47], a[28:31], v[76:79]
    ds_read_b128 a[28:31], v2 offset:23552
    s_waitcnt lgkmcnt(4)
    v_mfma_f32_16x16x32_bf16 v[80:83], a[40:43], a[0:3], v[80:83]
    v_mfma_f32_16x16x32_bf16 v[84:87], a[44:47], a[0:3], v[84:87]
    ds_read_b128 a[0:3], v2 offset:24576
    v_mfma_f32_16x16x32_bf16 v[88:91], a[40:43], a[4:7], v[88:91]
    v_mfma_f32_16x16x32_bf16 v[92:95], a[44:47], a[4:7], v[92:95]
    ds_read_b128 a[4:7], v2 offset:25600
    v_mfma_f32_16x16x32_bf16 v[96:99], a[40:43], a[8:11], v[96:99]
    v_mfma_f32_16x16x32_bf16 v[100:103], a[44:47], a[8:11], v[100:103]
    ds_read_b128 a[8:11], v2 offset:26624
    v_mfma_f32_16x16x32_bf16 v[104:107], a[40:43], a[12:15], v[104:107]
    v_mfma_f32_16x16x32_bf16 v[108:111], a[44:47], a[12:15], v[108:111]
    ds_read_b128 a[12:15], v2 offset:27648
    s_waitcnt lgkmcnt(4)
    v_mfma_f32_16x16x32_bf16 v[32:35], a[48:51], a[16:19], v[32:35]
    v_mfma_f32_16x16x32_bf16 v[36:39], a[52:55], a[16:19], v[36:39]
    s_waitcnt vmcnt(12)
    ds_read_b128 a[32:35], v4 offset:8192
    ds_read_b128 a[16:19], v2 offset:28672
    v_mfma_f32_16x16x32_bf16 v[40:43], a[48:51], a[20:23], v[40:43]
    ds_read_b128 a[36:39], v4 offset:10240
    ds_read_b128 a[40:43], v5 offset:8192
    ds_read_b128 a[44:47], v5 offset:10240
    v_mfma_f32_16x16x32_bf16 v[44:47], a[52:55], a[20:23], v[44:47]
    ds_read_b128 a[20:23], v2 offset:29696
    v_mfma_f32_16x16x32_bf16 v[48:51], a[48:51], a[24:27], v[48:51]
    v_mfma_f32_16x16x32_bf16 v[52:55], a[52:55], a[24:27], v[52:55]
    ds_read_b128 a[24:27], v2 offset:30720
    v_mfma_f32_16x16x32_bf16 v[56:59], a[48:51], a[28:31], v[56:59]
    v_mfma_f32_16x16x32_bf16 v[60:63], a[52:55], a[28:31], v[60:63]
    ds_read_b128 a[28:31], v2 offset:31744
    s_waitcnt lgkmcnt(8)
    v_mfma_f32_16x16x32_bf16 v[64:67], a[48:51], a[0:3], v[64:67]
    v_mfma_f32_16x16x32_bf16 v[68:71], a[52:55], a[0:3], v[68:71]
    ds_read_b128 a[0:3], v2 offset:32768
    v_mfma_f32_16x16x32_bf16 v[72:75], a[48:51], a[4:7], v[72:75]
    v_mfma_f32_16x16x32_bf16 v[76:79], a[52:55], a[4:7], v[76:79]
    ds_read_b128 a[4:7], v2 offset:33792
    v_mfma_f32_16x16x32_bf16 v[80:83], a[48:51], a[8:11], v[80:83]
    v_mfma_f32_16x16x32_bf16 v[84:87], a[52:55], a[8:11], v[84:87]
    ds_read_b128 a[8:11], v2 offset:34816
    v_mfma_f32_16x16x32_bf16 v[88:91], a[48:51], a[12:15], v[88:91]
    v_mfma_f32_16x16x32_bf16 v[92:95], a[52:55], a[12:15], v[92:95]
    ds_read_b128 a[12:15], v2 offset:35840
    s_waitcnt lgkmcnt(4)
    v_mfma_f32_16x16x32_bf16 v[96:99], a[48:51], a[16:19], v[96:99]
    v_mfma_f32_16x16x32_bf16 v[100:103], a[52:55], a[16:19], v[100:103]
    ds_read_b128 a[16:19], v2 offset:36864
    v_mfma_f32_16x16x32_bf16 v[104:107], a[48:51], a[20:23], v[104:107]
    v_mfma_f32_16x16x32_bf16 v[108:111], a[52:55], a[20:23], v[108:111]
    ds_read_b128 a[20:23], v2 offset:37888
    v_mfma_f32_16x16x32_bf16 v[32:35], a[56:59], a[24:27], v[32:35]
    v_mfma_f32_16x16x32_bf16 v[36:39], a[60:63], a[24:27], v[36:39]
    ds_read_b128 a[24:27], v2 offset:38912
    v_mfma_f32_16x16x32_bf16 v[40:43], a[56:59], a[28:31], v[40:43]
    s_add_u32 m0, s29, 8192
    s_mov_b32 s32, 131328
    buffer_load_dwordx4 v10, s[8:11], s32 offen nt lds
    v_mfma_f32_16x16x32_bf16 v[44:47], a[60:63], a[28:31], v[44:47]
    ds_read_b128 a[28:31], v2 offset:39936
    s_waitcnt lgkmcnt(4)
    v_mfma_f32_16x16x32_bf16 v[48:51], a[56:59], a[0:3], v[48:51]
    v_mfma_f32_16x16x32_bf16 v[52:55], a[60:63], a[0:3], v[52:55]
    buffer_load_dwordx4 v11, s[8:11], s32 offen offset:1024 nt lds
    ds_read_b128 a[0:3], v3
    v_mfma_f32_16x16x32_bf16 v[56:59], a[56:59], a[4:7], v[56:59]
    v_mfma_f32_16x16x32_bf16 v[60:63], a[60:63], a[4:7], v[60:63]
    ds_read_b128 a[4:7], v3 offset:1024
    v_mfma_f32_16x16x32_bf16 v[64:67], a[56:59], a[8:11], v[64:67]
    buffer_load_dwordx4 v12, s[8:11], s32 offen offset:2048 nt lds
    v_mfma_f32_16x16x32_bf16 v[68:71], a[60:63], a[8:11], v[68:71]
    ds_read_b128 a[8:11], v3 offset:2048
    v_mfma_f32_16x16x32_bf16 v[72:75], a[56:59], a[12:15], v[72:75]
    v_mfma_f32_16x16x32_bf16 v[76:79], a[60:63], a[12:15], v[76:79]
    buffer_load_dwordx4 v13, s[8:11], s32 offen offset:3072 nt lds
    ds_read_b128 a[12:15], v3 offset:3072
    s_waitcnt lgkmcnt(4)
    v_mfma_f32_16x16x32_bf16 v[80:83], a[56:59], a[16:19], v[80:83]
    v_mfma_f32_16x16x32_bf16 v[84:87], a[60:63], a[16:19], v[84:87]
    ds_read_b128 a[16:19], v3 offset:4096
    v_mfma_f32_16x16x32_bf16 v[88:91], a[56:59], a[20:23], v[88:91]
    v_mfma_f32_16x16x32_bf16 v[92:95], a[60:63], a[20:23], v[92:95]
    ds_read_b128 a[20:23], v3 offset:5120
    v_mfma_f32_16x16x32_bf16 v[96:99], a[56:59], a[24:27], v[96:99]
    v_mfma_f32_16x16x32_bf16 v[100:103], a[60:63], a[24:27], v[100:103]
    ds_read_b128 a[24:27], v3 offset:6144
    v_mfma_f32_16x16x32_bf16 v[104:107], a[56:59], a[28:31], v[104:107]
    v_mfma_f32_16x16x32_bf16 v[108:111], a[60:63], a[28:31], v[108:111]
    ds_read_b128 a[28:31], v3 offset:7168
    s_waitcnt lgkmcnt(4)
    v_mfma_f32_16x16x32_bf16 v[32:35], a[64:67], a[0:3], v[32:35]
    v_mfma_f32_16x16x32_bf16 v[36:39], a[68:71], a[0:3], v[36:39]
    s_waitcnt vmcnt(12)
    ds_read_b128 a[48:51], v4 offset:12288
    ds_read_b128 a[0:3], v3 offset:8192
    v_mfma_f32_16x16x32_bf16 v[40:43], a[64:67], a[4:7], v[40:43]
    ds_read_b128 a[52:55], v4 offset:14336
    ds_read_b128 a[56:59], v5 offset:12288
    ds_read_b128 a[60:63], v5 offset:14336
    v_mfma_f32_16x16x32_bf16 v[44:47], a[68:71], a[4:7], v[44:47]
    ds_read_b128 a[4:7], v3 offset:9216
    v_mfma_f32_16x16x32_bf16 v[48:51], a[64:67], a[8:11], v[48:51]
    v_mfma_f32_16x16x32_bf16 v[52:55], a[68:71], a[8:11], v[52:55]
    ds_read_b128 a[8:11], v3 offset:10240
    v_mfma_f32_16x16x32_bf16 v[56:59], a[64:67], a[12:15], v[56:59]
    v_mfma_f32_16x16x32_bf16 v[60:63], a[68:71], a[12:15], v[60:63]
    ds_read_b128 a[12:15], v3 offset:11264
    s_waitcnt lgkmcnt(8)
    v_mfma_f32_16x16x32_bf16 v[64:67], a[64:67], a[16:19], v[64:67]
    v_mfma_f32_16x16x32_bf16 v[68:71], a[68:71], a[16:19], v[68:71]
    ds_read_b128 a[16:19], v3 offset:12288
    v_mfma_f32_16x16x32_bf16 v[72:75], a[64:67], a[20:23], v[72:75]
    v_mfma_f32_16x16x32_bf16 v[76:79], a[68:71], a[20:23], v[76:79]
    ds_read_b128 a[20:23], v3 offset:13312
    v_mfma_f32_16x16x32_bf16 v[80:83], a[64:67], a[24:27], v[80:83]
    v_mfma_f32_16x16x32_bf16 v[84:87], a[68:71], a[24:27], v[84:87]
    ds_read_b128 a[24:27], v3 offset:14336
    v_mfma_f32_16x16x32_bf16 v[88:91], a[64:67], a[28:31], v[88:91]
    v_mfma_f32_16x16x32_bf16 v[92:95], a[68:71], a[28:31], v[92:95]
    ds_read_b128 a[28:31], v3 offset:15360
    s_waitcnt lgkmcnt(4)
    v_mfma_f32_16x16x32_bf16 v[96:99], a[64:67], a[0:3], v[96:99]
    v_mfma_f32_16x16x32_bf16 v[100:103], a[68:71], a[0:3], v[100:103]
    ds_read_b128 a[0:3], v3 offset:16384
    v_mfma_f32_16x16x32_bf16 v[104:107], a[64:67], a[4:7], v[104:107]
    v_mfma_f32_16x16x32_bf16 v[108:111], a[68:71], a[4:7], v[108:111]
    ds_read_b128 a[4:7], v3 offset:17408
    v_mfma_f32_16x16x32_bf16 v[32:35], a[72:75], a[8:11], v[32:35]
    v_mfma_f32_16x16x32_bf16 v[36:39], a[76:79], a[8:11], v[36:39]
    ds_read_b128 a[8:11], v3 offset:18432
    v_mfma_f32_16x16x32_bf16 v[40:43], a[72:75], a[12:15], v[40:43]
    s_add_u32 m0, s29, 12288
    s_mov_b32 s32, 131456
    buffer_load_dwordx4 v10, s[8:11], s32 offen nt lds
    v_mfma_f32_16x16x32_bf16 v[44:47], a[76:79], a[12:15], v[44:47]
    ds_read_b128 a[12:15], v3 offset:19456
    s_waitcnt lgkmcnt(4)
    v_mfma_f32_16x16x32_bf16 v[48:51], a[72:75], a[16:19], v[48:51]
    v_mfma_f32_16x16x32_bf16 v[52:55], a[76:79], a[16:19], v[52:55]
    buffer_load_dwordx4 v11, s[8:11], s32 offen offset:1024 nt lds
    ds_read_b128 a[16:19], v3 offset:20480
    v_mfma_f32_16x16x32_bf16 v[56:59], a[72:75], a[20:23], v[56:59]
    v_mfma_f32_16x16x32_bf16 v[60:63], a[76:79], a[20:23], v[60:63]
    ds_read_b128 a[20:23], v3 offset:21504
    v_mfma_f32_16x16x32_bf16 v[64:67], a[72:75], a[24:27], v[64:67]
    buffer_load_dwordx4 v12, s[8:11], s32 offen offset:2048 nt lds
    v_mfma_f32_16x16x32_bf16 v[68:71], a[76:79], a[24:27], v[68:71]
    ds_read_b128 a[24:27], v3 offset:22528
    v_mfma_f32_16x16x32_bf16 v[72:75], a[72:75], a[28:31], v[72:75]
    v_mfma_f32_16x16x32_bf16 v[76:79], a[76:79], a[28:31], v[76:79]
    buffer_load_dwordx4 v13, s[8:11], s32 offen offset:3072 nt lds
    ds_read_b128 a[28:31], v3 offset:23552
    s_waitcnt lgkmcnt(4)
    v_mfma_f32_16x16x32_bf16 v[80:83], a[72:75], a[0:3], v[80:83]
    v_mfma_f32_16x16x32_bf16 v[84:87], a[76:79], a[0:3], v[84:87]
    ds_read_b128 a[0:3], v3 offset:24576
    v_mfma_f32_16x16x32_bf16 v[88:91], a[72:75], a[4:7], v[88:91]
    v_mfma_f32_16x16x32_bf16 v[92:95], a[76:79], a[4:7], v[92:95]
    ds_read_b128 a[4:7], v3 offset:25600
    v_mfma_f32_16x16x32_bf16 v[96:99], a[72:75], a[8:11], v[96:99]
    v_mfma_f32_16x16x32_bf16 v[100:103], a[76:79], a[8:11], v[100:103]
    ds_read_b128 a[8:11], v3 offset:26624
    v_mfma_f32_16x16x32_bf16 v[104:107], a[72:75], a[12:15], v[104:107]
    v_mfma_f32_16x16x32_bf16 v[108:111], a[76:79], a[12:15], v[108:111]
    ds_read_b128 a[12:15], v3 offset:27648
    s_waitcnt lgkmcnt(4)
    v_mfma_f32_16x16x32_bf16 v[32:35], a[80:83], a[16:19], v[32:35]
    v_mfma_f32_16x16x32_bf16 v[36:39], a[84:87], a[16:19], v[36:39]
    s_waitcnt vmcnt(12)
    ds_read_b128 a[64:67], v4
    ds_read_b128 a[68:71], v4 offset:2048
    ds_read_b128 a[16:19], v3 offset:28672
    v_mfma_f32_16x16x32_bf16 v[40:43], a[80:83], a[20:23], v[40:43]
    ds_read_b128 a[72:75], v5
    ds_read_b128 a[76:79], v5 offset:2048
    v_mfma_f32_16x16x32_bf16 v[44:47], a[84:87], a[20:23], v[44:47]
    ds_read_b128 a[20:23], v3 offset:29696
    v_mfma_f32_16x16x32_bf16 v[48:51], a[80:83], a[24:27], v[48:51]
    v_mfma_f32_16x16x32_bf16 v[52:55], a[84:87], a[24:27], v[52:55]
    ds_read_b128 a[24:27], v3 offset:30720
    v_mfma_f32_16x16x32_bf16 v[56:59], a[80:83], a[28:31], v[56:59]
    v_mfma_f32_16x16x32_bf16 v[60:63], a[84:87], a[28:31], v[60:63]
    ds_read_b128 a[28:31], v3 offset:31744
    s_waitcnt lgkmcnt(8)
    v_mfma_f32_16x16x32_bf16 v[64:67], a[80:83], a[0:3], v[64:67]
    v_mfma_f32_16x16x32_bf16 v[68:71], a[84:87], a[0:3], v[68:71]
    ds_read_b128 a[0:3], v3 offset:32768
    v_mfma_f32_16x16x32_bf16 v[72:75], a[80:83], a[4:7], v[72:75]
    v_mfma_f32_16x16x32_bf16 v[76:79], a[84:87], a[4:7], v[76:79]
    ds_read_b128 a[4:7], v3 offset:33792
    v_mfma_f32_16x16x32_bf16 v[80:83], a[80:83], a[8:11], v[80:83]
    v_mfma_f32_16x16x32_bf16 v[84:87], a[84:87], a[8:11], v[84:87]
    ds_read_b128 a[8:11], v3 offset:34816
    v_mfma_f32_16x16x32_bf16 v[88:91], a[80:83], a[12:15], v[88:91]
    v_mfma_f32_16x16x32_bf16 v[92:95], a[84:87], a[12:15], v[92:95]
    ds_read_b128 a[12:15], v3 offset:35840
    s_waitcnt lgkmcnt(4)
    v_mfma_f32_16x16x32_bf16 v[96:99], a[80:83], a[16:19], v[96:99]
    v_mfma_f32_16x16x32_bf16 v[100:103], a[84:87], a[16:19], v[100:103]
    ds_read_b128 a[16:19], v3 offset:36864
    v_mfma_f32_16x16x32_bf16 v[104:107], a[80:83], a[20:23], v[104:107]
    v_mfma_f32_16x16x32_bf16 v[108:111], a[84:87], a[20:23], v[108:111]
    ds_read_b128 a[20:23], v3 offset:37888
    v_mfma_f32_16x16x32_bf16 v[32:35], a[88:91], a[24:27], v[32:35]
    v_mfma_f32_16x16x32_bf16 v[36:39], a[92:95], a[24:27], v[36:39]
    ds_read_b128 a[24:27], v3 offset:38912
    v_mfma_f32_16x16x32_bf16 v[40:43], a[88:91], a[28:31], v[40:43]
    s_add_u32 m0, s29, 0
    s_mov_b32 s32, 196608
    buffer_load_dwordx4 v10, s[8:11], s32 offen nt lds
    v_mfma_f32_16x16x32_bf16 v[44:47], a[92:95], a[28:31], v[44:47]
    ds_read_b128 a[28:31], v3 offset:39936
    s_waitcnt lgkmcnt(4)
    v_mfma_f32_16x16x32_bf16 v[48:51], a[88:91], a[0:3], v[48:51]
    v_mfma_f32_16x16x32_bf16 v[52:55], a[92:95], a[0:3], v[52:55]
    buffer_load_dwordx4 v11, s[8:11], s32 offen offset:1024 nt lds
    ds_read_b128 a[0:3], v2
    v_mfma_f32_16x16x32_bf16 v[56:59], a[88:91], a[4:7], v[56:59]
    v_mfma_f32_16x16x32_bf16 v[60:63], a[92:95], a[4:7], v[60:63]
    ds_read_b128 a[4:7], v2 offset:1024
    v_mfma_f32_16x16x32_bf16 v[64:67], a[88:91], a[8:11], v[64:67]
    buffer_load_dwordx4 v12, s[8:11], s32 offen offset:2048 nt lds
    v_mfma_f32_16x16x32_bf16 v[68:71], a[92:95], a[8:11], v[68:71]
    ds_read_b128 a[8:11], v2 offset:2048
    v_mfma_f32_16x16x32_bf16 v[72:75], a[88:91], a[12:15], v[72:75]
    v_mfma_f32_16x16x32_bf16 v[76:79], a[92:95], a[12:15], v[76:79]
    buffer_load_dwordx4 v13, s[8:11], s32 offen offset:3072 nt lds
    ds_read_b128 a[12:15], v2 offset:3072
    s_waitcnt lgkmcnt(4)
    v_mfma_f32_16x16x32_bf16 v[80:83], a[88:91], a[16:19], v[80:83]
    v_mfma_f32_16x16x32_bf16 v[84:87], a[92:95], a[16:19], v[84:87]
    ds_read_b128 a[16:19], v2 offset:4096
    v_mfma_f32_16x16x32_bf16 v[88:91], a[88:91], a[20:23], v[88:91]
    v_mfma_f32_16x16x32_bf16 v[92:95], a[92:95], a[20:23], v[92:95]
    ds_read_b128 a[20:23], v2 offset:5120
    v_mfma_f32_16x16x32_bf16 v[96:99], a[88:91], a[24:27], v[96:99]
    v_mfma_f32_16x16x32_bf16 v[100:103], a[92:95], a[24:27], v[100:103]
    ds_read_b128 a[24:27], v2 offset:6144
    v_mfma_f32_16x16x32_bf16 v[104:107], a[88:91], a[28:31], v[104:107]
    v_mfma_f32_16x16x32_bf16 v[108:111], a[92:95], a[28:31], v[108:111]
    ds_read_b128 a[28:31], v2 offset:7168
    s_waitcnt lgkmcnt(4)
    v_mfma_f32_16x16x32_bf16 v[176:179], a[136:139], a[0:3], 0
    v_mfma_f32_16x16x32_bf16 v[180:183], a[140:143], a[0:3], 0
    s_waitcnt vmcnt(12)
    ds_read_b128 a[80:83], v4 offset:4096
    ds_read_b128 a[84:87], v4 offset:6144
    ds_read_b128 a[0:3], v2 offset:8192
    v_mfma_f32_16x16x32_bf16 v[184:187], a[136:139], a[4:7], 0
    v_max3_f32 v21, v21, v32, v33
    v_max3_f32 v22, v22, v40, v41
    ds_read_b128 a[88:91], v5 offset:4096
    v_max3_f32 v23, v23, v48, v49
    v_mfma_f32_16x16x32_bf16 v[188:191], a[140:143], a[4:7], 0
    ds_read_b128 a[92:95], v5 offset:6144
    v_max3_f32 v24, v24, v56, v57
    ds_read_b128 a[4:7], v2 offset:9216
    v_mfma_f32_16x16x32_bf16 v[192:195], a[136:139], a[8:11], 0
    v_max3_f32 v25, v25, v64, v65
    v_max3_f32 v26, v26, v72, v73
    v_max3_f32 v27, v27, v80, v81
    v_mfma_f32_16x16x32_bf16 v[196:199], a[140:143], a[8:11], 0
    v_max3_f32 v28, v28, v88, v89
    v_max3_f32 v29, v29, v96, v97
    v_max3_f32 v30, v30, v104, v105
    ds_read_b128 a[8:11], v2 offset:10240
    v_mfma_f32_16x16x32_bf16 v[200:203], a[136:139], a[12:15], 0
    ds_write_b32 v31, v21
    ds_write_b32 v31, v22 offset:256
    ds_write_b32 v31, v23 offset:512
    ds_write_b32 v31, v24 offset:768
    ds_write_b32 v31, v25 offset:1024
    v_mfma_f32_16x16x32_bf16 v[204:207], a[140:143], a[12:15], 0
    ds_write_b32 v31, v26 offset:1280
    ds_write_b32 v31, v27 offset:1536
    ds_read_b128 a[12:15], v2 offset:11264
    s_waitcnt lgkmcnt(15)
    v_mfma_f32_16x16x32_bf16 v[208:211], a[136:139], a[16:19], 0
    ds_write_b32 v31, v28 offset:1792
    ds_write_b32 v31, v29 offset:2048
    ds_write_b32 v31, v30 offset:2304
    v_mfma_f32_16x16x32_bf16 v[212:215], a[140:143], a[16:19], 0
    ds_read_b128 a[16:19], v2 offset:12288
    v_mfma_f32_16x16x32_bf16 v[216:219], a[136:139], a[20:23], 0
    v_mfma_f32_16x16x32_bf16 v[220:223], a[140:143], a[20:23], 0
    ds_read_b128 a[20:23], v2 offset:13312
    v_mfma_f32_16x16x32_bf16 v[224:227], a[136:139], a[24:27], 0
    v_mfma_f32_16x16x32_bf16 v[228:231], a[140:143], a[24:27], 0
    ds_read_b128 a[24:27], v2 offset:14336
    v_mfma_f32_16x16x32_bf16 v[232:235], a[136:139], a[28:31], 0
    v_mfma_f32_16x16x32_bf16 v[236:239], a[140:143], a[28:31], 0
    ds_read_b128 a[28:31], v2 offset:15360
    s_waitcnt lgkmcnt(7)
    v_mfma_f32_16x16x32_bf16 v[240:243], a[136:139], a[0:3], 0
    v_mfma_f32_16x16x32_bf16 v[244:247], a[140:143], a[0:3], 0
    ds_read_b128 a[0:3], v2 offset:16384
    v_mfma_f32_16x16x32_bf16 v[248:251], a[136:139], a[4:7], 0
    v_mfma_f32_16x16x32_bf16 v[252:255], a[140:143], a[4:7], 0
    ds_read_b128 a[4:7], v2 offset:17408
    v_mfma_f32_16x16x32_bf16 v[176:179], a[144:147], a[8:11], v[176:179]
    v_mfma_f32_16x16x32_bf16 v[180:183], a[148:151], a[8:11], v[180:183]
    ds_read_b128 a[8:11], v2 offset:18432
    v_mfma_f32_16x16x32_bf16 v[184:187], a[144:147], a[12:15], v[184:187]
    s_add_u32 m0, s29, 4096
    s_mov_b32 s32, 196736
    buffer_load_dwordx4 v10, s[8:11], s32 offen nt lds
    v_mfma_f32_16x16x32_bf16 v[188:191], a[148:151], a[12:15], v[188:191]
    ds_read_b128 a[12:15], v2 offset:19456
    s_waitcnt lgkmcnt(4)
    v_mfma_f32_16x16x32_bf16 v[192:195], a[144:147], a[16:19], v[192:195]
    v_mfma_f32_16x16x32_bf16 v[196:199], a[148:151], a[16:19], v[196:199]
    buffer_load_dwordx4 v11, s[8:11], s32 offen offset:1024 nt lds
    ds_read_b128 a[16:19], v2 offset:20480
    v_mfma_f32_16x16x32_bf16 v[200:203], a[144:147], a[20:23], v[200:203]
    v_mfma_f32_16x16x32_bf16 v[204:207], a[148:151], a[20:23], v[204:207]
    s_waitcnt lgkmcnt(0)
    s_barrier
    ds_read_b128 a[20:23], v2 offset:21504
    v_mfma_f32_16x16x32_bf16 v[208:211], a[144:147], a[24:27], v[208:211]
    buffer_load_dwordx4 v12, s[8:11], s32 offen offset:2048 nt lds
    v_mfma_f32_16x16x32_bf16 v[212:215], a[148:151], a[24:27], v[212:215]
    ds_read_b128 v[112:115], v19
    ds_read_b128 v[116:119], v19 offset:256
    ds_read_b128 v[120:123], v19 offset:512
    ds_read_b128 a[24:27], v2 offset:22528
    v_mfma_f32_16x16x32_bf16 v[216:219], a[144:147], a[28:31], v[216:219]
    ds_read_b128 v[124:127], v19 offset:768
    ds_read_b128 v[128:131], v19 offset:1024
    ds_read_b128 v[132:135], v19 offset:1280
    ds_read_b128 v[136:139], v19 offset:1536
    ds_read_b128 v[140:143], v19 offset:1792
    v_mfma_f32_16x16x32_bf16 v[220:223], a[148:151], a[28:31], v[220:223]
    buffer_load_dwordx4 v13, s[8:11], s32 offen offset:3072 nt lds
    ds_read_b128 a[28:31], v2 offset:23552
    v_mfma_f32_16x16x32_bf16 v[224:227], a[144:147], a[0:3], v[224:227]
    ds_read_b128 v[144:147], v19 offset:2048
    ds_read_b128 v[148:151], v19 offset:2304
    s_waitcnt lgkmcnt(11)
    v_max3_f32 v21, v112, v113, v114
    v_mfma_f32_16x16x32_bf16 v[228:231], a[148:151], a[0:3], v[228:231]
    v_max_f32 v21, v21, v115
    v_mul_f32 v21, s34, v21
    s_waitcnt lgkmcnt(10)
    v_max3_f32 v22, v116, v117, v118
    ds_read_b128 a[0:3], v2 offset:24576
    v_mfma_f32_16x16x32_bf16 v[232:235], a[144:147], a[4:7], v[232:235]
    v_max_f32 v22, v22, v119
    v_mul_f32 v22, s34, v22
    s_waitcnt lgkmcnt(10)
    v_max3_f32 v23, v120, v121, v122
    v_max_f32 v23, v23, v123
    v_mul_f32 v23, s34, v23
    v_mfma_f32_16x16x32_bf16 v[236:239], a[148:151], a[4:7], v[236:239]
    s_waitcnt lgkmcnt(8)
    v_max3_f32 v24, v124, v125, v126
    v_max_f32 v24, v24, v127
    v_mul_f32 v24, s34, v24
    ds_read_b128 a[4:7], v2 offset:25600
    v_mfma_f32_16x16x32_bf16 v[240:243], a[144:147], a[8:11], v[240:243]
    s_waitcnt lgkmcnt(8)
    v_max3_f32 v25, v128, v129, v130
    v_max_f32 v25, v25, v131
    v_mul_f32 v25, s34, v25
    s_waitcnt lgkmcnt(7)
    v_max3_f32 v26, v132, v133, v134
    v_max_f32 v26, v26, v135
    v_mfma_f32_16x16x32_bf16 v[244:247], a[148:151], a[8:11], v[244:247]
    v_mul_f32 v26, s34, v26
    s_waitcnt lgkmcnt(6)
    v_max3_f32 v27, v136, v137, v138
    v_max_f32 v27, v27, v139
    ds_read_b128 a[8:11], v2 offset:26624
    v_mfma_f32_16x16x32_bf16 v[248:251], a[144:147], a[12:15], v[248:251]
    v_mul_f32 v27, s34, v27
    s_waitcnt lgkmcnt(6)
    v_max3_f32 v28, v140, v141, v142
    v_max_f32 v28, v28, v143
    v_mul_f32 v28, s34, v28
    s_waitcnt lgkmcnt(4)
    v_max3_f32 v29, v144, v145, v146
    v_mfma_f32_16x16x32_bf16 v[252:255], a[148:151], a[12:15], v[252:255]
    v_max_f32 v29, v29, v147
    v_mul_f32 v29, s34, v29
    ds_read_b128 a[12:15], v2 offset:27648
    v_mfma_f32_16x16x32_bf16 v[176:179], a[152:155], a[16:19], v[176:179]
    s_waitcnt lgkmcnt(4)
    v_max3_f32 v30, v148, v149, v150
    v_max_f32 v30, v30, v151
    v_mul_f32 v30, s34, v30
    v_mfma_f32_16x16x32_bf16 v[180:183], a[156:159], a[16:19], v[180:183]
    s_waitcnt vmcnt(12)
    ds_read_b128 a[136:139], v4 offset:8192
    ds_read_b128 a[140:143], v4 offset:10240
    ds_read_b128 a[16:19], v2 offset:28672
    v_mfma_f32_16x16x32_bf16 v[184:187], a[152:155], a[20:23], v[184:187]
    ds_read_b128 a[144:147], v5 offset:8192
    ds_read_b128 a[148:151], v5 offset:10240
    v_mfma_f32_16x16x32_bf16 v[188:191], a[156:159], a[20:23], v[188:191]
    ds_read_b128 a[20:23], v2 offset:29696
    v_mfma_f32_16x16x32_bf16 v[192:195], a[152:155], a[24:27], v[192:195]
    v_fma_f32 v32, v32, s34, -v21
    v_fma_f32 v33, v33, s34, -v21
    v_fma_f32 v34, v34, s34, -v21
    v_exp_f32 v32, v32
    v_mfma_f32_16x16x32_bf16 v[196:199], a[156:159], a[24:27], v[196:199]
    v_fma_f32 v35, v35, s34, -v21
    v_exp_f32 v33, v33
    ds_read_b128 a[24:27], v2 offset:30720
    v_mfma_f32_16x16x32_bf16 v[200:203], a[152:155], a[28:31], v[200:203]
    v_fma_f32 v36, v36, s34, -v21
    v_exp_f32 v34, v34
    v_add_f32 v152, v152, v32
    v_fma_f32 v37, v37, s34, -v21
    v_mfma_f32_16x16x32_bf16 v[204:207], a[156:159], a[28:31], v[204:207]
    v_exp_f32 v35, v35
    ds_read_b128 a[28:31], v2 offset:31744
    s_waitcnt lgkmcnt(8)
    v_mfma_f32_16x16x32_bf16 v[208:211], a[152:155], a[0:3], v[208:211]
    v_add_f32 v152, v152, v33
    v_fma_f32 v38, v38, s34, -v21
    v_exp_f32 v36, v36
    v_add_f32 v152, v152, v34
    v_mfma_f32_16x16x32_bf16 v[212:215], a[156:159], a[0:3], v[212:215]
    v_cvt_pk_bf16_f32 v112, v32, v33
    v_fma_f32 v39, v39, s34, -v21
    ds_read_b128 a[0:3], v2 offset:32768
    v_mfma_f32_16x16x32_bf16 v[216:219], a[152:155], a[4:7], v[216:219]
    v_exp_f32 v37, v37
    v_add_f32 v152, v152, v35
    v_fma_f32 v40, v40, s34, -v22
    v_mfma_f32_16x16x32_bf16 v[220:223], a[156:159], a[4:7], v[220:223]
    v_exp_f32 v38, v38
    v_add_f32 v152, v152, v36
    v_cvt_pk_bf16_f32 v113, v34, v35
    ds_read_b128 a[4:7], v2 offset:33792
    v_mfma_f32_16x16x32_bf16 v[224:227], a[152:155], a[8:11], v[224:227]
    v_fma_f32 v41, v41, s34, -v22
    v_exp_f32 v39, v39
    v_add_f32 v152, v152, v37
    v_fma_f32 v42, v42, s34, -v22
    v_mfma_f32_16x16x32_bf16 v[228:231], a[156:159], a[8:11], v[228:231]
    v_exp_f32 v40, v40
    v_add_f32 v152, v152, v38
    ds_read_b128 a[8:11], v2 offset:34816
    v_mfma_f32_16x16x32_bf16 v[232:235], a[152:155], a[12:15], v[232:235]
    v_cvt_pk_bf16_f32 v114, v36, v37
    v_fma_f32 v43, v43, s34, -v22
    v_exp_f32 v41, v41
    v_mfma_f32_16x16x32_bf16 v[236:239], a[156:159], a[12:15], v[236:239]
    v_add_f32 v152, v152, v39
    v_fma_f32 v44, v44, s34, -v22
    ds_read_b128 a[12:15], v2 offset:35840
    s_waitcnt lgkmcnt(4)
    v_mfma_f32_16x16x32_bf16 v[240:243], a[152:155], a[16:19], v[240:243]
    v_exp_f32 v42, v42
    v_add_f32 v153, v153, v40
    v_cvt_pk_bf16_f32 v115, v38, v39
    v_fma_f32 v45, v45, s34, -v22
    v_mfma_f32_16x16x32_bf16 v[244:247], a[156:159], a[16:19], v[244:247]
    v_exp_f32 v43, v43
    v_add_f32 v153, v153, v41
    v_fma_f32 v46, v46, s34, -v22
    ds_read_b128 a[16:19], v2 offset:36864
    v_mfma_f32_16x16x32_bf16 v[248:251], a[152:155], a[20:23], v[248:251]
    v_exp_f32 v44, v44
    v_add_f32 v153, v153, v42
    v_cvt_pk_bf16_f32 v116, v40, v41
    v_mfma_f32_16x16x32_bf16 v[252:255], a[156:159], a[20:23], v[252:255]
    v_fma_f32 v47, v47, s34, -v22
    v_exp_f32 v45, v45
    v_add_f32 v153, v153, v43
    ds_read_b128 a[20:23], v2 offset:37888
    v_mfma_f32_16x16x32_bf16 v[176:179], a[160:163], a[24:27], v[176:179]
    v_fma_f32 v48, v48, s34, -v23
    v_exp_f32 v46, v46
    v_add_f32 v153, v153, v44
    v_mfma_f32_16x16x32_bf16 v[180:183], a[164:167], a[24:27], v[180:183]
    v_cvt_pk_bf16_f32 v117, v42, v43
    v_fma_f32 v49, v49, s34, -v23
    v_exp_f32 v47, v47
    ds_read_b128 a[24:27], v2 offset:38912
    v_mfma_f32_16x16x32_bf16 v[184:187], a[160:163], a[28:31], v[184:187]
    s_add_u32 m0, s29, 8192
    s_mov_b32 s32, 196864
    buffer_load_dwordx4 v10, s[8:11], s32 offen nt lds
    v_mfma_f32_16x16x32_bf16 v[188:191], a[164:167], a[28:31], v[188:191]
    v_add_f32 v153, v153, v45
    ds_read_b128 a[28:31], v2 offset:39936
    s_waitcnt lgkmcnt(4)
    v_mfma_f32_16x16x32_bf16 v[192:195], a[160:163], a[0:3], v[192:195]
    v_fma_f32 v50, v50, s34, -v23
    v_exp_f32 v48, v48
    v_add_f32 v153, v153, v46
    v_mfma_f32_16x16x32_bf16 v[196:199], a[164:167], a[0:3], v[196:199]
    buffer_load_dwordx4 v11, s[8:11], s32 offen offset:1024 nt lds
    ds_read_b128 a[0:3], v3
    v_mfma_f32_16x16x32_bf16 v[200:203], a[160:163], a[4:7], v[200:203]
    v_cvt_pk_bf16_f32 v118, v44, v45
    v_fma_f32 v51, v51, s34, -v23
    v_mfma_f32_16x16x32_bf16 v[204:207], a[164:167], a[4:7], v[204:207]
    v_exp_f32 v49, v49
    v_add_f32 v153, v153, v47
    v_fma_f32 v52, v52, s34, -v23
    ds_read_b128 a[4:7], v3 offset:1024
    v_mfma_f32_16x16x32_bf16 v[208:211], a[160:163], a[8:11], v[208:211]
    buffer_load_dwordx4 v12, s[8:11], s32 offen offset:2048 nt lds
    v_mfma_f32_16x16x32_bf16 v[212:215], a[164:167], a[8:11], v[212:215]
    v_exp_f32 v50, v50
    v_add_f32 v154, v154, v48
    ds_read_b128 a[8:11], v3 offset:2048
    v_mfma_f32_16x16x32_bf16 v[216:219], a[160:163], a[12:15], v[216:219]
    v_cvt_pk_bf16_f32 v119, v46, v47
    v_fma_f32 v53, v53, s34, -v23
    v_exp_f32 v51, v51
    v_mfma_f32_16x16x32_bf16 v[220:223], a[164:167], a[12:15], v[220:223]
    buffer_load_dwordx4 v13, s[8:11], s32 offen offset:3072 nt lds
    ds_read_b128 a[12:15], v3 offset:3072
    s_waitcnt lgkmcnt(4)
    v_mfma_f32_16x16x32_bf16 v[224:227], a[160:163], a[16:19], v[224:227]
    v_add_f32 v154, v154, v49
    v_fma_f32 v54, v54, s34, -v23
    v_mfma_f32_16x16x32_bf16 v[228:231], a[164:167], a[16:19], v[228:231]
    v_exp_f32 v52, v52
    v_add_f32 v154, v154, v50
    v_cvt_pk_bf16_f32 v120, v48, v49
    ds_read_b128 a[16:19], v3 offset:4096
    v_mfma_f32_16x16x32_bf16 v[232:235], a[160:163], a[20:23], v[232:235]
    v_fma_f32 v55, v55, s34, -v23
    v_exp_f32 v53, v53
    v_add_f32 v154, v154, v51
    v_mfma_f32_16x16x32_bf16 v[236:239], a[164:167], a[20:23], v[236:239]
    v_fma_f32 v56, v56, s34, -v24
    v_exp_f32 v54, v54
    v_add_f32 v154, v154, v52
    ds_read_b128 a[20:23], v3 offset:5120
    v_mfma_f32_16x16x32_bf16 v[240:243], a[160:163], a[24:27], v[240:243]
    v_cvt_pk_bf16_f32 v121, v50, v51
    v_fma_f32 v57, v57, s34, -v24
    v_exp_f32 v55, v55
    v_mfma_f32_16x16x32_bf16 v[244:247], a[164:167], a[24:27], v[244:247]
    v_add_f32 v154, v154, v53
    v_fma_f32 v58, v58, s34, -v24
    v_exp_f32 v56, v56
    ds_read_b128 a[24:27], v3 offset:6144
    v_mfma_f32_16x16x32_bf16 v[248:251], a[160:163], a[28:31], v[248:251]
    v_add_f32 v154, v154, v54
    v_cvt_pk_bf16_f32 v122, v52, v53
    v_fma_f32 v59, v59, s34, -v24
    v_mfma_f32_16x16x32_bf16 v[252:255], a[164:167], a[28:31], v[252:255]
    v_exp_f32 v57, v57
    v_add_f32 v154, v154, v55
    ds_read_b128 a[28:31], v3 offset:7168
    s_waitcnt lgkmcnt(4)
    v_mfma_f32_16x16x32_bf16 v[176:179], a[32:35], a[0:3], v[176:179]
    v_fma_f32 v60, v60, s34, -v24
    v_exp_f32 v58, v58
    v_add_f32 v155, v155, v56
    v_cvt_pk_bf16_f32 v123, v54, v55
    v_mfma_f32_16x16x32_bf16 v[180:183], a[36:39], a[0:3], v[180:183]
    s_waitcnt vmcnt(12)
    ds_read_b128 a[152:155], v4 offset:12288
    ds_read_b128 a[0:3], v3 offset:8192
    v_mfma_f32_16x16x32_bf16 v[184:187], a[32:35], a[4:7], v[184:187]
    ds_read_b128 a[156:159], v4 offset:14336
    ds_read_b128 a[160:163], v5 offset:12288
    ds_read_b128 a[164:167], v5 offset:14336
    v_mfma_f32_16x16x32_bf16 v[188:191], a[36:39], a[4:7], v[188:191]
    v_fma_f32 v61, v61, s34, -v24
    v_exp_f32 v59, v59
    ds_read_b128 a[4:7], v3 offset:9216
    v_mfma_f32_16x16x32_bf16 v[192:195], a[32:35], a[8:11], v[192:195]
    v_add_f32 v155, v155, v57
    v_fma_f32 v62, v62, s34, -v24
    v_exp_f32 v60, v60
    v_add_f32 v155, v155, v58
    v_mfma_f32_16x16x32_bf16 v[196:199], a[36:39], a[8:11], v[196:199]
    v_cvt_pk_bf16_f32 v124, v56, v57
    v_fma_f32 v63, v63, s34, -v24
    ds_read_b128 a[8:11], v3 offset:10240
    v_mfma_f32_16x16x32_bf16 v[200:203], a[32:35], a[12:15], v[200:203]
    v_exp_f32 v61, v61
    v_add_f32 v155, v155, v59
    v_fma_f32 v64, v64, s34, -v25
    v_mfma_f32_16x16x32_bf16 v[204:207], a[36:39], a[12:15], v[204:207]
    v_exp_f32 v62, v62
    v_add_f32 v155, v155, v60
    ds_read_b128 a[12:15], v3 offset:11264
    s_waitcnt lgkmcnt(8)
    v_mfma_f32_16x16x32_bf16 v[208:211], a[32:35], a[16:19], v[208:211]
    v_cvt_pk_bf16_f32 v125, v58, v59
    v_fma_f32 v65, v65, s34, -v25
    v_exp_f32 v63, v63
    v_add_f32 v155, v155, v61
    v_mfma_f32_16x16x32_bf16 v[212:215], a[36:39], a[16:19], v[212:215]
    v_fma_f32 v66, v66, s34, -v25
    v_exp_f32 v64, v64
    ds_read_b128 a[16:19], v3 offset:12288
    v_mfma_f32_16x16x32_bf16 v[216:219], a[32:35], a[20:23], v[216:219]
    v_add_f32 v155, v155, v62
    v_cvt_pk_bf16_f32 v126, v60, v61
    v_fma_f32 v67, v67, s34, -v25
    v_exp_f32 v65, v65
    v_mfma_f32_16x16x32_bf16 v[220:223], a[36:39], a[20:23], v[220:223]
    v_add_f32 v155, v155, v63
    v_fma_f32 v68, v68, s34, -v25
    ds_read_b128 a[20:23], v3 offset:13312
    v_mfma_f32_16x16x32_bf16 v[224:227], a[32:35], a[24:27], v[224:227]
    v_exp_f32 v66, v66
    v_add_f32 v156, v156, v64
    v_cvt_pk_bf16_f32 v127, v62, v63
    v_fma_f32 v69, v69, s34, -v25
    v_mfma_f32_16x16x32_bf16 v[228:231], a[36:39], a[24:27], v[228:231]
    v_exp_f32 v67, v67
    v_add_f32 v156, v156, v65
    v_fma_f32 v70, v70, s34, -v25
    ds_read_b128 a[24:27], v3 offset:14336
    v_mfma_f32_16x16x32_bf16 v[232:235], a[32:35], a[28:31], v[232:235]
    v_exp_f32 v68, v68
    v_add_f32 v156, v156, v66
    v_cvt_pk_bf16_f32 v128, v64, v65
    v_mfma_f32_16x16x32_bf16 v[236:239], a[36:39], a[28:31], v[236:239]
    v_fma_f32 v71, v71, s34, -v25
    v_exp_f32 v69, v69
    ds_read_b128 a[28:31], v3 offset:15360
    s_waitcnt lgkmcnt(4)
    v_mfma_f32_16x16x32_bf16 v[240:243], a[32:35], a[0:3], v[240:243]
    v_add_f32 v156, v156, v67
    v_fma_f32 v72, v72, s34, -v26
    v_exp_f32 v70, v70
    v_mfma_f32_16x16x32_bf16 v[244:247], a[36:39], a[0:3], v[244:247]
    v_add_f32 v156, v156, v68
    v_cvt_pk_bf16_f32 v129, v66, v67
    v_fma_f32 v73, v73, s34, -v26
    ds_read_b128 a[0:3], v3 offset:16384
    v_mfma_f32_16x16x32_bf16 v[248:251], a[32:35], a[4:7], v[248:251]
    v_exp_f32 v71, v71
    v_add_f32 v156, v156, v69
    v_fma_f32 v74, v74, s34, -v26
    v_mfma_f32_16x16x32_bf16 v[252:255], a[36:39], a[4:7], v[252:255]
    v_exp_f32 v72, v72
    v_add_f32 v156, v156, v70
    v_cvt_pk_bf16_f32 v130, v68, v69
    ds_read_b128 a[4:7], v3 offset:17408
    v_mfma_f32_16x16x32_bf16 v[176:179], a[40:43], a[8:11], v[176:179]
    v_fma_f32 v75, v75, s34, -v26
    v_exp_f32 v73, v73
    v_add_f32 v156, v156, v71
    v_fma_f32 v76, v76, s34, -v26
    v_mfma_f32_16x16x32_bf16 v[180:183], a[44:47], a[8:11], v[180:183]
    v_exp_f32 v74, v74
    v_add_f32 v157, v157, v72
    ds_read_b128 a[8:11], v3 offset:18432
    v_mfma_f32_16x16x32_bf16 v[184:187], a[40:43], a[12:15], v[184:187]
    s_add_u32 m0, s29, 12288
    s_mov_b32 s32, 196992
    buffer_load_dwordx4 v10, s[8:11], s32 offen nt lds
    v_mfma_f32_16x16x32_bf16 v[188:191], a[44:47], a[12:15], v[188:191]
    v_cvt_pk_bf16_f32 v131, v70, v71
    ds_read_b128 a[12:15], v3 offset:19456
    s_waitcnt lgkmcnt(4)
    v_mfma_f32_16x16x32_bf16 v[192:195], a[40:43], a[16:19], v[192:195]
    v_fma_f32 v77, v77, s34, -v26
    v_exp_f32 v75, v75
    v_add_f32 v157, v157, v73
    v_mfma_f32_16x16x32_bf16 v[196:199], a[44:47], a[16:19], v[196:199]
    buffer_load_dwordx4 v11, s[8:11], s32 offen offset:1024 nt lds
    ds_read_b128 a[16:19], v3 offset:20480
    v_mfma_f32_16x16x32_bf16 v[200:203], a[40:43], a[20:23], v[200:203]
    v_fma_f32 v78, v78, s34, -v26
    v_exp_f32 v76, v76
    v_add_f32 v157, v157, v74
    v_mfma_f32_16x16x32_bf16 v[204:207], a[44:47], a[20:23], v[204:207]
    v_cvt_pk_bf16_f32 v132, v72, v73
    v_fma_f32 v79, v79, s34, -v26
    ds_read_b128 a[20:23], v3 offset:21504
    v_mfma_f32_16x16x32_bf16 v[208:211], a[40:43], a[24:27], v[208:211]
    buffer_load_dwordx4 v12, s[8:11], s32 offen offset:2048 nt lds
    v_mfma_f32_16x16x32_bf16 v[212:215], a[44:47], a[24:27], v[212:215]
    v_exp_f32 v77, v77
    v_add_f32 v157, v157, v75
    v_fma_f32 v80, v80, s34, -v27
    ds_read_b128 a[24:27], v3 offset:22528
    v_mfma_f32_16x16x32_bf16 v[216:219], a[40:43], a[28:31], v[216:219]
    v_exp_f32 v78, v78
    v_add_f32 v157, v157, v76
    v_cvt_pk_bf16_f32 v133, v74, v75
    v_mfma_f32_16x16x32_bf16 v[220:223], a[44:47], a[28:31], v[220:223]
    buffer_load_dwordx4 v13, s[8:11], s32 offen offset:3072 nt lds
    ds_read_b128 a[28:31], v3 offset:23552
    s_waitcnt lgkmcnt(4)
    v_mfma_f32_16x16x32_bf16 v[224:227], a[40:43], a[0:3], v[224:227]
    v_fma_f32 v81, v81, s34, -v27
    v_exp_f32 v79, v79
    v_mfma_f32_16x16x32_bf16 v[228:231], a[44:47], a[0:3], v[228:231]
    v_add_f32 v157, v157, v77
    v_fma_f32 v82, v82, s34, -v27
    ds_read_b128 a[0:3], v3 offset:24576
    v_mfma_f32_16x16x32_bf16 v[232:235], a[40:43], a[4:7], v[232:235]
    v_exp_f32 v80, v80
    v_add_f32 v157, v157, v78
    v_cvt_pk_bf16_f32 v134, v76, v77
    v_fma_f32 v83, v83, s34, -v27
    v_mfma_f32_16x16x32_bf16 v[236:239], a[44:47], a[4:7], v[236:239]
    v_exp_f32 v81, v81
    v_add_f32 v157, v157, v79
    v_fma_f32 v84, v84, s34, -v27
    ds_read_b128 a[4:7], v3 offset:25600
    v_mfma_f32_16x16x32_bf16 v[240:243], a[40:43], a[8:11], v[240:243]
    v_exp_f32 v82, v82
    v_add_f32 v158, v158, v80
    v_cvt_pk_bf16_f32 v135, v78, v79
    v_mfma_f32_16x16x32_bf16 v[244:247], a[44:47], a[8:11], v[244:247]
    v_fma_f32 v85, v85, s34, -v27
    v_exp_f32 v83, v83
    v_add_f32 v158, v158, v81
    ds_read_b128 a[8:11], v3 offset:26624
    v_mfma_f32_16x16x32_bf16 v[248:251], a[40:43], a[12:15], v[248:251]
    v_fma_f32 v86, v86, s34, -v27
    v_exp_f32 v84, v84
    v_add_f32 v158, v158, v82
    v_mfma_f32_16x16x32_bf16 v[252:255], a[44:47], a[12:15], v[252:255]
    v_cvt_pk_bf16_f32 v136, v80, v81
    v_fma_f32 v87, v87, s34, -v27
    ds_read_b128 a[12:15], v3 offset:27648
    s_waitcnt lgkmcnt(4)
    v_mfma_f32_16x16x32_bf16 v[176:179], a[48:51], a[16:19], v[176:179]
    v_exp_f32 v85, v85
    v_add_f32 v158, v158, v83
    v_fma_f32 v88, v88, s34, -v28
    v_mfma_f32_16x16x32_bf16 v[180:183], a[52:55], a[16:19], v[180:183]
    v_exp_f32 v86, v86
    v_add_f32 v158, v158, v84
    v_cvt_pk_bf16_f32 v137, v82, v83
    ds_read_b128 a[16:19], v3 offset:28672
    v_mfma_f32_16x16x32_bf16 v[184:187], a[48:51], a[20:23], v[184:187]
    v_fma_f32 v89, v89, s34, -v28
    v_exp_f32 v87, v87
    v_add_f32 v158, v158, v85
    v_fma_f32 v90, v90, s34, -v28
    v_mfma_f32_16x16x32_bf16 v[188:191], a[52:55], a[20:23], v[188:191]
    v_exp_f32 v88, v88
    v_add_f32 v158, v158, v86
    ds_read_b128 a[20:23], v3 offset:29696
    v_mfma_f32_16x16x32_bf16 v[192:195], a[48:51], a[24:27], v[192:195]
    v_cvt_pk_bf16_f32 v138, v84, v85
    v_fma_f32 v91, v91, s34, -v28
    v_exp_f32 v89, v89
    v_add_f32 v158, v158, v87
    v_mfma_f32_16x16x32_bf16 v[196:199], a[52:55], a[24:27], v[196:199]
    v_fma_f32 v92, v92, s34, -v28
    v_exp_f32 v90, v90
    ds_read_b128 a[24:27], v3 offset:30720
    v_mfma_f32_16x16x32_bf16 v[200:203], a[48:51], a[28:31], v[200:203]
    v_add_f32 v159, v159, v88
    v_cvt_pk_bf16_f32 v139, v86, v87
    v_fma_f32 v93, v93, s34, -v28
    v_exp_f32 v91, v91
    v_mfma_f32_16x16x32_bf16 v[204:207], a[52:55], a[28:31], v[204:207]
    v_add_f32 v159, v159, v89
    v_fma_f32 v94, v94, s34, -v28
    ds_read_b128 a[28:31], v3 offset:31744
    s_waitcnt lgkmcnt(4)
    v_mfma_f32_16x16x32_bf16 v[208:211], a[48:51], a[0:3], v[208:211]
    v_exp_f32 v92, v92
    s_waitcnt vmcnt(12)
    ds_read_b128 a[32:35], v4
    v_mfma_f32_16x16x32_bf16 v[212:215], a[52:55], a[0:3], v[212:215]
    v_add_f32 v159, v159, v90
    ds_read_b128 a[36:39], v4 offset:2048
    v_cvt_pk_bf16_f32 v140, v88, v89
    ds_read_b128 a[0:3], v3 offset:32768
    v_mfma_f32_16x16x32_bf16 v[216:219], a[48:51], a[4:7], v[216:219]
    ds_read_b128 a[40:43], v5
    v_fma_f32 v95, v95, s34, -v28
    ds_read_b128 a[44:47], v5 offset:2048
    v_exp_f32 v93, v93
    v_mfma_f32_16x16x32_bf16 v[220:223], a[52:55], a[4:7], v[220:223]
    v_add_f32 v159, v159, v91
    v_fma_f32 v96, v96, s34, -v29
    ds_read_b128 a[4:7], v3 offset:33792
    v_mfma_f32_16x16x32_bf16 v[224:227], a[48:51], a[8:11], v[224:227]
    v_exp_f32 v94, v94
    v_add_f32 v159, v159, v92
    v_cvt_pk_bf16_f32 v141, v90, v91
    v_mfma_f32_16x16x32_bf16 v[228:231], a[52:55], a[8:11], v[228:231]
    v_fma_f32 v97, v97, s34, -v29
    v_exp_f32 v95, v95
    v_add_f32 v159, v159, v93
    ds_read_b128 a[8:11], v3 offset:34816
    v_mfma_f32_16x16x32_bf16 v[232:235], a[48:51], a[12:15], v[232:235]
    v_fma_f32 v98, v98, s34, -v29
    v_exp_f32 v96, v96
    v_add_f32 v159, v159, v94
    v_cvt_pk_bf16_f32 v142, v92, v93
    v_mfma_f32_16x16x32_bf16 v[236:239], a[52:55], a[12:15], v[236:239]
    v_fma_f32 v99, v99, s34, -v29
    ds_read_b128 a[12:15], v3 offset:35840
    s_waitcnt lgkmcnt(8)
    v_mfma_f32_16x16x32_bf16 v[240:243], a[48:51], a[16:19], v[240:243]
    v_exp_f32 v97, v97
    v_add_f32 v159, v159, v95
    v_fma_f32 v100, v100, s34, -v29
    v_mfma_f32_16x16x32_bf16 v[244:247], a[52:55], a[16:19], v[244:247]
    v_exp_f32 v98, v98
    v_add_f32 v160, v160, v96
    v_cvt_pk_bf16_f32 v143, v94, v95
    ds_read_b128 a[16:19], v3 offset:36864
    v_mfma_f32_16x16x32_bf16 v[248:251], a[48:51], a[20:23], v[248:251]
    v_fma_f32 v101, v101, s34, -v29
    v_exp_f32 v99, v99
    v_add_f32 v160, v160, v97
    v_fma_f32 v102, v102, s34, -v29
    v_mfma_f32_16x16x32_bf16 v[252:255], a[52:55], a[20:23], v[252:255]
    v_exp_f32 v100, v100
    v_add_f32 v160, v160, v98
    ds_read_b128 a[20:23], v3 offset:37888
    v_mfma_f32_16x16x32_bf16 v[176:179], a[56:59], a[24:27], v[176:179]
    v_cvt_pk_bf16_f32 v144, v96, v97
    v_fma_f32 v103, v103, s34, -v29
    v_exp_f32 v101, v101
    v_add_f32 v160, v160, v99
    v_mfma_f32_16x16x32_bf16 v[180:183], a[60:63], a[24:27], v[180:183]
    v_fma_f32 v104, v104, s34, -v30
    v_exp_f32 v102, v102
    ds_read_b128 a[24:27], v3 offset:38912
    v_mfma_f32_16x16x32_bf16 v[184:187], a[56:59], a[28:31], v[184:187]
    v_mov_b32 v10, v14
    v_add_u32 v11, 3072, v14
    v_add_u32 v12, 6144, v14
    v_add_u32 v13, 9216, v14
    s_waitcnt lgkmcnt(6)
    s_add_u32 m0, s29, 0
    s_mov_b32 s32, 0
    buffer_load_dwordx4 v10, s[12:15], s32 offen nt lds
    v_mfma_f32_16x16x32_bf16 v[188:191], a[60:63], a[28:31], v[188:191]
    v_add_f32 v160, v160, v100
    ds_read_b128 a[28:31], v3 offset:39936
    s_waitcnt lgkmcnt(4)
    v_mfma_f32_16x16x32_bf16 v[192:195], a[56:59], a[0:3], v[192:195]
    v_cvt_pk_bf16_f32 v145, v98, v99
    v_fma_f32 v105, v105, s34, -v30
    v_exp_f32 v103, v103
    v_mfma_f32_16x16x32_bf16 v[196:199], a[60:63], a[0:3], v[196:199]
    buffer_load_dwordx4 v11, s[12:15], s32 offen offset:1024 nt lds
    ds_read_b128 a[0:3], v2
    v_mfma_f32_16x16x32_bf16 v[200:203], a[56:59], a[4:7], v[200:203]
    v_add_f32 v160, v160, v101
    v_fma_f32 v106, v106, s34, -v30
    v_mfma_f32_16x16x32_bf16 v[204:207], a[60:63], a[4:7], v[204:207]
    v_exp_f32 v104, v104
    v_add_f32 v160, v160, v102
    v_cvt_pk_bf16_f32 v146, v100, v101
    ds_read_b128 a[4:7], v2 offset:1024
    v_mfma_f32_16x16x32_bf16 v[208:211], a[56:59], a[8:11], v[208:211]
    buffer_load_dwordx4 v12, s[12:15], s32 offen offset:2048 nt lds
    v_mfma_f32_16x16x32_bf16 v[212:215], a[60:63], a[8:11], v[212:215]
    v_fma_f32 v107, v107, s34, -v30
    ds_read_b128 a[8:11], v2 offset:2048
    v_mfma_f32_16x16x32_bf16 v[216:219], a[56:59], a[12:15], v[216:219]
    v_exp_f32 v105, v105
    v_add_f32 v160, v160, v103
    v_fma_f32 v108, v108, s34, -v30
    v_mfma_f32_16x16x32_bf16 v[220:223], a[60:63], a[12:15], v[220:223]
    buffer_load_dwordx4 v13, s[12:15], s32 offen offset:3072 nt lds
    ds_read_b128 a[12:15], v2 offset:3072
    s_waitcnt lgkmcnt(4)
    v_mfma_f32_16x16x32_bf16 v[224:227], a[56:59], a[16:19], v[224:227]
    v_exp_f32 v106, v106
    v_add_f32 v161, v161, v104
    v_mfma_f32_16x16x32_bf16 v[228:231], a[60:63], a[16:19], v[228:231]
    v_cvt_pk_bf16_f32 v147, v102, v103
    v_fma_f32 v109, v109, s34, -v30
    ds_read_b128 a[16:19], v2 offset:4096
    v_mfma_f32_16x16x32_bf16 v[232:235], a[56:59], a[20:23], v[232:235]
    v_exp_f32 v107, v107
    v_add_f32 v161, v161, v105
    v_fma_f32 v110, v110, s34, -v30
    v_mfma_f32_16x16x32_bf16 v[236:239], a[60:63], a[20:23], v[236:239]
    v_exp_f32 v108, v108
    v_add_f32 v161, v161, v106
    v_cvt_pk_bf16_f32 v148, v104, v105
    ds_read_b128 a[20:23], v2 offset:5120
    v_mfma_f32_16x16x32_bf16 v[240:243], a[56:59], a[24:27], v[240:243]
    v_fma_f32 v111, v111, s34, -v30
    v_exp_f32 v109, v109
    v_add_f32 v161, v161, v107
    v_mfma_f32_16x16x32_bf16 v[244:247], a[60:63], a[24:27], v[244:247]
    v_exp_f32 v110, v110
    v_add_f32 v161, v161, v108
    v_cvt_pk_bf16_f32 v149, v106, v107
    ds_read_b128 a[24:27], v2 offset:6144
    v_mfma_f32_16x16x32_bf16 v[248:251], a[56:59], a[28:31], v[248:251]
    v_exp_f32 v111, v111
    v_add_f32 v161, v161, v109
    v_add_f32 v161, v161, v110
    v_cvt_pk_bf16_f32 v150, v108, v109
    v_mfma_f32_16x16x32_bf16 v[252:255], a[60:63], a[28:31], v[252:255]
    v_add_f32 v161, v161, v111
    v_cvt_pk_bf16_f32 v151, v110, v111
    ds_read_b128 a[28:31], v2 offset:7168
    s_waitcnt lgkmcnt(4)
    v_mfma_f32_16x16x32_bf16 v[32:35], a[64:67], a[0:3], 0
    v_fma_f32 v176, v176, s34, -v21
    v_fma_f32 v177, v177, s34, -v21
    v_fma_f32 v178, v178, s34, -v21
    v_mfma_f32_16x16x32_bf16 v[36:39], a[68:71], a[0:3], 0
    s_waitcnt vmcnt(12)
    ds_read_b128 a[48:51], v4 offset:4096
    ds_read_b128 a[52:55], v4 offset:6144
    ds_read_b128 a[0:3], v2 offset:8192
    v_mfma_f32_16x16x32_bf16 v[40:43], a[64:67], a[4:7], 0
    ds_read_b128 a[56:59], v5 offset:4096
    ds_read_b128 a[60:63], v5 offset:6144
    v_mfma_f32_16x16x32_bf16 v[44:47], a[68:71], a[4:7], 0
    v_exp_f32 v176, v176
    v_fma_f32 v179, v179, s34, -v21
    ds_read_b128 a[4:7], v2 offset:9216
    v_mfma_f32_16x16x32_bf16 v[48:51], a[64:67], a[8:11], 0
    v_exp_f32 v177, v177
    v_fma_f32 v180, v180, s34, -v21
    v_exp_f32 v178, v178
    v_mfma_f32_16x16x32_bf16 v[52:55], a[68:71], a[8:11], 0
    v_add_f32 v152, v152, v176
    v_fma_f32 v181, v181, s34, -v21
    ds_read_b128 a[8:11], v2 offset:10240
    v_mfma_f32_16x16x32_bf16 v[56:59], a[64:67], a[12:15], 0
    v_exp_f32 v179, v179
    v_add_f32 v152, v152, v177
    v_fma_f32 v182, v182, s34, -v21
    v_mfma_f32_16x16x32_bf16 v[60:63], a[68:71], a[12:15], 0
    ds_read_b128 a[12:15], v2 offset:11264
    s_waitcnt lgkmcnt(8)
    v_mfma_f32_16x16x32_bf16 v[64:67], a[64:67], a[16:19], 0
    v_exp_f32 v180, v180
    v_add_f32 v152, v152, v178
    v_cvt_pk_bf16_f32 v176, v176, v177
    v_fma_f32 v183, v183, s34, -v21
    v_mfma_f32_16x16x32_bf16 v[68:71], a[68:71], a[16:19], 0
    ds_read_b128 a[16:19], v2 offset:12288
    v_mfma_f32_16x16x32_bf16 v[72:75], a[64:67], a[20:23], 0
    v_exp_f32 v181, v181
    v_accvgpr_write_b32 a208, v176
    v_add_f32 v152, v152, v179
    v_fma_f32 v184, v184, s34, -v22
    v_mfma_f32_16x16x32_bf16 v[76:79], a[68:71], a[20:23], 0
    ds_read_b128 a[20:23], v2 offset:13312
    v_mfma_f32_16x16x32_bf16 v[80:83], a[64:67], a[24:27], 0
    v_exp_f32 v182, v182
    v_add_f32 v152, v152, v180
    v_cvt_pk_bf16_f32 v178, v178, v179
    v_fma_f32 v185, v185, s34, -v22
    v_mfma_f32_16x16x32_bf16 v[84:87], a[68:71], a[24:27], 0
    ds_read_b128 a[24:27], v2 offset:14336
    v_mfma_f32_16x16x32_bf16 v[88:91], a[64:67], a[28:31], 0
    v_exp_f32 v183, v183
    v_accvgpr_write_b32 a209, v178
    v_add_f32 v152, v152, v181
    v_fma_f32 v186, v186, s34, -v22
    v_mfma_f32_16x16x32_bf16 v[92:95], a[68:71], a[28:31], 0
    ds_read_b128 a[28:31], v2 offset:15360
    s_waitcnt lgkmcnt(4)
    v_mfma_f32_16x16x32_bf16 v[96:99], a[64:67], a[0:3], 0
    v_exp_f32 v184, v184
    v_add_f32 v152, v152, v182
    v_cvt_pk_bf16_f32 v180, v180, v181
    v_fma_f32 v187, v187, s34, -v22
    v_mfma_f32_16x16x32_bf16 v[100:103], a[68:71], a[0:3], 0
    ds_read_b128 a[0:3], v2 offset:16384
    v_mfma_f32_16x16x32_bf16 v[104:107], a[64:67], a[4:7], 0
    v_exp_f32 v185, v185
    v_accvgpr_write_b32 a210, v180
    v_add_f32 v152, v152, v183
    v_fma_f32 v188, v188, s34, -v22
    v_mfma_f32_16x16x32_bf16 v[108:111], a[68:71], a[4:7], 0
    ds_read_b128 a[4:7], v2 offset:17408
    v_mfma_f32_16x16x32_bf16 v[32:35], a[72:75], a[8:11], v[32:35]
    v_exp_f32 v186, v186
    v_add_f32 v153, v153, v184
    v_cvt_pk_bf16_f32 v182, v182, v183
    v_fma_f32 v189, v189, s34, -v22
    v_mfma_f32_16x16x32_bf16 v[36:39], a[76:79], a[8:11], v[36:39]
    ds_read_b128 a[8:11], v2 offset:18432
    v_mfma_f32_16x16x32_bf16 v[40:43], a[72:75], a[12:15], v[40:43]
    s_add_u32 m0, s29, 4096
    s_mov_b32 s32, 16384
    buffer_load_dwordx4 v10, s[12:15], s32 offen nt lds
    v_mfma_f32_16x16x32_bf16 v[44:47], a[76:79], a[12:15], v[44:47]
    ds_read_b128 a[12:15], v2 offset:19456
    s_waitcnt lgkmcnt(4)
    v_mfma_f32_16x16x32_bf16 v[48:51], a[72:75], a[16:19], v[48:51]
    v_exp_f32 v187, v187
    v_accvgpr_write_b32 a211, v182
    v_add_f32 v153, v153, v185
    v_fma_f32 v190, v190, s34, -v22
    v_mfma_f32_16x16x32_bf16 v[52:55], a[76:79], a[16:19], v[52:55]
    buffer_load_dwordx4 v11, s[12:15], s32 offen offset:1024 nt lds
    ds_read_b128 a[16:19], v2 offset:20480
    v_mfma_f32_16x16x32_bf16 v[56:59], a[72:75], a[20:23], v[56:59]
    v_exp_f32 v188, v188
    v_add_f32 v153, v153, v186
    v_mfma_f32_16x16x32_bf16 v[60:63], a[76:79], a[20:23], v[60:63]
    v_cvt_pk_bf16_f32 v184, v184, v185
    v_fma_f32 v191, v191, s34, -v22
    ds_read_b128 a[20:23], v2 offset:21504
    v_mfma_f32_16x16x32_bf16 v[64:67], a[72:75], a[24:27], v[64:67]
    buffer_load_dwordx4 v12, s[12:15], s32 offen offset:2048 nt lds
    v_mfma_f32_16x16x32_bf16 v[68:71], a[76:79], a[24:27], v[68:71]
    v_exp_f32 v189, v189
    v_accvgpr_write_b32 a212, v184
    ds_read_b128 a[24:27], v2 offset:22528
    v_mfma_f32_16x16x32_bf16 v[72:75], a[72:75], a[28:31], v[72:75]
    v_add_f32 v153, v153, v187
    v_fma_f32 v192, v192, s34, -v23
    v_exp_f32 v190, v190
    v_mfma_f32_16x16x32_bf16 v[76:79], a[76:79], a[28:31], v[76:79]
    buffer_load_dwordx4 v13, s[12:15], s32 offen offset:3072 nt lds
    ds_read_b128 a[28:31], v2 offset:23552
    s_waitcnt lgkmcnt(4)
    v_mfma_f32_16x16x32_bf16 v[80:83], a[72:75], a[0:3], v[80:83]
    v_add_f32 v153, v153, v188
    v_cvt_pk_bf16_f32 v186, v186, v187
    v_fma_f32 v193, v193, s34, -v23
    v_mfma_f32_16x16x32_bf16 v[84:87], a[76:79], a[0:3], v[84:87]
    v_exp_f32 v191, v191
    v_accvgpr_write_b32 a213, v186
    ds_read_b128 a[0:3], v2 offset:24576
    v_mfma_f32_16x16x32_bf16 v[88:91], a[72:75], a[4:7], v[88:91]
    v_add_f32 v153, v153, v189
    v_fma_f32 v194, v194, s34, -v23
    v_exp_f32 v192, v192
    v_mfma_f32_16x16x32_bf16 v[92:95], a[76:79], a[4:7], v[92:95]
    v_add_f32 v153, v153, v190
    v_cvt_pk_bf16_f32 v188, v188, v189
    v_fma_f32 v195, v195, s34, -v23
    ds_read_b128 a[4:7], v2 offset:25600
    v_mfma_f32_16x16x32_bf16 v[96:99], a[72:75], a[8:11], v[96:99]
    v_exp_f32 v193, v193
    v_accvgpr_write_b32 a214, v188
    v_add_f32 v153, v153, v191
    v_fma_f32 v196, v196, s34, -v23
    v_mfma_f32_16x16x32_bf16 v[100:103], a[76:79], a[8:11], v[100:103]
    v_exp_f32 v194, v194
    v_add_f32 v154, v154, v192
    ds_read_b128 a[8:11], v2 offset:26624
    v_mfma_f32_16x16x32_bf16 v[104:107], a[72:75], a[12:15], v[104:107]
    v_cvt_pk_bf16_f32 v190, v190, v191
    v_fma_f32 v197, v197, s34, -v23
    v_exp_f32 v195, v195
    v_mfma_f32_16x16x32_bf16 v[108:111], a[76:79], a[12:15], v[108:111]
    v_accvgpr_write_b32 a215, v190
    v_add_f32 v154, v154, v193
    ds_read_b128 a[12:15], v2 offset:27648
    s_waitcnt lgkmcnt(4)
    v_mfma_f32_16x16x32_bf16 v[32:35], a[80:83], a[16:19], v[32:35]
    v_fma_f32 v198, v198, s34, -v23
    v_exp_f32 v196, v196
    v_add_f32 v154, v154, v194
    v_mfma_f32_16x16x32_bf16 v[36:39], a[84:87], a[16:19], v[36:39]
    s_waitcnt vmcnt(12)
    ds_read_b128 a[64:67], v4 offset:8192
    ds_read_b128 a[68:71], v4 offset:10240
    ds_read_b128 a[16:19], v2 offset:28672
    v_mfma_f32_16x16x32_bf16 v[40:43], a[80:83], a[20:23], v[40:43]
    ds_read_b128 a[72:75], v5 offset:8192
    ds_read_b128 a[76:79], v5 offset:10240
    v_mfma_f32_16x16x32_bf16 v[44:47], a[84:87], a[20:23], v[44:47]
    v_cvt_pk_bf16_f32 v192, v192, v193
    v_fma_f32 v199, v199, s34, -v23
    ds_read_b128 a[20:23], v2 offset:29696
    v_mfma_f32_16x16x32_bf16 v[48:51], a[80:83], a[24:27], v[48:51]
    v_exp_f32 v197, v197
    v_accvgpr_write_b32 a216, v192
    v_add_f32 v154, v154, v195
    v_fma_f32 v200, v200, s34, -v24
    v_mfma_f32_16x16x32_bf16 v[52:55], a[84:87], a[24:27], v[52:55]
    v_exp_f32 v198, v198
    v_add_f32 v154, v154, v196
    ds_read_b128 a[24:27], v2 offset:30720
    v_mfma_f32_16x16x32_bf16 v[56:59], a[80:83], a[28:31], v[56:59]
    v_cvt_pk_bf16_f32 v194, v194, v195
    v_fma_f32 v201, v201, s34, -v24
    v_exp_f32 v199, v199
    v_mfma_f32_16x16x32_bf16 v[60:63], a[84:87], a[28:31], v[60:63]
    v_accvgpr_write_b32 a217, v194
    v_add_f32 v154, v154, v197
    ds_read_b128 a[28:31], v2 offset:31744
    s_waitcnt lgkmcnt(8)
    v_mfma_f32_16x16x32_bf16 v[64:67], a[80:83], a[0:3], v[64:67]
    v_fma_f32 v202, v202, s34, -v24
    v_exp_f32 v200, v200
    v_add_f32 v154, v154, v198
    v_cvt_pk_bf16_f32 v196, v196, v197
    v_mfma_f32_16x16x32_bf16 v[68:71], a[84:87], a[0:3], v[68:71]
    v_fma_f32 v203, v203, s34, -v24
    ds_read_b128 a[0:3], v2 offset:32768
    v_mfma_f32_16x16x32_bf16 v[72:75], a[80:83], a[4:7], v[72:75]
    v_exp_f32 v201, v201
    v_accvgpr_write_b32 a218, v196
    v_add_f32 v154, v154, v199
    v_fma_f32 v204, v204, s34, -v24
    v_mfma_f32_16x16x32_bf16 v[76:79], a[84:87], a[4:7], v[76:79]
    ds_read_b128 a[4:7], v2 offset:33792
    v_mfma_f32_16x16x32_bf16 v[80:83], a[80:83], a[8:11], v[80:83]
    v_exp_f32 v202, v202
    v_add_f32 v155, v155, v200
    v_cvt_pk_bf16_f32 v198, v198, v199
    v_fma_f32 v205, v205, s34, -v24
    v_mfma_f32_16x16x32_bf16 v[84:87], a[84:87], a[8:11], v[84:87]
    ds_read_b128 a[8:11], v2 offset:34816
    v_mfma_f32_16x16x32_bf16 v[88:91], a[80:83], a[12:15], v[88:91]
    v_exp_f32 v203, v203
    v_accvgpr_write_b32 a219, v198
    v_add_f32 v155, v155, v201
    v_fma_f32 v206, v206, s34, -v24
    v_mfma_f32_16x16x32_bf16 v[92:95], a[84:87], a[12:15], v[92:95]
    ds_read_b128 a[12:15], v2 offset:35840
    s_waitcnt lgkmcnt(4)
    v_mfma_f32_16x16x32_bf16 v[96:99], a[80:83], a[16:19], v[96:99]
    v_exp_f32 v204, v204
    v_add_f32 v155, v155, v202
    v_cvt_pk_bf16_f32 v200, v200, v201
    v_fma_f32 v207, v207, s34, -v24
    v_mfma_f32_16x16x32_bf16 v[100:103], a[84:87], a[16:19], v[100:103]
    ds_read_b128 a[16:19], v2 offset:36864
    v_mfma_f32_16x16x32_bf16 v[104:107], a[80:83], a[20:23], v[104:107]
    v_exp_f32 v205, v205
    v_accvgpr_write_b32 a220, v200
    v_add_f32 v155, v155, v203
    v_fma_f32 v208, v208, s34, -v25
    v_mfma_f32_16x16x32_bf16 v[108:111], a[84:87], a[20:23], v[108:111]
    ds_read_b128 a[20:23], v2 offset:37888
    v_mfma_f32_16x16x32_bf16 v[32:35], a[88:91], a[24:27], v[32:35]
    v_exp_f32 v206, v206
    v_add_f32 v155, v155, v204
    v_cvt_pk_bf16_f32 v202, v202, v203
    v_fma_f32 v209, v209, s34, -v25
    v_mfma_f32_16x16x32_bf16 v[36:39], a[92:95], a[24:27], v[36:39]
    ds_read_b128 a[24:27], v2 offset:38912
    v_mfma_f32_16x16x32_bf16 v[40:43], a[88:91], a[28:31], v[40:43]
    s_add_u32 m0, s29, 8192
    s_mov_b32 s32, 32768
    buffer_load_dwordx4 v10, s[12:15], s32 offen nt lds
    v_mfma_f32_16x16x32_bf16 v[44:47], a[92:95], a[28:31], v[44:47]
    ds_read_b128 a[28:31], v2 offset:39936
    s_waitcnt lgkmcnt(4)
    v_mfma_f32_16x16x32_bf16 v[48:51], a[88:91], a[0:3], v[48:51]
    v_exp_f32 v207, v207
    v_accvgpr_write_b32 a221, v202
    v_add_f32 v155, v155, v205
    v_fma_f32 v210, v210, s34, -v25
    v_mfma_f32_16x16x32_bf16 v[52:55], a[92:95], a[0:3], v[52:55]
    buffer_load_dwordx4 v11, s[12:15], s32 offen offset:1024 nt lds
    ds_read_b128 a[0:3], v3
    v_mfma_f32_16x16x32_bf16 v[56:59], a[88:91], a[4:7], v[56:59]
    v_exp_f32 v208, v208
    v_add_f32 v155, v155, v206
    v_mfma_f32_16x16x32_bf16 v[60:63], a[92:95], a[4:7], v[60:63]
    v_cvt_pk_bf16_f32 v204, v204, v205
    v_fma_f32 v211, v211, s34, -v25
    ds_read_b128 a[4:7], v3 offset:1024
    v_mfma_f32_16x16x32_bf16 v[64:67], a[88:91], a[8:11], v[64:67]
    buffer_load_dwordx4 v12, s[12:15], s32 offen offset:2048 nt lds
    v_mfma_f32_16x16x32_bf16 v[68:71], a[92:95], a[8:11], v[68:71]
    v_exp_f32 v209, v209
    v_accvgpr_write_b32 a222, v204
    ds_read_b128 a[8:11], v3 offset:2048
    v_mfma_f32_16x16x32_bf16 v[72:75], a[88:91], a[12:15], v[72:75]
    v_add_f32 v155, v155, v207
    v_fma_f32 v212, v212, s34, -v25
    v_exp_f32 v210, v210
    v_mfma_f32_16x16x32_bf16 v[76:79], a[92:95], a[12:15], v[76:79]
    buffer_load_dwordx4 v13, s[12:15], s32 offen offset:3072 nt lds
    ds_read_b128 a[12:15], v3 offset:3072
    s_waitcnt lgkmcnt(4)
    v_mfma_f32_16x16x32_bf16 v[80:83], a[88:91], a[16:19], v[80:83]
    v_add_f32 v156, v156, v208
    v_cvt_pk_bf16_f32 v206, v206, v207
    v_fma_f32 v213, v213, s34, -v25
    v_mfma_f32_16x16x32_bf16 v[84:87], a[92:95], a[16:19], v[84:87]
    v_exp_f32 v211, v211
    v_accvgpr_write_b32 a223, v206
    ds_read_b128 a[16:19], v3 offset:4096
    v_mfma_f32_16x16x32_bf16 v[88:91], a[88:91], a[20:23], v[88:91]
    v_add_f32 v156, v156, v209
    v_fma_f32 v214, v214, s34, -v25
    v_exp_f32 v212, v212
    v_mfma_f32_16x16x32_bf16 v[92:95], a[92:95], a[20:23], v[92:95]
    v_add_f32 v156, v156, v210
    v_cvt_pk_bf16_f32 v208, v208, v209
    v_fma_f32 v215, v215, s34, -v25
    ds_read_b128 a[20:23], v3 offset:5120
    v_mfma_f32_16x16x32_bf16 v[96:99], a[88:91], a[24:27], v[96:99]
    v_exp_f32 v213, v213
    v_accvgpr_write_b32 a224, v208
    v_add_f32 v156, v156, v211
    v_fma_f32 v216, v216, s34, -v26
    v_mfma_f32_16x16x32_bf16 v[100:103], a[92:95], a[24:27], v[100:103]
    v_exp_f32 v214, v214
    v_add_f32 v156, v156, v212
    ds_read_b128 a[24:27], v3 offset:6144
    v_mfma_f32_16x16x32_bf16 v[104:107], a[88:91], a[28:31], v[104:107]
    v_cvt_pk_bf16_f32 v210, v210, v211
    v_fma_f32 v217, v217, s34, -v26
    v_exp_f32 v215, v215
    v_mfma_f32_16x16x32_bf16 v[108:111], a[92:95], a[28:31], v[108:111]
    v_accvgpr_write_b32 a225, v210
    v_add_f32 v156, v156, v213
    v_fma_f32 v218, v218, s34, -v26
    ds_read_b128 a[28:31], v3 offset:7168
    s_waitcnt lgkmcnt(4)
    v_mfma_f32_16x16x32_bf16 v[32:35], a[136:139], a[0:3], v[32:35]
    v_exp_f32 v216, v216
    v_add_f32 v156, v156, v214
    v_cvt_pk_bf16_f32 v212, v212, v213
    v_mfma_f32_16x16x32_bf16 v[36:39], a[140:143], a[0:3], v[36:39]
    s_waitcnt vmcnt(12)
    ds_read_b128 a[80:83], v4 offset:12288
    ds_read_b128 a[0:3], v3 offset:8192
    v_mfma_f32_16x16x32_bf16 v[40:43], a[136:139], a[4:7], v[40:43]
    ds_read_b128 a[84:87], v4 offset:14336
    ds_read_b128 a[88:91], v5 offset:12288
    ds_read_b128 a[92:95], v5 offset:14336
    v_mfma_f32_16x16x32_bf16 v[44:47], a[140:143], a[4:7], v[44:47]
    v_fma_f32 v219, v219, s34, -v26
    v_exp_f32 v217, v217
    ds_read_b128 a[4:7], v3 offset:9216
    v_mfma_f32_16x16x32_bf16 v[48:51], a[136:139], a[8:11], v[48:51]
    v_accvgpr_write_b32 a226, v212
    v_add_f32 v156, v156, v215
    v_fma_f32 v220, v220, s34, -v26
    v_mfma_f32_16x16x32_bf16 v[52:55], a[140:143], a[8:11], v[52:55]
    v_exp_f32 v218, v218
    v_add_f32 v157, v157, v216
    v_cvt_pk_bf16_f32 v214, v214, v215
    ds_read_b128 a[8:11], v3 offset:10240
    v_mfma_f32_16x16x32_bf16 v[56:59], a[136:139], a[12:15], v[56:59]
    v_fma_f32 v221, v221, s34, -v26
    v_exp_f32 v219, v219
    v_accvgpr_write_b32 a227, v214
    v_mfma_f32_16x16x32_bf16 v[60:63], a[140:143], a[12:15], v[60:63]
    v_add_f32 v157, v157, v217
    v_fma_f32 v222, v222, s34, -v26
    ds_read_b128 a[12:15], v3 offset:11264
    s_waitcnt lgkmcnt(8)
    v_mfma_f32_16x16x32_bf16 v[64:67], a[136:139], a[16:19], v[64:67]
    v_exp_f32 v220, v220
    v_add_f32 v157, v157, v218
    v_cvt_pk_bf16_f32 v216, v216, v217
    v_fma_f32 v223, v223, s34, -v26
    v_mfma_f32_16x16x32_bf16 v[68:71], a[140:143], a[16:19], v[68:71]
    ds_read_b128 a[16:19], v3 offset:12288
    v_mfma_f32_16x16x32_bf16 v[72:75], a[136:139], a[20:23], v[72:75]
    v_exp_f32 v221, v221
    v_accvgpr_write_b32 a228, v216
    v_add_f32 v157, v157, v219
    v_fma_f32 v224, v224, s34, -v27
    v_mfma_f32_16x16x32_bf16 v[76:79], a[140:143], a[20:23], v[76:79]
    ds_read_b128 a[20:23], v3 offset:13312
    v_mfma_f32_16x16x32_bf16 v[80:83], a[136:139], a[24:27], v[80:83]
    v_exp_f32 v222, v222
    v_add_f32 v157, v157, v220
    v_cvt_pk_bf16_f32 v218, v218, v219
    v_fma_f32 v225, v225, s34, -v27
    v_mfma_f32_16x16x32_bf16 v[84:87], a[140:143], a[24:27], v[84:87]
    ds_read_b128 a[24:27], v3 offset:14336
    v_mfma_f32_16x16x32_bf16 v[88:91], a[136:139], a[28:31], v[88:91]
    v_exp_f32 v223, v223
    v_accvgpr_write_b32 a229, v218
    v_add_f32 v157, v157, v221
    v_fma_f32 v226, v226, s34, -v27
    v_mfma_f32_16x16x32_bf16 v[92:95], a[140:143], a[28:31], v[92:95]
    ds_read_b128 a[28:31], v3 offset:15360
    s_waitcnt lgkmcnt(4)
    v_mfma_f32_16x16x32_bf16 v[96:99], a[136:139], a[0:3], v[96:99]
    v_exp_f32 v224, v224
    v_add_f32 v157, v157, v222
    v_cvt_pk_bf16_f32 v220, v220, v221
    v_fma_f32 v227, v227, s34, -v27
    v_mfma_f32_16x16x32_bf16 v[100:103], a[140:143], a[0:3], v[100:103]
    ds_read_b128 a[0:3], v3 offset:16384
    v_mfma_f32_16x16x32_bf16 v[104:107], a[136:139], a[4:7], v[104:107]
    v_exp_f32 v225, v225
    v_accvgpr_write_b32 a230, v220
    v_add_f32 v157, v157, v223
    v_fma_f32 v228, v228, s34, -v27
    v_mfma_f32_16x16x32_bf16 v[108:111], a[140:143], a[4:7], v[108:111]
    ds_read_b128 a[4:7], v3 offset:17408
    v_mfma_f32_16x16x32_bf16 v[32:35], a[144:147], a[8:11], v[32:35]
    v_exp_f32 v226, v226
    v_add_f32 v158, v158, v224
    v_cvt_pk_bf16_f32 v222, v222, v223
    v_fma_f32 v229, v229, s34, -v27
    v_mfma_f32_16x16x32_bf16 v[36:39], a[148:151], a[8:11], v[36:39]
    ds_read_b128 a[8:11], v3 offset:18432
    v_mfma_f32_16x16x32_bf16 v[40:43], a[144:147], a[12:15], v[40:43]
    s_add_u32 m0, s29, 12288
    s_mov_b32 s32, 49152
    buffer_load_dwordx4 v10, s[12:15], s32 offen nt lds
    v_mfma_f32_16x16x32_bf16 v[44:47], a[148:151], a[12:15], v[44:47]
    ds_read_b128 a[12:15], v3 offset:19456
    s_waitcnt lgkmcnt(4)
    v_mfma_f32_16x16x32_bf16 v[48:51], a[144:147], a[16:19], v[48:51]
    v_exp_f32 v227, v227
    v_accvgpr_write_b32 a231, v222
    v_add_f32 v158, v158, v225
    v_fma_f32 v230, v230, s34, -v27
    v_mfma_f32_16x16x32_bf16 v[52:55], a[148:151], a[16:19], v[52:55]
    buffer_load_dwordx4 v11, s[12:15], s32 offen offset:1024 nt lds
    ds_read_b128 a[16:19], v3 offset:20480
    v_mfma_f32_16x16x32_bf16 v[56:59], a[144:147], a[20:23], v[56:59]
    v_exp_f32 v228, v228
    v_add_f32 v158, v158, v226
    v_mfma_f32_16x16x32_bf16 v[60:63], a[148:151], a[20:23], v[60:63]
    v_cvt_pk_bf16_f32 v224, v224, v225
    v_fma_f32 v231, v231, s34, -v27
    ds_read_b128 a[20:23], v3 offset:21504
    v_mfma_f32_16x16x32_bf16 v[64:67], a[144:147], a[24:27], v[64:67]
    buffer_load_dwordx4 v12, s[12:15], s32 offen offset:2048 nt lds
    v_mfma_f32_16x16x32_bf16 v[68:71], a[148:151], a[24:27], v[68:71]
    v_exp_f32 v229, v229
    v_accvgpr_write_b32 a232, v224
    ds_read_b128 a[24:27], v3 offset:22528
    v_mfma_f32_16x16x32_bf16 v[72:75], a[144:147], a[28:31], v[72:75]
    v_add_f32 v158, v158, v227
    v_fma_f32 v232, v232, s34, -v28
    v_exp_f32 v230, v230
    v_add_f32 v158, v158, v228
    v_mfma_f32_16x16x32_bf16 v[76:79], a[148:151], a[28:31], v[76:79]
    buffer_load_dwordx4 v13, s[12:15], s32 offen offset:3072 nt lds
    ds_read_b128 a[28:31], v3 offset:23552
    s_waitcnt lgkmcnt(4)
    v_mfma_f32_16x16x32_bf16 v[80:83], a[144:147], a[0:3], v[80:83]
    v_cvt_pk_bf16_f32 v226, v226, v227
    v_fma_f32 v233, v233, s34, -v28
    v_mfma_f32_16x16x32_bf16 v[84:87], a[148:151], a[0:3], v[84:87]
    v_exp_f32 v231, v231
    v_accvgpr_write_b32 a233, v226
    v_add_f32 v158, v158, v229
    ds_read_b128 a[0:3], v3 offset:24576
    v_mfma_f32_16x16x32_bf16 v[88:91], a[144:147], a[4:7], v[88:91]
    v_fma_f32 v234, v234, s34, -v28
    v_exp_f32 v232, v232
    v_add_f32 v158, v158, v230
    v_mfma_f32_16x16x32_bf16 v[92:95], a[148:151], a[4:7], v[92:95]
    v_cvt_pk_bf16_f32 v228, v228, v229
    v_fma_f32 v235, v235, s34, -v28
    ds_read_b128 a[4:7], v3 offset:25600
    v_mfma_f32_16x16x32_bf16 v[96:99], a[144:147], a[8:11], v[96:99]
    v_exp_f32 v233, v233
    v_accvgpr_write_b32 a234, v228
    v_add_f32 v158, v158, v231
    v_fma_f32 v236, v236, s34, -v28
    v_mfma_f32_16x16x32_bf16 v[100:103], a[148:151], a[8:11], v[100:103]
    v_exp_f32 v234, v234
    v_add_f32 v159, v159, v232
    ds_read_b128 a[8:11], v3 offset:26624
    v_mfma_f32_16x16x32_bf16 v[104:107], a[144:147], a[12:15], v[104:107]
    v_cvt_pk_bf16_f32 v230, v230, v231
    v_fma_f32 v237, v237, s34, -v28
    v_exp_f32 v235, v235
    v_accvgpr_write_b32 a235, v230
    v_mfma_f32_16x16x32_bf16 v[108:111], a[148:151], a[12:15], v[108:111]
    v_add_f32 v159, v159, v233
    v_fma_f32 v238, v238, s34, -v28
    ds_read_b128 a[12:15], v3 offset:27648
    s_waitcnt lgkmcnt(4)
    v_mfma_f32_16x16x32_bf16 v[32:35], a[152:155], a[16:19], v[32:35]
    v_exp_f32 v236, v236
    v_add_f32 v159, v159, v234
    v_cvt_pk_bf16_f32 v232, v232, v233
    v_mfma_f32_16x16x32_bf16 v[36:39], a[156:159], a[16:19], v[36:39]
    v_fma_f32 v239, v239, s34, -v28
    s_waitcnt vmcnt(12)
    ds_read_b64_tr_b16 a[136:137], v6
    ds_read_b128 a[16:19], v3 offset:28672
    v_mfma_f32_16x16x32_bf16 v[40:43], a[152:155], a[20:23], v[40:43]
    v_exp_f32 v237, v237
    v_accvgpr_write_b32 a236, v232
    v_add_f32 v159, v159, v235
    v_mfma_f32_16x16x32_bf16 v[44:47], a[156:159], a[20:23], v[44:47]
    v_fma_f32 v240, v240, s34, -v29
    ds_read_b64_tr_b16 a[138:139], v6 offset:2048
    ds_read_b64_tr_b16 a[140:141], v7
    ds_read_b128 a[20:23], v3 offset:29696
    v_mfma_f32_16x16x32_bf16 v[48:51], a[152:155], a[24:27], v[48:51]
    v_exp_f32 v238, v238
    v_add_f32 v159, v159, v236
    v_cvt_pk_bf16_f32 v234, v234, v235
    v_fma_f32 v241, v241, s34, -v29
    v_mfma_f32_16x16x32_bf16 v[52:55], a[156:159], a[24:27], v[52:55]
    ds_read_b64_tr_b16 a[142:143], v7 offset:2048
    ds_read_b64_tr_b16 a[144:145], v8
    ds_read_b128 a[24:27], v3 offset:30720
    v_mfma_f32_16x16x32_bf16 v[56:59], a[152:155], a[28:31], v[56:59]
    v_exp_f32 v239, v239
    v_accvgpr_write_b32 a237, v234
    v_add_f32 v159, v159, v237
    v_mfma_f32_16x16x32_bf16 v[60:63], a[156:159], a[28:31], v[60:63]
    ds_read_b64_tr_b16 a[146:147], v8 offset:2048
    v_fma_f32 v242, v242, s34, -v29
    ds_read_b128 a[28:31], v3 offset:31744
    s_waitcnt lgkmcnt(10)
    v_mfma_f32_16x16x32_bf16 v[64:67], a[152:155], a[0:3], v[64:67]
    v_exp_f32 v240, v240
    ds_read_b64_tr_b16 a[148:149], v9
    ds_read_b64_tr_b16 a[150:151], v9 offset:2048
    v_mfma_f32_16x16x32_bf16 v[68:71], a[156:159], a[0:3], v[68:71]
    v_add_f32 v159, v159, v238
    v_cvt_pk_bf16_f32 v236, v236, v237
    ds_read_b128 a[0:3], v3 offset:32768
    v_mfma_f32_16x16x32_bf16 v[72:75], a[152:155], a[4:7], v[72:75]
    v_fma_f32 v243, v243, s34, -v29
    v_exp_f32 v241, v241
    v_accvgpr_write_b32 a238, v236
    v_add_f32 v159, v159, v239
    v_mfma_f32_16x16x32_bf16 v[76:79], a[156:159], a[4:7], v[76:79]
    v_fma_f32 v244, v244, s34, -v29
    ds_read_b128 a[4:7], v3 offset:33792
    v_mfma_f32_16x16x32_bf16 v[80:83], a[152:155], a[8:11], v[80:83]
    v_exp_f32 v242, v242
    v_add_f32 v160, v160, v240
    v_cvt_pk_bf16_f32 v238, v238, v239
    v_fma_f32 v245, v245, s34, -v29
    v_mfma_f32_16x16x32_bf16 v[84:87], a[156:159], a[8:11], v[84:87]
    ds_read_b128 a[8:11], v3 offset:34816
    v_mfma_f32_16x16x32_bf16 v[88:91], a[152:155], a[12:15], v[88:91]
    v_exp_f32 v243, v243
    v_accvgpr_write_b32 a239, v238
    v_add_f32 v160, v160, v241
    v_fma_f32 v246, v246, s34, -v29
    v_mfma_f32_16x16x32_bf16 v[92:95], a[156:159], a[12:15], v[92:95]
    ds_read_b128 a[12:15], v3 offset:35840
    s_waitcnt lgkmcnt(6)
    v_mfma_f32_16x16x32_bf16 v[96:99], a[152:155], a[16:19], v[96:99]
    v_exp_f32 v244, v244
    v_add_f32 v160, v160, v242
    v_cvt_pk_bf16_f32 v240, v240, v241
    v_fma_f32 v247, v247, s34, -v29
    v_mfma_f32_16x16x32_bf16 v[100:103], a[156:159], a[16:19], v[100:103]
    ds_read_b128 a[16:19], v3 offset:36864
    v_mfma_f32_16x16x32_bf16 v[104:107], a[152:155], a[20:23], v[104:107]
    v_exp_f32 v245, v245
    v_accvgpr_write_b32 a240, v240
    v_add_f32 v160, v160, v243
    v_fma_f32 v248, v248, s34, -v30
    v_mfma_f32_16x16x32_bf16 v[108:111], a[156:159], a[20:23], v[108:111]
    ds_read_b128 a[20:23], v3 offset:37888
    v_mfma_f32_16x16x32_bf16 v[32:35], a[160:163], a[24:27], v[32:35]
    v_exp_f32 v246, v246
    v_add_f32 v160, v160, v244
    v_cvt_pk_bf16_f32 v242, v242, v243
    v_fma_f32 v249, v249, s34, -v30
    v_mfma_f32_16x16x32_bf16 v[36:39], a[164:167], a[24:27], v[36:39]
    ds_read_b128 a[24:27], v3 offset:38912
    v_mfma_f32_16x16x32_bf16 v[40:43], a[160:163], a[28:31], v[40:43]
    s_waitcnt lgkmcnt(7)
    s_add_u32 m0, s29, 0
    s_mov_b32 s32, 65536
    buffer_load_dwordx4 v10, s[12:15], s32 offen nt lds
    v_mfma_f32_16x16x32_bf16 v[44:47], a[164:167], a[28:31], v[44:47]
    ds_read_b128 a[28:31], v3 offset:39936
    s_waitcnt lgkmcnt(4)
    v_mfma_f32_16x16x32_bf16 v[48:51], a[160:163], a[0:3], v[48:51]
    v_exp_f32 v247, v247
    v_accvgpr_write_b32 a241, v242
    v_add_f32 v160, v160, v245
    v_fma_f32 v250, v250, s34, -v30
    v_mfma_f32_16x16x32_bf16 v[52:55], a[164:167], a[0:3], v[52:55]
    buffer_load_dwordx4 v11, s[12:15], s32 offen offset:1024 nt lds
    ds_read_b128 a[0:3], v2
    v_mfma_f32_16x16x32_bf16 v[56:59], a[160:163], a[4:7], v[56:59]
    v_exp_f32 v248, v248
    v_add_f32 v160, v160, v246
    v_mfma_f32_16x16x32_bf16 v[60:63], a[164:167], a[4:7], v[60:63]
    v_cvt_pk_bf16_f32 v244, v244, v245
    v_fma_f32 v251, v251, s34, -v30
    v_exp_f32 v249, v249
    ds_read_b128 a[4:7], v2 offset:1024
    v_mfma_f32_16x16x32_bf16 v[64:67], a[160:163], a[8:11], v[64:67]
    buffer_load_dwordx4 v12, s[12:15], s32 offen offset:2048 nt lds
    v_mfma_f32_16x16x32_bf16 v[68:71], a[164:167], a[8:11], v[68:71]
    v_accvgpr_write_b32 a242, v244
    v_add_f32 v160, v160, v247
    v_fma_f32 v252, v252, s34, -v30
    ds_read_b128 a[8:11], v2 offset:2048
    v_mfma_f32_16x16x32_bf16 v[72:75], a[160:163], a[12:15], v[72:75]
    v_exp_f32 v250, v250
    v_add_f32 v161, v161, v248
    v_cvt_pk_bf16_f32 v246, v246, v247
    v_mfma_f32_16x16x32_bf16 v[76:79], a[164:167], a[12:15], v[76:79]
    buffer_load_dwordx4 v13, s[12:15], s32 offen offset:3072 nt lds
    ds_read_b128 a[12:15], v2 offset:3072
    s_waitcnt lgkmcnt(4)
    v_mfma_f32_16x16x32_bf16 v[80:83], a[160:163], a[16:19], v[80:83]
    v_fma_f32 v253, v253, s34, -v30
    v_exp_f32 v251, v251
    v_mfma_f32_16x16x32_bf16 v[84:87], a[164:167], a[16:19], v[84:87]
    v_accvgpr_write_b32 a243, v246
    v_add_f32 v161, v161, v249
    v_fma_f32 v254, v254, s34, -v30
    ds_read_b128 a[16:19], v2 offset:4096
    v_mfma_f32_16x16x32_bf16 v[88:91], a[160:163], a[20:23], v[88:91]
    v_exp_f32 v252, v252
    v_add_f32 v161, v161, v250
    v_cvt_pk_bf16_f32 v248, v248, v249
    v_fma_f32 v255, v255, s34, -v30
    v_mfma_f32_16x16x32_bf16 v[92:95], a[164:167], a[20:23], v[92:95]
    v_exp_f32 v253, v253
    v_accvgpr_write_b32 a244, v248
    ds_read_b128 a[20:23], v2 offset:5120
    v_mfma_f32_16x16x32_bf16 v[96:99], a[160:163], a[24:27], v[96:99]
    v_add_f32 v161, v161, v251
    v_exp_f32 v254, v254
    v_add_f32 v161, v161, v252
    v_cvt_pk_bf16_f32 v250, v250, v251
    v_mfma_f32_16x16x32_bf16 v[100:103], a[164:167], a[24:27], v[100:103]
    ds_read_b128 a[24:27], v2 offset:6144
    v_mfma_f32_16x16x32_bf16 v[104:107], a[160:163], a[28:31], v[104:107]
    v_exp_f32 v255, v255
    v_accvgpr_write_b32 a245, v250
    v_add_f32 v161, v161, v253
    v_add_f32 v161, v161, v254
    v_cvt_pk_bf16_f32 v252, v252, v253
    v_add_f32 v161, v161, v255
    v_mfma_f32_16x16x32_bf16 v[108:111], a[164:167], a[28:31], v[108:111]
    v_cvt_pk_bf16_f32 v254, v254, v255
    v_accvgpr_write_b32 a246, v252
    v_accvgpr_write_b32 a247, v254
    ds_read_b128 a[28:31], v2 offset:7168
    s_waitcnt lgkmcnt(4)
    v_mfma_f32_16x16x32_bf16 v[176:179], a[32:35], a[0:3], 0
    v_fma_f32 v32, v32, s34, -v21
    v_fma_f32 v33, v33, s34, -v21
    v_fma_f32 v34, v34, s34, -v21
    v_mfma_f32_16x16x32_bf16 v[180:183], a[36:39], a[0:3], 0
    s_waitcnt vmcnt(12)
    ds_read_b64_tr_b16 a[152:153], v6 offset:4096
    ds_read_b64_tr_b16 a[154:155], v6 offset:6144
    ds_read_b128 a[0:3], v2 offset:8192
    v_mfma_f32_16x16x32_bf16 v[184:187], a[32:35], a[4:7], 0
    ds_read_b64_tr_b16 a[156:157], v7 offset:4096
    ds_read_b64_tr_b16 a[158:159], v7 offset:6144
    ds_read_b64_tr_b16 a[160:161], v8 offset:4096
    ds_read_b64_tr_b16 a[162:163], v8 offset:6144
    v_mfma_f32_16x16x32_bf16 v[188:191], a[36:39], a[4:7], 0
    ds_read_b64_tr_b16 a[164:165], v9 offset:4096
    ds_read_b64_tr_b16 a[166:167], v9 offset:6144
    ds_read_b128 a[4:7], v2 offset:9216
    v_mfma_f32_16x16x32_bf16 v[192:195], a[32:35], a[8:11], 0
    v_exp_f32 v32, v32
    v_fma_f32 v35, v35, s34, -v21
    v_mfma_f32_16x16x32_bf16 v[196:199], a[36:39], a[8:11], 0
    v_exp_f32 v33, v33
    v_fma_f32 v36, v36, s34, -v21
    ds_read_b128 a[8:11], v2 offset:10240
    v_mfma_f32_16x16x32_bf16 v[200:203], a[32:35], a[12:15], 0
    v_exp_f32 v34, v34
    v_add_f32 v152, v152, v32
    v_fma_f32 v37, v37, s34, -v21
    v_mfma_f32_16x16x32_bf16 v[204:207], a[36:39], a[12:15], 0
    v_exp_f32 v35, v35
    v_add_f32 v152, v152, v33
    ds_read_b128 a[12:15], v2 offset:11264
    s_waitcnt lgkmcnt(12)
    v_mfma_f32_16x16x32_bf16 v[208:211], a[32:35], a[16:19], 0
    v_fma_f32 v38, v38, s34, -v21
    v_exp_f32 v36, v36
    v_add_f32 v152, v152, v34
    v_mfma_f32_16x16x32_bf16 v[212:215], a[36:39], a[16:19], 0
    v_cvt_pk_bf16_f32 v32, v32, v33
    v_fma_f32 v39, v39, s34, -v21
    ds_read_b128 a[16:19], v2 offset:12288
    v_mfma_f32_16x16x32_bf16 v[216:219], a[32:35], a[20:23], 0
    v_exp_f32 v37, v37
    v_accvgpr_write_b32 a168, v32
    v_add_f32 v152, v152, v35
    v_fma_f32 v40, v40, s34, -v22
    v_mfma_f32_16x16x32_bf16 v[220:223], a[36:39], a[20:23], 0
    ds_read_b128 a[20:23], v2 offset:13312
    v_mfma_f32_16x16x32_bf16 v[224:227], a[32:35], a[24:27], 0
    v_exp_f32 v38, v38
    v_add_f32 v152, v152, v36
    v_cvt_pk_bf16_f32 v34, v34, v35
    v_fma_f32 v41, v41, s34, -v22
    v_mfma_f32_16x16x32_bf16 v[228:231], a[36:39], a[24:27], 0
    ds_read_b128 a[24:27], v2 offset:14336
    v_mfma_f32_16x16x32_bf16 v[232:235], a[32:35], a[28:31], 0
    v_exp_f32 v39, v39
    v_accvgpr_write_b32 a169, v34
    v_add_f32 v152, v152, v37
    v_fma_f32 v42, v42, s34, -v22
    v_mfma_f32_16x16x32_bf16 v[236:239], a[36:39], a[28:31], 0
    ds_read_b128 a[28:31], v2 offset:15360
    s_waitcnt lgkmcnt(4)
    v_mfma_f32_16x16x32_bf16 v[240:243], a[32:35], a[0:3], 0
    v_exp_f32 v40, v40
    v_add_f32 v152, v152, v38
    v_cvt_pk_bf16_f32 v36, v36, v37
    v_fma_f32 v43, v43, s34, -v22
    v_mfma_f32_16x16x32_bf16 v[244:247], a[36:39], a[0:3], 0
    ds_read_b128 a[0:3], v2 offset:16384
    v_mfma_f32_16x16x32_bf16 v[248:251], a[32:35], a[4:7], 0
    v_exp_f32 v41, v41
    v_accvgpr_write_b32 a170, v36
    v_add_f32 v152, v152, v39
    v_fma_f32 v44, v44, s34, -v22
    v_mfma_f32_16x16x32_bf16 v[252:255], a[36:39], a[4:7], 0
    ds_read_b128 a[4:7], v2 offset:17408
    v_mfma_f32_16x16x32_bf16 v[176:179], a[40:43], a[8:11], v[176:179]
    v_exp_f32 v42, v42
    v_add_f32 v153, v153, v40
    v_cvt_pk_bf16_f32 v38, v38, v39
    v_fma_f32 v45, v45, s34, -v22
    v_mfma_f32_16x16x32_bf16 v[180:183], a[44:47], a[8:11], v[180:183]
    ds_read_b128 a[8:11], v2 offset:18432
    v_mfma_f32_16x16x32_bf16 v[184:187], a[40:43], a[12:15], v[184:187]
    s_add_u32 m0, s29, 4096
    s_mov_b32 s32, 81920
    buffer_load_dwordx4 v10, s[12:15], s32 offen nt lds
    v_mfma_f32_16x16x32_bf16 v[188:191], a[44:47], a[12:15], v[188:191]
    ds_read_b128 a[12:15], v2 offset:19456
    s_waitcnt lgkmcnt(4)
    v_mfma_f32_16x16x32_bf16 v[192:195], a[40:43], a[16:19], v[192:195]
    v_exp_f32 v43, v43
    v_accvgpr_write_b32 a171, v38
    v_add_f32 v153, v153, v41
    v_fma_f32 v46, v46, s34, -v22
    v_mfma_f32_16x16x32_bf16 v[196:199], a[44:47], a[16:19], v[196:199]
    buffer_load_dwordx4 v11, s[12:15], s32 offen offset:1024 nt lds
    ds_read_b128 a[16:19], v2 offset:20480
    v_mfma_f32_16x16x32_bf16 v[200:203], a[40:43], a[20:23], v[200:203]
    v_exp_f32 v44, v44
    v_add_f32 v153, v153, v42
    v_mfma_f32_16x16x32_bf16 v[204:207], a[44:47], a[20:23], v[204:207]
    v_cvt_pk_bf16_f32 v40, v40, v41
    v_fma_f32 v47, v47, s34, -v22
    v_exp_f32 v45, v45
    ds_read_b128 a[20:23], v2 offset:21504
    v_mfma_f32_16x16x32_bf16 v[208:211], a[40:43], a[24:27], v[208:211]
    buffer_load_dwordx4 v12, s[12:15], s32 offen offset:2048 nt lds
    v_mfma_f32_16x16x32_bf16 v[212:215], a[44:47], a[24:27], v[212:215]
    v_accvgpr_write_b32 a172, v40
    v_add_f32 v153, v153, v43
    v_fma_f32 v48, v48, s34, -v23
    ds_read_b128 a[24:27], v2 offset:22528
    v_mfma_f32_16x16x32_bf16 v[216:219], a[40:43], a[28:31], v[216:219]
    v_exp_f32 v46, v46
    v_add_f32 v153, v153, v44
    v_cvt_pk_bf16_f32 v42, v42, v43
    v_mfma_f32_16x16x32_bf16 v[220:223], a[44:47], a[28:31], v[220:223]
    buffer_load_dwordx4 v13, s[12:15], s32 offen offset:3072 nt lds
    ds_read_b128 a[28:31], v2 offset:23552
    s_waitcnt lgkmcnt(4)
    v_mfma_f32_16x16x32_bf16 v[224:227], a[40:43], a[0:3], v[224:227]
    v_fma_f32 v49, v49, s34, -v23
    v_exp_f32 v47, v47
    v_mfma_f32_16x16x32_bf16 v[228:231], a[44:47], a[0:3], v[228:231]
    v_accvgpr_write_b32 a173, v42
    v_add_f32 v153, v153, v45
    v_fma_f32 v50, v50, s34, -v23
    ds_read_b128 a[0:3], v2 offset:24576
    v_mfma_f32_16x16x32_bf16 v[232:235], a[40:43], a[4:7], v[232:235]
    v_exp_f32 v48, v48
    v_add_f32 v153, v153, v46
    v_cvt_pk_bf16_f32 v44, v44, v45
    v_fma_f32 v51, v51, s34, -v23
    v_mfma_f32_16x16x32_bf16 v[236:239], a[44:47], a[4:7], v[236:239]
    v_exp_f32 v49, v49
    v_accvgpr_write_b32 a174, v44
    v_add_f32 v153, v153, v47
    ds_read_b128 a[4:7], v2 offset:25600
    v_mfma_f32_16x16x32_bf16 v[240:243], a[40:43], a[8:11], v[240:243]
    v_fma_f32 v52, v52, s34, -v23
    v_exp_f32 v50, v50
    v_add_f32 v154, v154, v48
    v_mfma_f32_16x16x32_bf16 v[244:247], a[44:47], a[8:11], v[244:247]
    v_cvt_pk_bf16_f32 v46, v46, v47
    v_fma_f32 v53, v53, s34, -v23
    ds_read_b128 a[8:11], v2 offset:26624
    v_mfma_f32_16x16x32_bf16 v[248:251], a[40:43], a[12:15], v[248:251]
    v_exp_f32 v51, v51
    v_accvgpr_write_b32 a175, v46
    v_add_f32 v154, v154, v49
    v_fma_f32 v54, v54, s34, -v23
    v_mfma_f32_16x16x32_bf16 v[252:255], a[44:47], a[12:15], v[252:255]
    ds_read_b128 a[12:15], v2 offset:27648
    s_waitcnt lgkmcnt(4)
    v_mfma_f32_16x16x32_bf16 v[176:179], a[48:51], a[16:19], v[176:179]
    v_exp_f32 v52, v52
    v_add_f32 v154, v154, v50
    v_cvt_pk_bf16_f32 v48, v48, v49
    v_fma_f32 v55, v55, s34, -v23
    v_mfma_f32_16x16x32_bf16 v[180:183], a[52:55], a[16:19], v[180:183]
    s_waitcnt vmcnt(12)
    ds_read_b64_tr_b16 a[32:33], v6 offset:8192
    ds_read_b64_tr_b16 a[34:35], v6 offset:10240
    ds_read_b128 a[16:19], v2 offset:28672
    v_mfma_f32_16x16x32_bf16 v[184:187], a[48:51], a[20:23], v[184:187]
    ds_read_b64_tr_b16 a[36:37], v7 offset:8192
    ds_read_b64_tr_b16 a[38:39], v7 offset:10240
    ds_read_b64_tr_b16 a[40:41], v8 offset:8192
    v_mfma_f32_16x16x32_bf16 v[188:191], a[52:55], a[20:23], v[188:191]
    ds_read_b64_tr_b16 a[42:43], v8 offset:10240
    ds_read_b64_tr_b16 a[44:45], v9 offset:8192
    ds_read_b64_tr_b16 a[46:47], v9 offset:10240
    ds_read_b128 a[20:23], v2 offset:29696
    v_mfma_f32_16x16x32_bf16 v[192:195], a[48:51], a[24:27], v[192:195]
    v_exp_f32 v53, v53
    v_accvgpr_write_b32 a176, v48
    v_add_f32 v154, v154, v51
    v_mfma_f32_16x16x32_bf16 v[196:199], a[52:55], a[24:27], v[196:199]
    v_fma_f32 v56, v56, s34, -v24
    v_exp_f32 v54, v54
    ds_read_b128 a[24:27], v2 offset:30720
    v_mfma_f32_16x16x32_bf16 v[200:203], a[48:51], a[28:31], v[200:203]
    v_add_f32 v154, v154, v52
    v_cvt_pk_bf16_f32 v50, v50, v51
    v_fma_f32 v57, v57, s34, -v24
    v_exp_f32 v55, v55
    v_mfma_f32_16x16x32_bf16 v[204:207], a[52:55], a[28:31], v[204:207]
    v_accvgpr_write_b32 a177, v50
    v_add_f32 v154, v154, v53
    ds_read_b128 a[28:31], v2 offset:31744
    s_waitcnt lgkmcnt(12)
    v_mfma_f32_16x16x32_bf16 v[208:211], a[48:51], a[0:3], v[208:211]
    v_fma_f32 v58, v58, s34, -v24
    v_exp_f32 v56, v56
    v_add_f32 v154, v154, v54
    v_cvt_pk_bf16_f32 v52, v52, v53
    v_mfma_f32_16x16x32_bf16 v[212:215], a[52:55], a[0:3], v[212:215]
    v_fma_f32 v59, v59, s34, -v24
    ds_read_b128 a[0:3], v2 offset:32768
    v_mfma_f32_16x16x32_bf16 v[216:219], a[48:51], a[4:7], v[216:219]
    v_exp_f32 v57, v57
    v_accvgpr_write_b32 a178, v52
    v_add_f32 v154, v154, v55
    v_fma_f32 v60, v60, s34, -v24
    v_mfma_f32_16x16x32_bf16 v[220:223], a[52:55], a[4:7], v[220:223]
    ds_read_b128 a[4:7], v2 offset:33792
    v_mfma_f32_16x16x32_bf16 v[224:227], a[48:51], a[8:11], v[224:227]
    v_exp_f32 v58, v58
    v_add_f32 v155, v155, v56
    v_cvt_pk_bf16_f32 v54, v54, v55
    v_fma_f32 v61, v61, s34, -v24
    v_mfma_f32_16x16x32_bf16 v[228:231], a[52:55], a[8:11], v[228:231]
    ds_read_b128 a[8:11], v2 offset:34816
    v_mfma_f32_16x16x32_bf16 v[232:235], a[48:51], a[12:15], v[232:235]
    v_exp_f32 v59, v59
    v_accvgpr_write_b32 a179, v54
    v_add_f32 v155, v155, v57
    v_fma_f32 v62, v62, s34, -v24
    v_mfma_f32_16x16x32_bf16 v[236:239], a[52:55], a[12:15], v[236:239]
    ds_read_b128 a[12:15], v2 offset:35840
    s_waitcnt lgkmcnt(4)
    v_mfma_f32_16x16x32_bf16 v[240:243], a[48:51], a[16:19], v[240:243]
    v_exp_f32 v60, v60
    v_add_f32 v155, v155, v58
    v_cvt_pk_bf16_f32 v56, v56, v57
    v_fma_f32 v63, v63, s34, -v24
    v_mfma_f32_16x16x32_bf16 v[244:247], a[52:55], a[16:19], v[244:247]
    ds_read_b128 a[16:19], v2 offset:36864
    v_mfma_f32_16x16x32_bf16 v[248:251], a[48:51], a[20:23], v[248:251]
    v_exp_f32 v61, v61
    v_accvgpr_write_b32 a180, v56
    v_add_f32 v155, v155, v59
    v_fma_f32 v64, v64, s34, -v25
    v_mfma_f32_16x16x32_bf16 v[252:255], a[52:55], a[20:23], v[252:255]
    ds_read_b128 a[20:23], v2 offset:37888
    v_mfma_f32_16x16x32_bf16 v[176:179], a[56:59], a[24:27], v[176:179]
    v_exp_f32 v62, v62
    v_add_f32 v155, v155, v60
    v_cvt_pk_bf16_f32 v58, v58, v59
    v_fma_f32 v65, v65, s34, -v25
    v_mfma_f32_16x16x32_bf16 v[180:183], a[60:63], a[24:27], v[180:183]
    ds_read_b128 a[24:27], v2 offset:38912
    v_mfma_f32_16x16x32_bf16 v[184:187], a[56:59], a[28:31], v[184:187]
    s_add_u32 m0, s29, 8192
    s_mov_b32 s32, 98304
    buffer_load_dwordx4 v10, s[12:15], s32 offen nt lds
    v_mfma_f32_16x16x32_bf16 v[188:191], a[60:63], a[28:31], v[188:191]
    ds_read_b128 a[28:31], v2 offset:39936
    s_waitcnt lgkmcnt(4)
    v_mfma_f32_16x16x32_bf16 v[192:195], a[56:59], a[0:3], v[192:195]
    v_exp_f32 v63, v63
    v_accvgpr_write_b32 a181, v58
    v_add_f32 v155, v155, v61
    v_fma_f32 v66, v66, s34, -v25
    v_mfma_f32_16x16x32_bf16 v[196:199], a[60:63], a[0:3], v[196:199]
    buffer_load_dwordx4 v11, s[12:15], s32 offen offset:1024 nt lds
    ds_read_b128 a[0:3], v3
    v_mfma_f32_16x16x32_bf16 v[200:203], a[56:59], a[4:7], v[200:203]
    v_exp_f32 v64, v64
    v_add_f32 v155, v155, v62
    v_cvt_pk_bf16_f32 v60, v60, v61
    v_mfma_f32_16x16x32_bf16 v[204:207], a[60:63], a[4:7], v[204:207]
    v_fma_f32 v67, v67, s34, -v25
    v_exp_f32 v65, v65
    ds_read_b128 a[4:7], v3 offset:1024
    v_mfma_f32_16x16x32_bf16 v[208:211], a[56:59], a[8:11], v[208:211]
    buffer_load_dwordx4 v12, s[12:15], s32 offen offset:2048 nt lds
    v_mfma_f32_16x16x32_bf16 v[212:215], a[60:63], a[8:11], v[212:215]
    v_accvgpr_write_b32 a182, v60
    v_add_f32 v155, v155, v63
    v_fma_f32 v68, v68, s34, -v25
    ds_read_b128 a[8:11], v3 offset:2048
    v_mfma_f32_16x16x32_bf16 v[216:219], a[56:59], a[12:15], v[216:219]
    v_exp_f32 v66, v66
    v_add_f32 v156, v156, v64
    v_cvt_pk_bf16_f32 v62, v62, v63
    v_fma_f32 v69, v69, s34, -v25
    v_mfma_f32_16x16x32_bf16 v[220:223], a[60:63], a[12:15], v[220:223]
    buffer_load_dwordx4 v13, s[12:15], s32 offen offset:3072 nt lds
    ds_read_b128 a[12:15], v3 offset:3072
    s_waitcnt lgkmcnt(4)
    v_mfma_f32_16x16x32_bf16 v[224:227], a[56:59], a[16:19], v[224:227]
    v_exp_f32 v67, v67
    v_accvgpr_write_b32 a183, v62
    v_mfma_f32_16x16x32_bf16 v[228:231], a[60:63], a[16:19], v[228:231]
    v_add_f32 v156, v156, v65
    v_fma_f32 v70, v70, s34, -v25
    v_exp_f32 v68, v68
    ds_read_b128 a[16:19], v3 offset:4096
    v_mfma_f32_16x16x32_bf16 v[232:235], a[56:59], a[20:23], v[232:235]
    v_add_f32 v156, v156, v66
    v_cvt_pk_bf16_f32 v64, v64, v65
    v_fma_f32 v71, v71, s34, -v25
    v_exp_f32 v69, v69
    v_mfma_f32_16x16x32_bf16 v[236:239], a[60:63], a[20:23], v[236:239]
    v_accvgpr_write_b32 a184, v64
    v_add_f32 v156, v156, v67
    v_fma_f32 v72, v72, s34, -v26
    ds_read_b128 a[20:23], v3 offset:5120
    v_mfma_f32_16x16x32_bf16 v[240:243], a[56:59], a[24:27], v[240:243]
    v_exp_f32 v70, v70
    v_add_f32 v156, v156, v68
    v_cvt_pk_bf16_f32 v66, v66, v67
    v_fma_f32 v73, v73, s34, -v26
    v_mfma_f32_16x16x32_bf16 v[244:247], a[60:63], a[24:27], v[244:247]
    ds_read_b128 a[24:27], v3 offset:6144
    v_mfma_f32_16x16x32_bf16 v[248:251], a[56:59], a[28:31], v[248:251]
    v_exp_f32 v71, v71
    v_accvgpr_write_b32 a185, v66
    v_add_f32 v156, v156, v69
    v_fma_f32 v74, v74, s34, -v26
    v_mfma_f32_16x16x32_bf16 v[252:255], a[60:63], a[28:31], v[252:255]
    ds_read_b128 a[28:31], v3 offset:7168
    s_waitcnt lgkmcnt(4)
    v_mfma_f32_16x16x32_bf16 v[176:179], a[64:67], a[0:3], v[176:179]
    v_exp_f32 v72, v72
    v_add_f32 v156, v156, v70
    v_cvt_pk_bf16_f32 v68, v68, v69
    v_fma_f32 v75, v75, s34, -v26
    v_mfma_f32_16x16x32_bf16 v[180:183], a[68:71], a[0:3], v[180:183]
    s_waitcnt vmcnt(12)
    ds_read_b64_tr_b16 a[48:49], v6 offset:12288
    ds_read_b64_tr_b16 a[50:51], v6 offset:14336
    s_waitcnt lgkmcnt(0)
    s_barrier
    ds_read_b128 a[0:3], v3 offset:8192
    v_mfma_f32_16x16x32_bf16 v[184:187], a[64:67], a[4:7], v[184:187]
    ds_read_b64_tr_b16 a[52:53], v7 offset:12288
    ds_read_b64_tr_b16 a[54:55], v7 offset:14336
    ds_read_b64_tr_b16 a[56:57], v8 offset:12288
    ds_read_b64_tr_b16 a[58:59], v8 offset:14336
    v_mfma_f32_16x16x32_bf16 v[188:191], a[68:71], a[4:7], v[188:191]
    ds_read_b64_tr_b16 a[60:61], v9 offset:12288
    ds_read_b64_tr_b16 a[62:63], v9 offset:14336
    ds_read_b128 a[4:7], v3 offset:9216
    v_mfma_f32_16x16x32_bf16 v[192:195], a[64:67], a[8:11], v[192:195]
    ds_write_b128 v16, v[112:115]
    v_mfma_f32_16x16x32_bf16 v[196:199], a[68:71], a[8:11], v[196:199]
    v_exp_f32 v73, v73
    v_accvgpr_write_b32 a186, v68
    ds_read_b128 a[8:11], v3 offset:10240
    v_mfma_f32_16x16x32_bf16 v[200:203], a[64:67], a[12:15], v[200:203]
    v_add_f32 v156, v156, v71
    v_fma_f32 v76, v76, s34, -v26
    v_exp_f32 v74, v74
    v_add_f32 v157, v157, v72
    v_mfma_f32_16x16x32_bf16 v[204:207], a[68:71], a[12:15], v[204:207]
    v_cvt_pk_bf16_f32 v70, v70, v71
    v_fma_f32 v77, v77, s34, -v26
    ds_read_b128 a[12:15], v3 offset:11264
    v_mfma_f32_16x16x32_bf16 v[208:211], a[64:67], a[16:19], v[208:211]
    v_exp_f32 v75, v75
    v_accvgpr_write_b32 a187, v70
    v_add_f32 v157, v157, v73
    v_fma_f32 v78, v78, s34, -v26
    v_mfma_f32_16x16x32_bf16 v[212:215], a[68:71], a[16:19], v[212:215]
    ds_write_b128 v16, v[116:119] offset:1024
    ds_read_b128 a[16:19], v3 offset:12288
    v_mfma_f32_16x16x32_bf16 v[216:219], a[64:67], a[20:23], v[216:219]
    v_exp_f32 v76, v76
    v_add_f32 v157, v157, v74
    v_mfma_f32_16x16x32_bf16 v[220:223], a[68:71], a[20:23], v[220:223]
    v_cvt_pk_bf16_f32 v72, v72, v73
    v_fma_f32 v79, v79, s34, -v26
    v_exp_f32 v77, v77
    ds_read_b128 a[20:23], v3 offset:13312
    v_mfma_f32_16x16x32_bf16 v[224:227], a[64:67], a[24:27], v[224:227]
    v_accvgpr_write_b32 a188, v72
    v_add_f32 v157, v157, v75
    v_fma_f32 v80, v80, s34, -v27
    v_exp_f32 v78, v78
    v_mfma_f32_16x16x32_bf16 v[228:231], a[68:71], a[24:27], v[228:231]
    v_add_f32 v157, v157, v76
    v_cvt_pk_bf16_f32 v74, v74, v75
    v_fma_f32 v81, v81, s34, -v27
    ds_read_b128 a[24:27], v3 offset:14336
    v_mfma_f32_16x16x32_bf16 v[232:235], a[64:67], a[28:31], v[232:235]
    ds_write_b128 v16, v[120:123] offset:2048
    v_mfma_f32_16x16x32_bf16 v[236:239], a[68:71], a[28:31], v[236:239]
    v_exp_f32 v79, v79
    ds_read_b128 a[28:31], v3 offset:15360
    s_waitcnt lgkmcnt(6)
    v_mfma_f32_16x16x32_bf16 v[240:243], a[64:67], a[0:3], v[240:243]
    v_accvgpr_write_b32 a189, v74
    v_add_f32 v157, v157, v77
    v_fma_f32 v82, v82, s34, -v27
    v_exp_f32 v80, v80
    v_mfma_f32_16x16x32_bf16 v[244:247], a[68:71], a[0:3], v[244:247]
    v_add_f32 v157, v157, v78
    v_cvt_pk_bf16_f32 v76, v76, v77
    v_fma_f32 v83, v83, s34, -v27
    ds_read_b128 a[0:3], v3 offset:16384
    v_mfma_f32_16x16x32_bf16 v[248:251], a[64:67], a[4:7], v[248:251]
    v_exp_f32 v81, v81
    v_accvgpr_write_b32 a190, v76
    v_add_f32 v157, v157, v79
    v_fma_f32 v84, v84, s34, -v27
    v_mfma_f32_16x16x32_bf16 v[252:255], a[68:71], a[4:7], v[252:255]
    ds_read_b128 a[4:7], v3 offset:17408
    v_mfma_f32_16x16x32_bf16 v[176:179], a[72:75], a[8:11], v[176:179]
    ds_write_b128 v16, v[124:127] offset:3072
    v_mfma_f32_16x16x32_bf16 v[180:183], a[76:79], a[8:11], v[180:183]
    v_exp_f32 v82, v82
    v_add_f32 v158, v158, v80
    ds_read_b128 a[8:11], v3 offset:18432
    v_mfma_f32_16x16x32_bf16 v[184:187], a[72:75], a[12:15], v[184:187]
    s_add_u32 m0, s29, 12288
    s_mov_b32 s32, 114688
    buffer_load_dwordx4 v10, s[12:15], s32 offen nt lds
    v_mfma_f32_16x16x32_bf16 v[188:191], a[76:79], a[12:15], v[188:191]
    v_cvt_pk_bf16_f32 v78, v78, v79
    ds_read_b128 a[12:15], v3 offset:19456
    s_waitcnt lgkmcnt(5)
    v_mfma_f32_16x16x32_bf16 v[192:195], a[72:75], a[16:19], v[192:195]
    v_fma_f32 v85, v85, s34, -v27
    v_exp_f32 v83, v83
    v_accvgpr_write_b32 a191, v78
    v_add_f32 v158, v158, v81
    v_mfma_f32_16x16x32_bf16 v[196:199], a[76:79], a[16:19], v[196:199]
    buffer_load_dwordx4 v11, s[12:15], s32 offen offset:1024 nt lds
    ds_write_b128 v16, v[128:131] offset:4096
    ds_read_b128 a[16:19], v3 offset:20480
    v_mfma_f32_16x16x32_bf16 v[200:203], a[72:75], a[20:23], v[200:203]
    v_fma_f32 v86, v86, s34, -v27
    v_exp_f32 v84, v84
    v_mfma_f32_16x16x32_bf16 v[204:207], a[76:79], a[20:23], v[204:207]
    v_add_f32 v158, v158, v82
    v_cvt_pk_bf16_f32 v80, v80, v81
    v_fma_f32 v87, v87, s34, -v27
    ds_read_b128 a[20:23], v3 offset:21504
    v_mfma_f32_16x16x32_bf16 v[208:211], a[72:75], a[24:27], v[208:211]
    buffer_load_dwordx4 v12, s[12:15], s32 offen offset:2048 nt lds
    v_mfma_f32_16x16x32_bf16 v[212:215], a[76:79], a[24:27], v[212:215]
    v_exp_f32 v85, v85
    v_accvgpr_write_b32 a192, v80
    v_add_f32 v158, v158, v83
    ds_read_b128 a[24:27], v3 offset:22528
    v_mfma_f32_16x16x32_bf16 v[216:219], a[72:75], a[28:31], v[216:219]
    v_fma_f32 v88, v88, s34, -v28
    v_exp_f32 v86, v86
    v_add_f32 v158, v158, v84
    v_cvt_pk_bf16_f32 v82, v82, v83
    v_mfma_f32_16x16x32_bf16 v[220:223], a[76:79], a[28:31], v[220:223]
    buffer_load_dwordx4 v13, s[12:15], s32 offen offset:3072 nt lds
    ds_write_b128 v16, v[132:135] offset:5120
    ds_read_b128 a[28:31], v3 offset:23552
    s_waitcnt lgkmcnt(6)
    v_mfma_f32_16x16x32_bf16 v[224:227], a[72:75], a[0:3], v[224:227]
    v_fma_f32 v89, v89, s34, -v28
    v_exp_f32 v87, v87
    v_mfma_f32_16x16x32_bf16 v[228:231], a[76:79], a[0:3], v[228:231]
    v_accvgpr_write_b32 a193, v82
    v_add_f32 v158, v158, v85
    v_fma_f32 v90, v90, s34, -v28
    ds_read_b128 a[0:3], v3 offset:24576
    v_mfma_f32_16x16x32_bf16 v[232:235], a[72:75], a[4:7], v[232:235]
    v_exp_f32 v88, v88
    v_add_f32 v158, v158, v86
    v_cvt_pk_bf16_f32 v84, v84, v85
    v_fma_f32 v91, v91, s34, -v28
    v_mfma_f32_16x16x32_bf16 v[236:239], a[76:79], a[4:7], v[236:239]
    v_exp_f32 v89, v89
    v_accvgpr_write_b32 a194, v84
    v_add_f32 v158, v158, v87
    ds_read_b128 a[4:7], v3 offset:25600
    v_mfma_f32_16x16x32_bf16 v[240:243], a[72:75], a[8:11], v[240:243]
    ds_write_b128 v16, v[136:139] offset:6144
    v_mfma_f32_16x16x32_bf16 v[244:247], a[76:79], a[8:11], v[244:247]
    v_fma_f32 v92, v92, s34, -v28
    ds_read_b128 a[8:11], v3 offset:26624
    v_mfma_f32_16x16x32_bf16 v[248:251], a[72:75], a[12:15], v[248:251]
    v_exp_f32 v90, v90
    v_add_f32 v159, v159, v88
    v_cvt_pk_bf16_f32 v86, v86, v87
    v_fma_f32 v93, v93, s34, -v28
    v_mfma_f32_16x16x32_bf16 v[252:255], a[76:79], a[12:15], v[252:255]
    v_exp_f32 v91, v91
    v_accvgpr_write_b32 a195, v86
    ds_read_b128 a[12:15], v3 offset:27648
    s_waitcnt lgkmcnt(5)
    v_mfma_f32_16x16x32_bf16 v[176:179], a[80:83], a[16:19], v[176:179]
    v_add_f32 v159, v159, v89
    v_fma_f32 v94, v94, s34, -v28
    v_exp_f32 v92, v92
    v_mfma_f32_16x16x32_bf16 v[180:183], a[84:87], a[16:19], v[180:183]
    ds_write_b128 v16, v[140:143] offset:7168
    ds_read_b128 a[16:19], v3 offset:28672
    v_mfma_f32_16x16x32_bf16 v[184:187], a[80:83], a[20:23], v[184:187]
    v_add_f32 v159, v159, v90
    v_cvt_pk_bf16_f32 v88, v88, v89
    v_fma_f32 v95, v95, s34, -v28
    v_mfma_f32_16x16x32_bf16 v[188:191], a[84:87], a[20:23], v[188:191]
    v_exp_f32 v93, v93
    s_waitcnt vmcnt(12)
    ds_read_b128 a[20:23], v3 offset:29696
    v_mfma_f32_16x16x32_bf16 v[192:195], a[80:83], a[24:27], v[192:195]
    v_accvgpr_write_b32 a196, v88
    ds_read_b64_tr_b16 a[64:65], v6
    v_add_f32 v159, v159, v91
    ds_read_b64_tr_b16 a[66:67], v6 offset:2048
    v_fma_f32 v96, v96, s34, -v29
    v_mfma_f32_16x16x32_bf16 v[196:199], a[84:87], a[24:27], v[196:199]
    v_exp_f32 v94, v94
    ds_read_b64_tr_b16 a[68:69], v7
    ds_read_b128 a[24:27], v3 offset:30720
    v_mfma_f32_16x16x32_bf16 v[200:203], a[80:83], a[28:31], v[200:203]
    ds_read_b64_tr_b16 a[70:71], v7 offset:2048
    v_add_f32 v159, v159, v92
    ds_read_b64_tr_b16 a[72:73], v8
    v_cvt_pk_bf16_f32 v90, v90, v91
    v_mfma_f32_16x16x32_bf16 v[204:207], a[84:87], a[28:31], v[204:207]
    ds_write_b128 v16, v[144:147] offset:8192
    ds_read_b128 a[28:31], v3 offset:31744
    s_waitcnt lgkmcnt(11)
    v_mfma_f32_16x16x32_bf16 v[208:211], a[80:83], a[0:3], v[208:211]
    v_fma_f32 v97, v97, s34, -v29
    v_exp_f32 v95, v95
    v_mfma_f32_16x16x32_bf16 v[212:215], a[84:87], a[0:3], v[212:215]
    ds_read_b64_tr_b16 a[74:75], v8 offset:2048
    ds_read_b64_tr_b16 a[76:77], v9
    v_accvgpr_write_b32 a197, v90
    ds_read_b128 a[0:3], v3 offset:32768
    v_mfma_f32_16x16x32_bf16 v[216:219], a[80:83], a[4:7], v[216:219]
    ds_read_b64_tr_b16 a[78:79], v9 offset:2048
    v_add_f32 v159, v159, v93
    v_fma_f32 v98, v98, s34, -v29
    v_mfma_f32_16x16x32_bf16 v[220:223], a[84:87], a[4:7], v[220:223]
    v_exp_f32 v96, v96
    v_add_f32 v159, v159, v94
    v_cvt_pk_bf16_f32 v92, v92, v93
    ds_read_b128 a[4:7], v3 offset:33792
    v_mfma_f32_16x16x32_bf16 v[224:227], a[80:83], a[8:11], v[224:227]
    ds_write_b128 v16, v[148:151] offset:9216
    v_mfma_f32_16x16x32_bf16 v[228:231], a[84:87], a[8:11], v[228:231]
    v_fma_f32 v99, v99, s34, -v29
    ds_read_b128 a[8:11], v3 offset:34816
    v_mfma_f32_16x16x32_bf16 v[232:235], a[80:83], a[12:15], v[232:235]
    v_exp_f32 v97, v97
    v_accvgpr_write_b32 a198, v92
    v_add_f32 v159, v159, v95
    v_fma_f32 v100, v100, s34, -v29
    v_mfma_f32_16x16x32_bf16 v[236:239], a[84:87], a[12:15], v[236:239]
    v_exp_f32 v98, v98
    v_add_f32 v160, v160, v96
    ds_read_b128 a[12:15], v3 offset:35840
    s_waitcnt lgkmcnt(8)
    v_mfma_f32_16x16x32_bf16 v[240:243], a[80:83], a[16:19], v[240:243]
    v_cvt_pk_bf16_f32 v94, v94, v95
    v_fma_f32 v101, v101, s34, -v29
    v_exp_f32 v99, v99
    v_mfma_f32_16x16x32_bf16 v[244:247], a[84:87], a[16:19], v[244:247]
    v_accvgpr_write_b32 a199, v94
    v_add_f32 v160, v160, v97
    v_fma_f32 v102, v102, s34, -v29
    ds_read_b128 a[16:19], v3 offset:36864
    v_mfma_f32_16x16x32_bf16 v[248:251], a[80:83], a[20:23], v[248:251]
    v_exp_f32 v100, v100
    v_add_f32 v160, v160, v98
    v_cvt_pk_bf16_f32 v96, v96, v97
    v_fma_f32 v103, v103, s34, -v29
    v_mfma_f32_16x16x32_bf16 v[252:255], a[84:87], a[20:23], v[252:255]
    v_exp_f32 v101, v101
    v_accvgpr_write_b32 a200, v96
    v_add_f32 v160, v160, v99
    ds_read_b128 a[20:23], v3 offset:37888
    v_mfma_f32_16x16x32_bf16 v[176:179], a[88:91], a[24:27], v[176:179]
    v_fma_f32 v104, v104, s34, -v30
    v_exp_f32 v102, v102
    v_add_f32 v160, v160, v100
    v_mfma_f32_16x16x32_bf16 v[180:183], a[92:95], a[24:27], v[180:183]
    v_cvt_pk_bf16_f32 v98, v98, v99
    v_fma_f32 v105, v105, s34, -v30
    ds_read_b128 a[24:27], v3 offset:38912
    v_mfma_f32_16x16x32_bf16 v[184:187], a[88:91], a[28:31], v[184:187]
    s_waitcnt lgkmcnt(7)
    s_add_u32 m0, s29, 0
    s_mov_b32 s32, 131072
    buffer_load_dwordx4 v10, s[12:15], s32 offen nt lds
    v_mfma_f32_16x16x32_bf16 v[188:191], a[92:95], a[28:31], v[188:191]
    s_waitcnt lgkmcnt(0)
    s_barrier
    ds_read_b128 a[28:31], v3 offset:39936
    v_mfma_f32_16x16x32_bf16 v[192:195], a[88:91], a[0:3], v[192:195]
    v_exp_f32 v103, v103
    v_accvgpr_write_b32 a201, v98
    v_add_f32 v160, v160, v101
    v_fma_f32 v106, v106, s34, -v30
    v_mfma_f32_16x16x32_bf16 v[196:199], a[92:95], a[0:3], v[196:199]
    buffer_load_dwordx4 v11, s[12:15], s32 offen offset:1024 nt lds
    ds_read_b128 a[0:3], v2
    v_mfma_f32_16x16x32_bf16 v[200:203], a[88:91], a[4:7], v[200:203]
    v_exp_f32 v104, v104
    v_add_f32 v160, v160, v102
    v_mfma_f32_16x16x32_bf16 v[204:207], a[92:95], a[4:7], v[204:207]
    v_cvt_pk_bf16_f32 v100, v100, v101
    v_fma_f32 v107, v107, s34, -v30
    v_exp_f32 v105, v105
    ds_read_b128 a[4:7], v2 offset:1024
    v_mfma_f32_16x16x32_bf16 v[208:211], a[88:91], a[8:11], v[208:211]
    buffer_load_dwordx4 v12, s[12:15], s32 offen offset:2048 nt lds
    v_mfma_f32_16x16x32_bf16 v[212:215], a[92:95], a[8:11], v[212:215]
    v_accvgpr_write_b32 a202, v100
    v_add_f32 v160, v160, v103
    v_fma_f32 v108, v108, s34, -v30
    ds_read_b128 a[8:11], v2 offset:2048
    v_mfma_f32_16x16x32_bf16 v[216:219], a[88:91], a[12:15], v[216:219]
    v_exp_f32 v106, v106
    v_add_f32 v161, v161, v104
    v_cvt_pk_bf16_f32 v102, v102, v103
    v_mfma_f32_16x16x32_bf16 v[220:223], a[92:95], a[12:15], v[220:223]
    buffer_load_dwordx4 v13, s[12:15], s32 offen offset:3072 nt lds
    ds_read_b128 a[12:15], v2 offset:3072
    s_waitcnt lgkmcnt(4)
    v_mfma_f32_16x16x32_bf16 v[224:227], a[88:91], a[16:19], v[224:227]
    v_fma_f32 v109, v109, s34, -v30
    v_exp_f32 v107, v107
    v_mfma_f32_16x16x32_bf16 v[228:231], a[92:95], a[16:19], v[228:231]
    v_accvgpr_write_b32 a203, v102
    v_add_f32 v161, v161, v105
    v_fma_f32 v110, v110, s34, -v30
    ds_read_b128 a[16:19], v2 offset:4096
    v_mfma_f32_16x16x32_bf16 v[232:235], a[88:91], a[20:23], v[232:235]
    v_exp_f32 v108, v108
    v_add_f32 v161, v161, v106
    v_cvt_pk_bf16_f32 v104, v104, v105
    v_fma_f32 v111, v111, s34, -v30
    v_mfma_f32_16x16x32_bf16 v[236:239], a[92:95], a[20:23], v[236:239]
    v_exp_f32 v109, v109
    v_accvgpr_write_b32 a204, v104
    ds_read_b128 a[20:23], v2 offset:5120
    v_mfma_f32_16x16x32_bf16 v[240:243], a[88:91], a[24:27], v[240:243]
    v_add_f32 v161, v161, v107
    v_exp_f32 v110, v110
    v_add_f32 v161, v161, v108
    v_cvt_pk_bf16_f32 v106, v106, v107
    v_mfma_f32_16x16x32_bf16 v[244:247], a[92:95], a[24:27], v[244:247]
    ds_read_b128 a[24:27], v2 offset:6144
    v_mfma_f32_16x16x32_bf16 v[248:251], a[88:91], a[28:31], v[248:251]
    v_exp_f32 v111, v111
    v_accvgpr_write_b32 a205, v106
    v_add_f32 v161, v161, v109
    v_add_f32 v161, v161, v110
    v_cvt_pk_bf16_f32 v108, v108, v109
    v_add_f32 v161, v161, v111
    v_mfma_f32_16x16x32_bf16 v[252:255], a[92:95], a[28:31], v[252:255]
    v_cvt_pk_bf16_f32 v110, v110, v111
    v_accvgpr_write_b32 a206, v108
    v_accvgpr_write_b32 a207, v110
    ds_read_b128 a[28:31], v2 offset:7168
    s_waitcnt lgkmcnt(4)
    v_mfma_f32_16x16x32_bf16 v[32:35], a[136:139], a[0:3], 0
    v_fma_f32 v176, v176, s34, -v21
    v_fma_f32 v177, v177, s34, -v21
    v_fma_f32 v178, v178, s34, -v21
    v_mfma_f32_16x16x32_bf16 v[36:39], a[140:143], a[0:3], 0
    s_waitcnt vmcnt(12)
    ds_read_b64_tr_b16 a[80:81], v6 offset:4096
    v_mfma_f32_16x16x32_bf16 v[40:43], a[144:147], a[0:3], 0
    ds_read_b64_tr_b16 a[82:83], v6 offset:6144
    ds_read_b64_tr_b16 a[84:85], v7 offset:4096
    ds_read_b64_tr_b16 a[86:87], v7 offset:6144
    v_mfma_f32_16x16x32_bf16 v[44:47], a[148:151], a[0:3], 0
    ds_read_b64_tr_b16 a[88:89], v8 offset:4096
    ds_read_b128 a[0:3], v2 offset:8192
    v_mfma_f32_16x16x32_bf16 v[48:51], a[136:139], a[4:7], 0
    ds_read_b64_tr_b16 a[90:91], v8 offset:6144
    ds_read_b64_tr_b16 a[92:93], v9 offset:4096
    ds_read_b64_tr_b16 a[94:95], v9 offset:6144
    v_mfma_f32_16x16x32_bf16 v[52:55], a[140:143], a[4:7], 0
    v_exp_f32 v176, v176
    v_mfma_f32_16x16x32_bf16 v[56:59], a[144:147], a[4:7], 0
    v_fma_f32 v179, v179, s34, -v21
    v_mfma_f32_16x16x32_bf16 v[60:63], a[148:151], a[4:7], 0
    v_exp_f32 v177, v177
    s_waitcnt lgkmcnt(0)
    s_barrier
    ds_read_b128 a[4:7], v2 offset:9216
    v_mfma_f32_16x16x32_bf16 v[64:67], a[136:139], a[8:11], 0
    v_fma_f32 v180, v180, s34, -v21
    v_mfma_f32_16x16x32_bf16 v[68:71], a[140:143], a[8:11], 0
    v_exp_f32 v178, v178
    v_add_f32 v152, v152, v176
    v_fma_f32 v181, v181, s34, -v21
    v_mfma_f32_16x16x32_bf16 v[72:75], a[144:147], a[8:11], 0
    ds_write_b128 v16, a[208:211] offset:40960
    v_mfma_f32_16x16x32_bf16 v[76:79], a[148:151], a[8:11], 0
    ds_read_b128 a[8:11], v2 offset:10240
    v_mfma_f32_16x16x32_bf16 v[80:83], a[136:139], a[12:15], 0
    v_exp_f32 v179, v179
    v_add_f32 v152, v152, v177
    v_mfma_f32_16x16x32_bf16 v[84:87], a[140:143], a[12:15], 0
    v_fma_f32 v182, v182, s34, -v21
    v_mfma_f32_16x16x32_bf16 v[88:91], a[144:147], a[12:15], 0
    v_exp_f32 v180, v180
    v_add_f32 v152, v152, v178
    v_cvt_pk_bf16_f32 v176, v176, v177
    v_mfma_f32_16x16x32_bf16 v[92:95], a[148:151], a[12:15], 0
    v_fma_f32 v183, v183, s34, -v21
    ds_read_b128 a[12:15], v2 offset:11264
    v_mfma_f32_16x16x32_bf16 v[96:99], a[136:139], a[16:19], 0
    v_exp_f32 v181, v181
    v_add_f32 v152, v152, v179
    v_mfma_f32_16x16x32_bf16 v[100:103], a[140:143], a[16:19], 0
    v_fma_f32 v184, v184, s34, -v22
    v_mfma_f32_16x16x32_bf16 v[104:107], a[144:147], a[16:19], 0
    v_exp_f32 v182, v182
    v_add_f32 v152, v152, v180
    v_cvt_pk_bf16_f32 v177, v178, v179
    v_mfma_f32_16x16x32_bf16 v[108:111], a[148:151], a[16:19], 0
    v_fma_f32 v185, v185, s34, -v22
    ds_read_b128 a[16:19], v2 offset:12288
    v_mfma_f32_16x16x32_bf16 v[112:115], a[136:139], a[20:23], 0
    ds_write_b128 v16, a[212:215] offset:41984
    v_mfma_f32_16x16x32_bf16 v[116:119], a[140:143], a[20:23], 0
    v_exp_f32 v183, v183
    v_mfma_f32_16x16x32_bf16 v[120:123], a[144:147], a[20:23], 0
    s_add_u32 m0, s29, 4096
    s_mov_b32 s32, 147456
    buffer_load_dwordx4 v10, s[12:15], s32 offen nt lds
    v_mfma_f32_16x16x32_bf16 v[124:127], a[148:151], a[20:23], 0
    ds_read_b128 a[20:23], v2 offset:13312
    v_mfma_f32_16x16x32_bf16 v[128:131], a[136:139], a[24:27], 0
    v_add_f32 v152, v152, v181
    v_fma_f32 v186, v186, s34, -v22
    v_mfma_f32_16x16x32_bf16 v[132:135], a[140:143], a[24:27], 0
    buffer_load_dwordx4 v11, s[12:15], s32 offen offset:1024 nt lds
    v_mfma_f32_16x16x32_bf16 v[136:139], a[144:147], a[24:27], 0
    v_exp_f32 v184, v184
    v_mfma_f32_16x16x32_bf16 v[140:143], a[148:151], a[24:27], 0
    v_add_f32 v152, v152, v182
    v_cvt_pk_bf16_f32 v178, v180, v181
    ds_read_b128 a[24:27], v2 offset:14336
    v_mfma_f32_16x16x32_bf16 v[144:147], a[136:139], a[28:31], 0
    buffer_load_dwordx4 v12, s[12:15], s32 offen offset:2048 nt lds
    v_mfma_f32_16x16x32_bf16 v[148:151], a[140:143], a[28:31], 0
    v_fma_f32 v187, v187, s34, -v22
    v_mfma_f32_16x16x32_bf16 a[96:99], a[144:147], a[28:31], 0
    v_exp_f32 v185, v185
    v_add_f32 v152, v152, v183
    v_fma_f32 v188, v188, s34, -v22
    v_mfma_f32_16x16x32_bf16 a[100:103], a[148:151], a[28:31], 0
    buffer_load_dwordx4 v13, s[12:15], s32 offen offset:3072 nt lds
    ds_write_b128 v16, a[216:219] offset:43008
    ds_read_b128 a[28:31], v2 offset:15360
    s_waitcnt lgkmcnt(6)
    v_mfma_f32_16x16x32_bf16 a[104:107], a[136:139], a[0:3], 0
    v_exp_f32 v186, v186
    v_mfma_f32_16x16x32_bf16 a[108:111], a[140:143], a[0:3], 0
    v_add_f32 v153, v153, v184
    v_cvt_pk_bf16_f32 v179, v182, v183
    v_fma_f32 v189, v189, s34, -v22
    v_mfma_f32_16x16x32_bf16 a[112:115], a[144:147], a[0:3], 0
    v_exp_f32 v187, v187
    v_add_f32 v153, v153, v185
    v_mfma_f32_16x16x32_bf16 a[116:119], a[148:151], a[0:3], 0
    v_fma_f32 v190, v190, s34, -v22
    ds_read_b128 a[0:3], v2 offset:16384
    v_mfma_f32_16x16x32_bf16 a[120:123], a[136:139], a[4:7], 0
    v_exp_f32 v188, v188
    v_add_f32 v153, v153, v186
    v_cvt_pk_bf16_f32 v180, v184, v185
    v_mfma_f32_16x16x32_bf16 a[124:127], a[140:143], a[4:7], 0
    v_fma_f32 v191, v191, s34, -v22
    v_mfma_f32_16x16x32_bf16 a[128:131], a[144:147], a[4:7], 0
    v_exp_f32 v189, v189
    v_add_f32 v153, v153, v187
    v_fma_f32 v192, v192, s34, -v23
    v_mfma_f32_16x16x32_bf16 a[132:135], a[148:151], a[4:7], 0
    ds_read_b128 a[4:7], v2 offset:17408
    v_mfma_f32_16x16x32_bf16 v[32:35], a[152:155], a[8:11], v[32:35]
    v_exp_f32 v190, v190
    v_add_f32 v153, v153, v188
    v_cvt_pk_bf16_f32 v181, v186, v187
    v_mfma_f32_16x16x32_bf16 v[36:39], a[156:159], a[8:11], v[36:39]
    s_waitcnt vmcnt(12)
    ds_read_b64_tr_b16 a[136:137], v6 offset:8192
    v_mfma_f32_16x16x32_bf16 v[40:43], a[160:163], a[8:11], v[40:43]
    ds_write_b128 v16, a[220:223] offset:44032
    v_mfma_f32_16x16x32_bf16 v[44:47], a[164:167], a[8:11], v[44:47]
    ds_read_b128 a[8:11], v2 offset:18432
    v_mfma_f32_16x16x32_bf16 v[48:51], a[152:155], a[12:15], v[48:51]
    ds_read_b64_tr_b16 a[138:139], v6 offset:10240
    ds_read_b64_tr_b16 a[140:141], v7 offset:8192
    ds_read_b64_tr_b16 a[142:143], v7 offset:10240
    v_mfma_f32_16x16x32_bf16 v[52:55], a[156:159], a[12:15], v[52:55]
    ds_read_b64_tr_b16 a[144:145], v8 offset:8192
    ds_read_b64_tr_b16 a[146:147], v8 offset:10240
    v_mfma_f32_16x16x32_bf16 v[56:59], a[160:163], a[12:15], v[56:59]
    ds_read_b64_tr_b16 a[148:149], v9 offset:8192
    ds_read_b64_tr_b16 a[150:151], v9 offset:10240
    v_mfma_f32_16x16x32_bf16 v[60:63], a[164:167], a[12:15], v[60:63]
    ds_read_b128 a[12:15], v2 offset:19456
    s_waitcnt lgkmcnt(13)
    v_mfma_f32_16x16x32_bf16 v[64:67], a[152:155], a[16:19], v[64:67]
    v_fma_f32 v193, v193, s34, -v23
    v_exp_f32 v191, v191
    v_add_f32 v153, v153, v189
    v_mfma_f32_16x16x32_bf16 v[68:71], a[156:159], a[16:19], v[68:71]
    v_fma_f32 v194, v194, s34, -v23
    v_mfma_f32_16x16x32_bf16 v[72:75], a[160:163], a[16:19], v[72:75]
    v_exp_f32 v192, v192
    v_add_f32 v153, v153, v190
    v_cvt_pk_bf16_f32 v182, v188, v189
    v_mfma_f32_16x16x32_bf16 v[76:79], a[164:167], a[16:19], v[76:79]
    v_fma_f32 v195, v195, s34, -v23
    ds_read_b128 a[16:19], v2 offset:20480
    v_mfma_f32_16x16x32_bf16 v[80:83], a[152:155], a[20:23], v[80:83]
    v_exp_f32 v193, v193
    v_add_f32 v153, v153, v191
    v_fma_f32 v196, v196, s34, -v23
    v_mfma_f32_16x16x32_bf16 v[84:87], a[156:159], a[20:23], v[84:87]
    ds_write_b128 v16, a[224:227] offset:45056
    v_mfma_f32_16x16x32_bf16 v[88:91], a[160:163], a[20:23], v[88:91]
    v_exp_f32 v194, v194
    v_mfma_f32_16x16x32_bf16 v[92:95], a[164:167], a[20:23], v[92:95]
    v_add_f32 v154, v154, v192
    ds_read_b128 a[20:23], v2 offset:21504
    v_mfma_f32_16x16x32_bf16 v[96:99], a[152:155], a[24:27], v[96:99]
    v_cvt_pk_bf16_f32 v183, v190, v191
    v_fma_f32 v197, v197, s34, -v23
    v_mfma_f32_16x16x32_bf16 v[100:103], a[156:159], a[24:27], v[100:103]
    v_exp_f32 v195, v195
    v_add_f32 v154, v154, v193
    v_fma_f32 v198, v198, s34, -v23
    v_mfma_f32_16x16x32_bf16 v[104:107], a[160:163], a[24:27], v[104:107]
    v_mfma_f32_16x16x32_bf16 v[108:111], a[164:167], a[24:27], v[108:111]
    v_exp_f32 v196, v196
    ds_read_b128 a[24:27], v2 offset:22528
    v_mfma_f32_16x16x32_bf16 v[112:115], a[152:155], a[28:31], v[112:115]
    v_add_f32 v154, v154, v194
    v_cvt_pk_bf16_f32 v184, v192, v193
    v_fma_f32 v199, v199, s34, -v23
    v_mfma_f32_16x16x32_bf16 v[116:119], a[156:159], a[28:31], v[116:119]
    v_exp_f32 v197, v197
    v_add_f32 v154, v154, v195
    v_fma_f32 v200, v200, s34, -v24
    v_mfma_f32_16x16x32_bf16 v[120:123], a[160:163], a[28:31], v[120:123]
    s_waitcnt lgkmcnt(5)
    s_add_u32 m0, s29, 8192
    s_mov_b32 s32, 163840
    buffer_load_dwordx4 v10, s[12:15], s32 offen nt lds
    v_mfma_f32_16x16x32_bf16 v[124:127], a[164:167], a[28:31], v[124:127]
    ds_read_b128 a[28:31], v2 offset:23552
    s_waitcnt lgkmcnt(5)
    v_mfma_f32_16x16x32_bf16 v[128:131], a[152:155], a[0:3], v[128:131]
    ds_write_b128 v16, a[228:231] offset:46080
    v_mfma_f32_16x16x32_bf16 v[132:135], a[156:159], a[0:3], v[132:135]
    buffer_load_dwordx4 v11, s[12:15], s32 offen offset:1024 nt lds
    v_mfma_f32_16x16x32_bf16 v[136:139], a[160:163], a[0:3], v[136:139]
    v_exp_f32 v198, v198
    v_mfma_f32_16x16x32_bf16 v[140:143], a[164:167], a[0:3], v[140:143]
    v_add_f32 v154, v154, v196
    ds_read_b128 a[0:3], v2 offset:24576
    v_mfma_f32_16x16x32_bf16 v[144:147], a[152:155], a[4:7], v[144:147]
    buffer_load_dwordx4 v12, s[12:15], s32 offen offset:2048 nt lds
    v_mfma_f32_16x16x32_bf16 v[148:151], a[156:159], a[4:7], v[148:151]
    v_cvt_pk_bf16_f32 v185, v194, v195
    v_fma_f32 v201, v201, s34, -v24
    v_mfma_f32_16x16x32_bf16 a[96:99], a[160:163], a[4:7], a[96:99]
    v_exp_f32 v199, v199
    v_add_f32 v154, v154, v197
    v_mfma_f32_16x16x32_bf16 a[100:103], a[164:167], a[4:7], a[100:103]
    buffer_load_dwordx4 v13, s[12:15], s32 offen offset:3072 nt lds
    ds_read_b128 a[4:7], v2 offset:25600
    v_mfma_f32_16x16x32_bf16 a[104:107], a[152:155], a[8:11], a[104:107]
    v_fma_f32 v202, v202, s34, -v24
    v_mfma_f32_16x16x32_bf16 a[108:111], a[156:159], a[8:11], a[108:111]
    v_exp_f32 v200, v200
    v_add_f32 v154, v154, v198
    v_cvt_pk_bf16_f32 v186, v196, v197
    v_mfma_f32_16x16x32_bf16 a[112:115], a[160:163], a[8:11], a[112:115]
    ds_write_b128 v16, a[232:235] offset:47104
    v_mfma_f32_16x16x32_bf16 a[116:119], a[164:167], a[8:11], a[116:119]
    ds_read_b128 a[8:11], v2 offset:26624
    v_mfma_f32_16x16x32_bf16 a[120:123], a[152:155], a[12:15], a[120:123]
    v_fma_f32 v203, v203, s34, -v24
    v_exp_f32 v201, v201
    v_mfma_f32_16x16x32_bf16 a[124:127], a[156:159], a[12:15], a[124:127]
    v_add_f32 v154, v154, v199
    v_fma_f32 v204, v204, s34, -v24
    v_mfma_f32_16x16x32_bf16 a[128:131], a[160:163], a[12:15], a[128:131]
    v_exp_f32 v202, v202
    v_add_f32 v155, v155, v200
    v_cvt_pk_bf16_f32 v187, v198, v199
    v_mfma_f32_16x16x32_bf16 a[132:135], a[164:167], a[12:15], a[132:135]
    ds_read_b128 a[12:15], v2 offset:27648
    s_waitcnt lgkmcnt(6)
    v_mfma_f32_16x16x32_bf16 v[32:35], a[32:35], a[16:19], v[32:35]
    v_fma_f32 v205, v205, s34, -v24
    v_exp_f32 v203, v203
    v_mfma_f32_16x16x32_bf16 v[36:39], a[36:39], a[16:19], v[36:39]
    s_waitcnt vmcnt(12)
    ds_read_b64_tr_b16 a[152:153], v6 offset:12288
    ds_read_b64_tr_b16 a[154:155], v6 offset:14336
    v_mfma_f32_16x16x32_bf16 v[40:43], a[40:43], a[16:19], v[40:43]
    ds_read_b64_tr_b16 a[156:157], v7 offset:12288
    ds_read_b64_tr_b16 a[158:159], v7 offset:14336
    v_mfma_f32_16x16x32_bf16 v[44:47], a[44:47], a[16:19], v[44:47]
    ds_read_b64_tr_b16 a[160:161], v8 offset:12288
    ds_read_b64_tr_b16 a[162:163], v8 offset:14336
    ds_read_b128 a[16:19], v2 offset:28672
    v_mfma_f32_16x16x32_bf16 v[48:51], a[32:35], a[20:23], v[48:51]
    ds_read_b64_tr_b16 a[164:165], v9 offset:12288
    ds_read_b64_tr_b16 a[166:167], v9 offset:14336
    v_mfma_f32_16x16x32_bf16 v[52:55], a[36:39], a[20:23], v[52:55]
    ds_write_b128 v16, a[236:239] offset:48128
    v_mfma_f32_16x16x32_bf16 v[56:59], a[40:43], a[20:23], v[56:59]
    v_mfma_f32_16x16x32_bf16 v[60:63], a[44:47], a[20:23], v[60:63]
    v_add_f32 v155, v155, v201
    v_fma_f32 v206, v206, s34, -v24
    ds_read_b128 a[20:23], v2 offset:29696
    v_mfma_f32_16x16x32_bf16 v[64:67], a[32:35], a[24:27], v[64:67]
    v_exp_f32 v204, v204
    v_add_f32 v155, v155, v202
    v_mfma_f32_16x16x32_bf16 v[68:71], a[36:39], a[24:27], v[68:71]
    v_cvt_pk_bf16_f32 v188, v200, v201
    v_fma_f32 v207, v207, s34, -v24
    v_mfma_f32_16x16x32_bf16 v[72:75], a[40:43], a[24:27], v[72:75]
    v_exp_f32 v205, v205
    v_add_f32 v155, v155, v203
    v_fma_f32 v208, v208, s34, -v25
    v_mfma_f32_16x16x32_bf16 v[76:79], a[44:47], a[24:27], v[76:79]
    ds_read_b128 a[24:27], v2 offset:30720
    v_mfma_f32_16x16x32_bf16 v[80:83], a[32:35], a[28:31], v[80:83]
    v_exp_f32 v206, v206
    v_add_f32 v155, v155, v204
    v_cvt_pk_bf16_f32 v189, v202, v203
    v_mfma_f32_16x16x32_bf16 v[84:87], a[36:39], a[28:31], v[84:87]
    v_fma_f32 v209, v209, s34, -v25
    v_mfma_f32_16x16x32_bf16 v[88:91], a[40:43], a[28:31], v[88:91]
    v_exp_f32 v207, v207
    v_add_f32 v155, v155, v205
    v_fma_f32 v210, v210, s34, -v25
    v_mfma_f32_16x16x32_bf16 v[92:95], a[44:47], a[28:31], v[92:95]
    ds_read_b128 a[28:31], v2 offset:31744
    s_waitcnt lgkmcnt(13)
    v_mfma_f32_16x16x32_bf16 v[96:99], a[32:35], a[0:3], v[96:99]
    ds_write_b128 v16, a[240:243] offset:49152
    v_mfma_f32_16x16x32_bf16 v[100:103], a[36:39], a[0:3], v[100:103]
    v_exp_f32 v208, v208
    v_mfma_f32_16x16x32_bf16 v[104:107], a[40:43], a[0:3], v[104:107]
    v_add_f32 v155, v155, v206
    v_cvt_pk_bf16_f32 v190, v204, v205
    v_fma_f32 v211, v211, s34, -v25
    v_mfma_f32_16x16x32_bf16 v[108:111], a[44:47], a[0:3], v[108:111]
    ds_read_b128 a[0:3], v2 offset:32768
    v_mfma_f32_16x16x32_bf16 v[112:115], a[32:35], a[4:7], v[112:115]
    v_exp_f32 v209, v209
    v_add_f32 v155, v155, v207
    v_fma_f32 v212, v212, s34, -v25
    v_mfma_f32_16x16x32_bf16 v[116:119], a[36:39], a[4:7], v[116:119]
    v_mfma_f32_16x16x32_bf16 v[120:123], a[40:43], a[4:7], v[120:123]
    s_waitcnt lgkmcnt(5)
    s_add_u32 m0, s29, 12288
    s_mov_b32 s32, 180224
    buffer_load_dwordx4 v10, s[12:15], s32 offen nt lds
    v_mfma_f32_16x16x32_bf16 v[124:127], a[44:47], a[4:7], v[124:127]
    ds_read_b128 a[4:7], v2 offset:33792
    v_mfma_f32_16x16x32_bf16 v[128:131], a[32:35], a[8:11], v[128:131]
    v_exp_f32 v210, v210
    v_add_f32 v156, v156, v208
    v_mfma_f32_16x16x32_bf16 v[132:135], a[36:39], a[8:11], v[132:135]
    buffer_load_dwordx4 v11, s[12:15], s32 offen offset:1024 nt lds
    v_mfma_f32_16x16x32_bf16 v[136:139], a[40:43], a[8:11], v[136:139]
    v_cvt_pk_bf16_f32 v191, v206, v207
    v_fma_f32 v213, v213, s34, -v25
    v_mfma_f32_16x16x32_bf16 v[140:143], a[44:47], a[8:11], v[140:143]
    ds_write_b128 v16, a[244:247] offset:50176
    ds_read_b128 a[8:11], v2 offset:34816
    v_mfma_f32_16x16x32_bf16 v[144:147], a[32:35], a[12:15], v[144:147]
    buffer_load_dwordx4 v12, s[12:15], s32 offen offset:2048 nt lds
    v_mfma_f32_16x16x32_bf16 v[148:151], a[36:39], a[12:15], v[148:151]
    v_exp_f32 v211, v211
    v_mfma_f32_16x16x32_bf16 a[96:99], a[40:43], a[12:15], a[96:99]
    v_add_f32 v156, v156, v209
    v_fma_f32 v214, v214, s34, -v25
    v_mfma_f32_16x16x32_bf16 a[100:103], a[44:47], a[12:15], a[100:103]
    buffer_load_dwordx4 v13, s[12:15], s32 offen offset:3072 nt lds
    ds_read_b128 a[12:15], v2 offset:35840
    s_waitcnt lgkmcnt(6)
    v_mfma_f32_16x16x32_bf16 a[104:107], a[32:35], a[16:19], a[104:107]
    v_mfma_f32_16x16x32_bf16 a[108:111], a[36:39], a[16:19], a[108:111]
    v_exp_f32 v212, v212
    v_add_f32 v156, v156, v210
    v_cvt_pk_bf16_f32 v192, v208, v209
    v_mfma_f32_16x16x32_bf16 a[112:115], a[40:43], a[16:19], a[112:115]
    v_fma_f32 v215, v215, s34, -v25
    v_mfma_f32_16x16x32_bf16 a[116:119], a[44:47], a[16:19], a[116:119]
    v_exp_f32 v213, v213
    ds_read_b128 a[16:19], v2 offset:36864
    v_mfma_f32_16x16x32_bf16 a[120:123], a[32:35], a[20:23], a[120:123]
    v_add_f32 v156, v156, v211
    v_fma_f32 v216, v216, s34, -v26
    v_mfma_f32_16x16x32_bf16 a[124:127], a[36:39], a[20:23], a[124:127]
    v_exp_f32 v214, v214
    v_add_f32 v156, v156, v212
    v_cvt_pk_bf16_f32 v193, v210, v211
    v_mfma_f32_16x16x32_bf16 a[128:131], a[40:43], a[20:23], a[128:131]
    v_fma_f32 v217, v217, s34, -v26
    v_mfma_f32_16x16x32_bf16 a[132:135], a[44:47], a[20:23], a[132:135]
    v_exp_f32 v215, v215
    ds_read_b128 a[20:23], v2 offset:37888
    v_mfma_f32_16x16x32_bf16 v[32:35], a[48:51], a[24:27], v[32:35]
    v_add_f32 v156, v156, v213
    v_fma_f32 v218, v218, s34, -v26
    v_mfma_f32_16x16x32_bf16 v[36:39], a[52:55], a[24:27], v[36:39]
    s_waitcnt vmcnt(12)
    ds_read_b64_tr_b16 a[32:33], v6
    ds_read_b64_tr_b16 a[34:35], v6 offset:2048
    v_mfma_f32_16x16x32_bf16 v[40:43], a[56:59], a[24:27], v[40:43]
    ds_read_b64_tr_b16 a[36:37], v7
    ds_read_b64_tr_b16 a[38:39], v7 offset:2048
    v_mfma_f32_16x16x32_bf16 v[44:47], a[60:63], a[24:27], v[44:47]
    ds_read_b64_tr_b16 a[40:41], v8
    ds_read_b64_tr_b16 a[42:43], v8 offset:2048
    ds_read_b128 a[24:27], v2 offset:38912
    v_mfma_f32_16x16x32_bf16 v[48:51], a[48:51], a[28:31], v[48:51]
    ds_read_b64_tr_b16 a[44:45], v9
    ds_read_b64_tr_b16 a[46:47], v9 offset:2048
    v_mfma_f32_16x16x32_bf16 v[52:55], a[52:55], a[28:31], v[52:55]
    v_exp_f32 v216, v216
    v_mfma_f32_16x16x32_bf16 v[56:59], a[56:59], a[28:31], v[56:59]
    v_add_f32 v156, v156, v214
    v_cvt_pk_bf16_f32 v194, v212, v213
    v_fma_f32 v219, v219, s34, -v26
    v_mfma_f32_16x16x32_bf16 v[60:63], a[60:63], a[28:31], v[60:63]
    ds_read_b128 a[28:31], v2 offset:39936
    s_waitcnt lgkmcnt(12)
    v_mfma_f32_16x16x32_bf16 v[64:67], a[48:51], a[0:3], v[64:67]
    v_exp_f32 v217, v217
    v_add_f32 v156, v156, v215
    v_fma_f32 v220, v220, s34, -v26
    v_mfma_f32_16x16x32_bf16 v[68:71], a[52:55], a[0:3], v[68:71]
    v_mfma_f32_16x16x32_bf16 v[72:75], a[56:59], a[0:3], v[72:75]
    v_exp_f32 v218, v218
    v_add_f32 v157, v157, v216
    v_cvt_pk_bf16_f32 v195, v214, v215
    v_mfma_f32_16x16x32_bf16 v[76:79], a[60:63], a[0:3], v[76:79]
    v_fma_f32 v221, v221, s34, -v26
    s_waitcnt lgkmcnt(0)
    s_barrier
    ds_read_b128 a[0:3], v3
    v_mfma_f32_16x16x32_bf16 v[80:83], a[48:51], a[4:7], v[80:83]
    v_exp_f32 v219, v219
    v_add_f32 v157, v157, v217
    v_mfma_f32_16x16x32_bf16 v[84:87], a[52:55], a[4:7], v[84:87]
    v_fma_f32 v222, v222, s34, -v26
    v_mfma_f32_16x16x32_bf16 v[88:91], a[56:59], a[4:7], v[88:91]
    ds_write_b128 v16, a[168:171]
    v_mfma_f32_16x16x32_bf16 v[92:95], a[60:63], a[4:7], v[92:95]
    ds_read_b128 a[4:7], v3 offset:1024
    v_mfma_f32_16x16x32_bf16 v[96:99], a[48:51], a[8:11], v[96:99]
    v_exp_f32 v220, v220
    v_add_f32 v157, v157, v218
    v_mfma_f32_16x16x32_bf16 v[100:103], a[52:55], a[8:11], v[100:103]
    v_cvt_pk_bf16_f32 v196, v216, v217
    v_fma_f32 v223, v223, s34, -v26
    v_mfma_f32_16x16x32_bf16 v[104:107], a[56:59], a[8:11], v[104:107]
    v_exp_f32 v221, v221
    v_add_f32 v157, v157, v219
    v_fma_f32 v224, v224, s34, -v27
    v_mfma_f32_16x16x32_bf16 v[108:111], a[60:63], a[8:11], v[108:111]
    ds_read_b128 a[8:11], v3 offset:2048
    v_mfma_f32_16x16x32_bf16 v[112:115], a[48:51], a[12:15], v[112:115]
    v_exp_f32 v222, v222
    v_add_f32 v157, v157, v220
    v_cvt_pk_bf16_f32 v197, v218, v219
    v_mfma_f32_16x16x32_bf16 v[116:119], a[52:55], a[12:15], v[116:119]
    v_fma_f32 v225, v225, s34, -v27
    v_mfma_f32_16x16x32_bf16 v[120:123], a[56:59], a[12:15], v[120:123]
    s_add_u32 m0, s29, 0
    s_mov_b32 s32, 196608
    buffer_load_dwordx4 v10, s[12:15], s32 offen nt lds
    v_mfma_f32_16x16x32_bf16 v[124:127], a[60:63], a[12:15], v[124:127]
    ds_read_b128 a[12:15], v3 offset:3072
    v_mfma_f32_16x16x32_bf16 v[128:131], a[48:51], a[16:19], v[128:131]
    v_exp_f32 v223, v223
    v_mfma_f32_16x16x32_bf16 v[132:135], a[52:55], a[16:19], v[132:135]
    buffer_load_dwordx4 v11, s[12:15], s32 offen offset:1024 nt lds
    v_mfma_f32_16x16x32_bf16 v[136:139], a[56:59], a[16:19], v[136:139]
    v_add_f32 v157, v157, v221
    v_fma_f32 v226, v226, s34, -v27
    v_mfma_f32_16x16x32_bf16 v[140:143], a[60:63], a[16:19], v[140:143]
    ds_read_b128 a[16:19], v3 offset:4096
    v_mfma_f32_16x16x32_bf16 v[144:147], a[48:51], a[20:23], v[144:147]
    buffer_load_dwordx4 v12, s[12:15], s32 offen offset:2048 nt lds
    ds_write_b128 v16, a[172:175] offset:1024
    v_mfma_f32_16x16x32_bf16 v[148:151], a[52:55], a[20:23], v[148:151]
    v_exp_f32 v224, v224
    v_mfma_f32_16x16x32_bf16 a[96:99], a[56:59], a[20:23], a[96:99]
    v_add_f32 v157, v157, v222
    v_cvt_pk_bf16_f32 v198, v220, v221
    v_fma_f32 v227, v227, s34, -v27
    v_mfma_f32_16x16x32_bf16 a[100:103], a[60:63], a[20:23], a[100:103]
    buffer_load_dwordx4 v13, s[12:15], s32 offen offset:3072 nt lds
    ds_read_b128 a[20:23], v3 offset:5120
    v_mfma_f32_16x16x32_bf16 a[104:107], a[48:51], a[24:27], a[104:107]
    v_mfma_f32_16x16x32_bf16 a[108:111], a[52:55], a[24:27], a[108:111]
    v_exp_f32 v225, v225
    v_add_f32 v157, v157, v223
    v_fma_f32 v228, v228, s34, -v27
    v_mfma_f32_16x16x32_bf16 a[112:115], a[56:59], a[24:27], a[112:115]
    v_mfma_f32_16x16x32_bf16 a[116:119], a[60:63], a[24:27], a[116:119]
    v_exp_f32 v226, v226
    ds_read_b128 a[24:27], v3 offset:6144
    v_mfma_f32_16x16x32_bf16 a[120:123], a[48:51], a[28:31], a[120:123]
    v_add_f32 v158, v158, v224
    v_cvt_pk_bf16_f32 v199, v222, v223
    v_fma_f32 v229, v229, s34, -v27
    v_mfma_f32_16x16x32_bf16 a[124:127], a[52:55], a[28:31], a[124:127]
    v_exp_f32 v227, v227
    v_add_f32 v158, v158, v225
    v_mfma_f32_16x16x32_bf16 a[128:131], a[56:59], a[28:31], a[128:131]
    v_fma_f32 v230, v230, s34, -v27
    v_mfma_f32_16x16x32_bf16 a[132:135], a[60:63], a[28:31], a[132:135]
    ds_read_b128 a[28:31], v3 offset:7168
    s_waitcnt lgkmcnt(5)
    v_mfma_f32_16x16x32_bf16 v[32:35], a[64:67], a[0:3], v[32:35]
    v_exp_f32 v228, v228
    v_add_f32 v158, v158, v226
    v_cvt_pk_bf16_f32 v200, v224, v225
    v_mfma_f32_16x16x32_bf16 v[36:39], a[68:71], a[0:3], v[36:39]
    s_waitcnt vmcnt(12)
    ds_read_b64_tr_b16 a[48:49], v6 offset:4096
    v_mfma_f32_16x16x32_bf16 v[40:43], a[72:75], a[0:3], v[40:43]
    ds_write_b128 v16, a[176:179] offset:2048
    v_mfma_f32_16x16x32_bf16 v[44:47], a[76:79], a[0:3], v[44:47]
    ds_read_b128 a[0:3], v3 offset:8192
    v_mfma_f32_16x16x32_bf16 v[48:51], a[64:67], a[4:7], v[48:51]
    ds_read_b64_tr_b16 a[50:51], v6 offset:6144
    ds_read_b64_tr_b16 a[52:53], v7 offset:4096
    ds_read_b64_tr_b16 a[54:55], v7 offset:6144
    v_mfma_f32_16x16x32_bf16 v[52:55], a[68:71], a[4:7], v[52:55]
    ds_read_b64_tr_b16 a[56:57], v8 offset:4096
    ds_read_b64_tr_b16 a[58:59], v8 offset:6144
    v_mfma_f32_16x16x32_bf16 v[56:59], a[72:75], a[4:7], v[56:59]
    ds_read_b64_tr_b16 a[60:61], v9 offset:4096
    ds_read_b64_tr_b16 a[62:63], v9 offset:6144
    v_mfma_f32_16x16x32_bf16 v[60:63], a[76:79], a[4:7], v[60:63]
    v_fma_f32 v231, v231, s34, -v27
    ds_read_b128 a[4:7], v3 offset:9216
    v_mfma_f32_16x16x32_bf16 v[64:67], a[64:67], a[8:11], v[64:67]
    v_exp_f32 v229, v229
    v_add_f32 v158, v158, v227
    v_mfma_f32_16x16x32_bf16 v[68:71], a[68:71], a[8:11], v[68:71]
    v_fma_f32 v232, v232, s34, -v28
    v_mfma_f32_16x16x32_bf16 v[72:75], a[72:75], a[8:11], v[72:75]
    v_exp_f32 v230, v230
    v_add_f32 v158, v158, v228
    v_cvt_pk_bf16_f32 v201, v226, v227
    v_mfma_f32_16x16x32_bf16 v[76:79], a[76:79], a[8:11], v[76:79]
    v_fma_f32 v233, v233, s34, -v28
    ds_read_b128 a[8:11], v3 offset:10240
    v_mfma_f32_16x16x32_bf16 v[80:83], a[64:67], a[12:15], v[80:83]
    v_exp_f32 v231, v231
    v_add_f32 v158, v158, v229
    v_mfma_f32_16x16x32_bf16 v[84:87], a[68:71], a[12:15], v[84:87]
    v_fma_f32 v234, v234, s34, -v28
    v_mfma_f32_16x16x32_bf16 v[88:91], a[72:75], a[12:15], v[88:91]
    v_exp_f32 v232, v232
    v_add_f32 v158, v158, v230
    v_cvt_pk_bf16_f32 v202, v228, v229
    v_mfma_f32_16x16x32_bf16 v[92:95], a[76:79], a[12:15], v[92:95]
    ds_read_b128 a[12:15], v3 offset:11264
    s_waitcnt lgkmcnt(13)
    v_mfma_f32_16x16x32_bf16 v[96:99], a[64:67], a[16:19], v[96:99]
    v_fma_f32 v235, v235, s34, -v28
    v_exp_f32 v233, v233
    v_mfma_f32_16x16x32_bf16 v[100:103], a[68:71], a[16:19], v[100:103]
    ds_write_b128 v16, a[180:183] offset:3072
    v_mfma_f32_16x16x32_bf16 v[104:107], a[72:75], a[16:19], v[104:107]
    v_add_f32 v158, v158, v231
    v_fma_f32 v236, v236, s34, -v28
    v_mfma_f32_16x16x32_bf16 v[108:111], a[76:79], a[16:19], v[108:111]
    ds_read_b128 a[16:19], v3 offset:12288
    v_mfma_f32_16x16x32_bf16 v[112:115], a[64:67], a[20:23], v[112:115]
    v_exp_f32 v234, v234
    v_add_f32 v159, v159, v232
    v_cvt_pk_bf16_f32 v203, v230, v231
    v_mfma_f32_16x16x32_bf16 v[116:119], a[68:71], a[20:23], v[116:119]
    v_fma_f32 v237, v237, s34, -v28
    v_mfma_f32_16x16x32_bf16 v[120:123], a[72:75], a[20:23], v[120:123]
    s_waitcnt lgkmcnt(5)
    s_add_u32 m0, s29, 4096
    s_mov_b32 s32, 212992
    buffer_load_dwordx4 v10, s[12:15], s32 offen nt lds
    v_mfma_f32_16x16x32_bf16 v[124:127], a[76:79], a[20:23], v[124:127]
    ds_read_b128 a[20:23], v3 offset:13312
    v_mfma_f32_16x16x32_bf16 v[128:131], a[64:67], a[24:27], v[128:131]
    v_exp_f32 v235, v235
    v_add_f32 v159, v159, v233
    v_mfma_f32_16x16x32_bf16 v[132:135], a[68:71], a[24:27], v[132:135]
    buffer_load_dwordx4 v11, s[12:15], s32 offen offset:1024 nt lds
    v_mfma_f32_16x16x32_bf16 v[136:139], a[72:75], a[24:27], v[136:139]
    v_fma_f32 v238, v238, s34, -v28
    v_mfma_f32_16x16x32_bf16 v[140:143], a[76:79], a[24:27], v[140:143]
    v_exp_f32 v236, v236
    ds_read_b128 a[24:27], v3 offset:14336
    v_mfma_f32_16x16x32_bf16 v[144:147], a[64:67], a[28:31], v[144:147]
    buffer_load_dwordx4 v12, s[12:15], s32 offen offset:2048 nt lds
    v_mfma_f32_16x16x32_bf16 v[148:151], a[68:71], a[28:31], v[148:151]
    v_add_f32 v159, v159, v234
    v_cvt_pk_bf16_f32 v204, v232, v233
    v_mfma_f32_16x16x32_bf16 a[96:99], a[72:75], a[28:31], a[96:99]
    v_fma_f32 v239, v239, s34, -v28
    v_exp_f32 v237, v237
    v_mfma_f32_16x16x32_bf16 a[100:103], a[76:79], a[28:31], a[100:103]
    buffer_load_dwordx4 v13, s[12:15], s32 offen offset:3072 nt lds
    ds_write_b128 v16, a[184:187] offset:4096
    ds_read_b128 a[28:31], v3 offset:15360
    s_waitcnt lgkmcnt(6)
    v_mfma_f32_16x16x32_bf16 a[104:107], a[64:67], a[0:3], a[104:107]
    v_add_f32 v159, v159, v235
    v_mfma_f32_16x16x32_bf16 a[108:111], a[68:71], a[0:3], a[108:111]
    v_fma_f32 v240, v240, s34, -v29
    v_exp_f32 v238, v238
    v_mfma_f32_16x16x32_bf16 a[112:115], a[72:75], a[0:3], a[112:115]
    v_add_f32 v159, v159, v236
    v_cvt_pk_bf16_f32 v205, v234, v235
    v_fma_f32 v241, v241, s34, -v29
    v_mfma_f32_16x16x32_bf16 a[116:119], a[76:79], a[0:3], a[116:119]
    v_exp_f32 v239, v239
    ds_read_b128 a[0:3], v3 offset:16384
    v_mfma_f32_16x16x32_bf16 a[120:123], a[64:67], a[4:7], a[120:123]
    v_add_f32 v159, v159, v237
    v_fma_f32 v242, v242, s34, -v29
    v_mfma_f32_16x16x32_bf16 a[124:127], a[68:71], a[4:7], a[124:127]
    v_exp_f32 v240, v240
    v_add_f32 v159, v159, v238
    v_mfma_f32_16x16x32_bf16 a[128:131], a[72:75], a[4:7], a[128:131]
    v_cvt_pk_bf16_f32 v206, v236, v237
    v_fma_f32 v243, v243, s34, -v29
    v_mfma_f32_16x16x32_bf16 a[132:135], a[76:79], a[4:7], a[132:135]
    v_exp_f32 v241, v241
    ds_read_b128 a[4:7], v3 offset:17408
    v_mfma_f32_16x16x32_bf16 v[32:35], a[80:83], a[8:11], v[32:35]
    v_add_f32 v159, v159, v239
    v_fma_f32 v244, v244, s34, -v29
    v_mfma_f32_16x16x32_bf16 v[36:39], a[84:87], a[8:11], v[36:39]
    s_waitcnt vmcnt(12)
    ds_read_b64_tr_b16 a[64:65], v6 offset:8192
    ds_read_b64_tr_b16 a[66:67], v6 offset:10240
    v_mfma_f32_16x16x32_bf16 v[40:43], a[88:91], a[8:11], v[40:43]
    ds_read_b64_tr_b16 a[68:69], v7 offset:8192
    ds_read_b64_tr_b16 a[70:71], v7 offset:10240
    v_mfma_f32_16x16x32_bf16 v[44:47], a[92:95], a[8:11], v[44:47]
    ds_read_b64_tr_b16 a[72:73], v8 offset:8192
    ds_read_b128 a[8:11], v3 offset:18432
    v_mfma_f32_16x16x32_bf16 v[48:51], a[80:83], a[12:15], v[48:51]
    ds_read_b64_tr_b16 a[74:75], v8 offset:10240
    ds_read_b64_tr_b16 a[76:77], v9 offset:8192
    ds_read_b64_tr_b16 a[78:79], v9 offset:10240
    v_mfma_f32_16x16x32_bf16 v[52:55], a[84:87], a[12:15], v[52:55]
    v_mfma_f32_16x16x32_bf16 v[56:59], a[88:91], a[12:15], v[56:59]
    ds_write_b128 v16, a[188:191] offset:5120
    v_mfma_f32_16x16x32_bf16 v[60:63], a[92:95], a[12:15], v[60:63]
    ds_read_b128 a[12:15], v3 offset:19456
    s_waitcnt lgkmcnt(13)
    v_mfma_f32_16x16x32_bf16 v[64:67], a[80:83], a[16:19], v[64:67]
    v_exp_f32 v242, v242
    v_mfma_f32_16x16x32_bf16 v[68:71], a[84:87], a[16:19], v[68:71]
    v_add_f32 v160, v160, v240
    v_cvt_pk_bf16_f32 v207, v238, v239
    v_fma_f32 v245, v245, s34, -v29
    v_mfma_f32_16x16x32_bf16 v[72:75], a[88:91], a[16:19], v[72:75]
    v_exp_f32 v243, v243
    v_add_f32 v160, v160, v241
    v_mfma_f32_16x16x32_bf16 v[76:79], a[92:95], a[16:19], v[76:79]
    v_fma_f32 v246, v246, s34, -v29
    ds_read_b128 a[16:19], v3 offset:20480
    v_mfma_f32_16x16x32_bf16 v[80:83], a[80:83], a[20:23], v[80:83]
    v_exp_f32 v244, v244
    v_add_f32 v160, v160, v242
    v_mfma_f32_16x16x32_bf16 v[84:87], a[84:87], a[20:23], v[84:87]
    v_cvt_pk_bf16_f32 v208, v240, v241
    v_fma_f32 v247, v247, s34, -v29
    v_mfma_f32_16x16x32_bf16 v[88:91], a[88:91], a[20:23], v[88:91]
    v_exp_f32 v245, v245
    v_add_f32 v160, v160, v243
    v_fma_f32 v248, v248, s34, -v30
    v_mfma_f32_16x16x32_bf16 v[92:95], a[92:95], a[20:23], v[92:95]
    ds_read_b128 a[20:23], v3 offset:21504
    v_mfma_f32_16x16x32_bf16 v[96:99], a[80:83], a[24:27], v[96:99]
    v_exp_f32 v246, v246
    v_add_f32 v160, v160, v244
    v_cvt_pk_bf16_f32 v209, v242, v243
    v_mfma_f32_16x16x32_bf16 v[100:103], a[84:87], a[24:27], v[100:103]
    v_fma_f32 v249, v249, s34, -v30
    v_mfma_f32_16x16x32_bf16 v[104:107], a[88:91], a[24:27], v[104:107]
    v_exp_f32 v247, v247
    v_add_f32 v160, v160, v245
    v_fma_f32 v250, v250, s34, -v30
    v_mfma_f32_16x16x32_bf16 v[108:111], a[92:95], a[24:27], v[108:111]
    ds_read_b128 a[24:27], v3 offset:22528
    v_mfma_f32_16x16x32_bf16 v[112:115], a[80:83], a[28:31], v[112:115]
    ds_write_b128 v16, a[192:195] offset:6144
    v_mfma_f32_16x16x32_bf16 v[116:119], a[84:87], a[28:31], v[116:119]
    v_mfma_f32_16x16x32_bf16 v[120:123], a[88:91], a[28:31], v[120:123]
    s_waitcnt lgkmcnt(6)
    s_add_u32 m0, s29, 8192
    s_mov_b32 s32, 229376
    buffer_load_dwordx4 v10, s[12:15], s32 offen nt lds
    v_mfma_f32_16x16x32_bf16 v[124:127], a[92:95], a[28:31], v[124:127]
    ds_read_b128 a[28:31], v3 offset:23552
    s_waitcnt lgkmcnt(5)
    v_mfma_f32_16x16x32_bf16 v[128:131], a[80:83], a[0:3], v[128:131]
    v_exp_f32 v248, v248
    v_mfma_f32_16x16x32_bf16 v[132:135], a[84:87], a[0:3], v[132:135]
    buffer_load_dwordx4 v11, s[12:15], s32 offen offset:1024 nt lds
    v_mfma_f32_16x16x32_bf16 v[136:139], a[88:91], a[0:3], v[136:139]
    v_add_f32 v160, v160, v246
    v_mfma_f32_16x16x32_bf16 v[140:143], a[92:95], a[0:3], v[140:143]
    v_cvt_pk_bf16_f32 v210, v244, v245
    v_fma_f32 v251, v251, s34, -v30
    ds_read_b128 a[0:3], v3 offset:24576
    v_mfma_f32_16x16x32_bf16 v[144:147], a[80:83], a[4:7], v[144:147]
    buffer_load_dwordx4 v12, s[12:15], s32 offen offset:2048 nt lds
    v_mfma_f32_16x16x32_bf16 v[148:151], a[84:87], a[4:7], v[148:151]
    v_mfma_f32_16x16x32_bf16 a[96:99], a[88:91], a[4:7], a[96:99]
    v_exp_f32 v249, v249
    v_add_f32 v160, v160, v247
    v_fma_f32 v252, v252, s34, -v30
    v_mfma_f32_16x16x32_bf16 a[100:103], a[92:95], a[4:7], a[100:103]
    buffer_load_dwordx4 v13, s[12:15], s32 offen offset:3072 nt lds
    ds_read_b128 a[4:7], v3 offset:25600
    v_mfma_f32_16x16x32_bf16 a[104:107], a[80:83], a[8:11], a[104:107]
    v_mfma_f32_16x16x32_bf16 a[108:111], a[84:87], a[8:11], a[108:111]
    v_exp_f32 v250, v250
    v_add_f32 v161, v161, v248
    v_mfma_f32_16x16x32_bf16 a[112:115], a[88:91], a[8:11], a[112:115]
    ds_write_b128 v16, a[196:199] offset:7168
    v_mfma_f32_16x16x32_bf16 a[116:119], a[92:95], a[8:11], a[116:119]
    ds_read_b128 a[8:11], v3 offset:26624
    v_mfma_f32_16x16x32_bf16 a[120:123], a[80:83], a[12:15], a[120:123]
    v_cvt_pk_bf16_f32 v211, v246, v247
    v_fma_f32 v253, v253, s34, -v30
    v_mfma_f32_16x16x32_bf16 a[124:127], a[84:87], a[12:15], a[124:127]
    v_exp_f32 v251, v251
    v_add_f32 v161, v161, v249
    v_mfma_f32_16x16x32_bf16 a[128:131], a[88:91], a[12:15], a[128:131]
    v_fma_f32 v254, v254, s34, -v30
    v_mfma_f32_16x16x32_bf16 a[132:135], a[92:95], a[12:15], a[132:135]
    ds_read_b128 a[12:15], v3 offset:27648
    s_waitcnt lgkmcnt(5)
    v_mfma_f32_16x16x32_bf16 v[32:35], a[136:139], a[16:19], v[32:35]
    v_exp_f32 v252, v252
    v_add_f32 v161, v161, v250
    v_cvt_pk_bf16_f32 v212, v248, v249
    v_mfma_f32_16x16x32_bf16 v[36:39], a[140:143], a[16:19], v[36:39]
    s_waitcnt vmcnt(12)
    ds_read_b64_tr_b16 a[80:81], v6 offset:12288
    v_mfma_f32_16x16x32_bf16 v[40:43], a[144:147], a[16:19], v[40:43]
    ds_read_b64_tr_b16 a[82:83], v6 offset:14336
    ds_read_b64_tr_b16 a[84:85], v7 offset:12288
    v_mfma_f32_16x16x32_bf16 v[44:47], a[148:151], a[16:19], v[44:47]
    ds_read_b64_tr_b16 a[86:87], v7 offset:14336
    ds_read_b64_tr_b16 a[88:89], v8 offset:12288
    ds_read_b128 a[16:19], v3 offset:28672
    v_mfma_f32_16x16x32_bf16 v[48:51], a[136:139], a[20:23], v[48:51]
    ds_read_b64_tr_b16 a[90:91], v8 offset:14336
    ds_read_b64_tr_b16 a[92:93], v9 offset:12288
    v_mfma_f32_16x16x32_bf16 v[52:55], a[140:143], a[20:23], v[52:55]
    ds_read_b64_tr_b16 a[94:95], v9 offset:14336
    v_fma_f32 v255, v255, s34, -v30
    v_mfma_f32_16x16x32_bf16 v[56:59], a[144:147], a[20:23], v[56:59]
    v_exp_f32 v253, v253
    v_add_f32 v161, v161, v251
    v_mfma_f32_16x16x32_bf16 v[60:63], a[148:151], a[20:23], v[60:63]
    ds_read_b128 a[20:23], v3 offset:29696
    v_mfma_f32_16x16x32_bf16 v[64:67], a[136:139], a[24:27], v[64:67]
    v_exp_f32 v254, v254
    v_add_f32 v161, v161, v252
    v_cvt_pk_bf16_f32 v213, v250, v251
    v_mfma_f32_16x16x32_bf16 v[68:71], a[140:143], a[24:27], v[68:71]
    ds_write_b128 v16, a[200:203] offset:8192
    v_mfma_f32_16x16x32_bf16 v[72:75], a[144:147], a[24:27], v[72:75]
    v_mfma_f32_16x16x32_bf16 v[76:79], a[148:151], a[24:27], v[76:79]
    v_exp_f32 v255, v255
    ds_read_b128 a[24:27], v3 offset:30720
    v_mfma_f32_16x16x32_bf16 v[80:83], a[136:139], a[28:31], v[80:83]
    v_add_f32 v161, v161, v253
    v_add_f32 v161, v161, v254
    v_cvt_pk_bf16_f32 v214, v252, v253
    v_mfma_f32_16x16x32_bf16 v[84:87], a[140:143], a[28:31], v[84:87]
    v_add_f32 v161, v161, v255
    v_cvt_pk_bf16_f32 v215, v254, v255
    v_mfma_f32_16x16x32_bf16 v[88:91], a[144:147], a[28:31], v[88:91]
    v_mfma_f32_16x16x32_bf16 v[92:95], a[148:151], a[28:31], v[92:95]
    ds_read_b128 a[28:31], v3 offset:31744
    s_waitcnt lgkmcnt(13)
    v_mfma_f32_16x16x32_bf16 v[96:99], a[136:139], a[0:3], v[96:99]
    v_mfma_f32_16x16x32_bf16 v[100:103], a[140:143], a[0:3], v[100:103]
    v_mfma_f32_16x16x32_bf16 v[104:107], a[144:147], a[0:3], v[104:107]
    v_mfma_f32_16x16x32_bf16 v[108:111], a[148:151], a[0:3], v[108:111]
    ds_read_b128 a[0:3], v3 offset:32768
    v_mfma_f32_16x16x32_bf16 v[112:115], a[136:139], a[4:7], v[112:115]
    v_mfma_f32_16x16x32_bf16 v[116:119], a[140:143], a[4:7], v[116:119]
    v_mfma_f32_16x16x32_bf16 v[120:123], a[144:147], a[4:7], v[120:123]
    s_waitcnt lgkmcnt(5)
    s_add_u32 m0, s29, 12288
    s_mov_b32 s32, 245760
    buffer_load_dwordx4 v10, s[12:15], s32 offen nt lds
    v_mfma_f32_16x16x32_bf16 v[124:127], a[148:151], a[4:7], v[124:127]
    ds_write_b128 v16, a[204:207] offset:9216
    ds_read_b128 a[4:7], v3 offset:33792
    v_mfma_f32_16x16x32_bf16 v[128:131], a[136:139], a[8:11], v[128:131]
    v_mfma_f32_16x16x32_bf16 v[132:135], a[140:143], a[8:11], v[132:135]
    buffer_load_dwordx4 v11, s[12:15], s32 offen offset:1024 nt lds
    v_mfma_f32_16x16x32_bf16 v[136:139], a[144:147], a[8:11], v[136:139]
    v_mfma_f32_16x16x32_bf16 v[140:143], a[148:151], a[8:11], v[140:143]
    ds_read_b128 a[8:11], v3 offset:34816
    v_mfma_f32_16x16x32_bf16 v[144:147], a[136:139], a[12:15], v[144:147]
    buffer_load_dwordx4 v12, s[12:15], s32 offen offset:2048 nt lds
    v_mfma_f32_16x16x32_bf16 v[148:151], a[140:143], a[12:15], v[148:151]
    v_mfma_f32_16x16x32_bf16 a[96:99], a[144:147], a[12:15], a[96:99]
    v_mfma_f32_16x16x32_bf16 a[100:103], a[148:151], a[12:15], a[100:103]
    buffer_load_dwordx4 v13, s[12:15], s32 offen offset:3072 nt lds
    ds_read_b128 a[12:15], v3 offset:35840
    s_waitcnt lgkmcnt(5)
    v_mfma_f32_16x16x32_bf16 a[104:107], a[136:139], a[16:19], a[104:107]
    v_mfma_f32_16x16x32_bf16 a[108:111], a[140:143], a[16:19], a[108:111]
    v_mfma_f32_16x16x32_bf16 a[112:115], a[144:147], a[16:19], a[112:115]
    v_mfma_f32_16x16x32_bf16 a[116:119], a[148:151], a[16:19], a[116:119]
    ds_read_b128 a[16:19], v3 offset:36864
    v_mfma_f32_16x16x32_bf16 a[120:123], a[136:139], a[20:23], a[120:123]
    v_mfma_f32_16x16x32_bf16 a[124:127], a[140:143], a[20:23], a[124:127]
    v_mfma_f32_16x16x32_bf16 a[128:131], a[144:147], a[20:23], a[128:131]
    v_mfma_f32_16x16x32_bf16 a[132:135], a[148:151], a[20:23], a[132:135]
    ds_read_b128 a[20:23], v3 offset:37888
    v_mfma_f32_16x16x32_bf16 v[32:35], a[152:155], a[24:27], v[32:35]
    v_mov_b32 v162, v152
    v_mov_b32 v163, v153
    v_mov_b32 v164, v154
    v_mov_b32 v165, v155
    v_mov_b32 v166, v156
    v_mov_b32 v167, v157
    v_mov_b32 v168, v158
    v_mfma_f32_16x16x32_bf16 v[36:39], a[156:159], a[24:27], v[36:39]
    v_mov_b32 v169, v159
    v_mov_b32 v170, v160
    v_mov_b32 v171, v161
    v_permlane32_swap_b32 v162, v152
    v_permlane32_swap_b32 v163, v153
    v_permlane32_swap_b32 v164, v154
    v_permlane32_swap_b32 v165, v155
    v_mfma_f32_16x16x32_bf16 v[40:43], a[160:163], a[24:27], v[40:43]
    v_permlane32_swap_b32 v166, v156
    v_permlane32_swap_b32 v167, v157
    v_permlane32_swap_b32 v168, v158
    v_permlane32_swap_b32 v169, v159
    v_permlane32_swap_b32 v170, v160
    v_permlane32_swap_b32 v171, v161
    v_mfma_f32_16x16x32_bf16 v[44:47], a[164:167], a[24:27], v[44:47]
    v_add_f32 v152, v162, v152
    v_add_f32 v153, v163, v153
    v_add_f32 v154, v164, v154
    v_add_f32 v155, v165, v155
    v_add_f32 v156, v166, v156
    v_add_f32 v157, v167, v157
    ds_read_b128 a[24:27], v3 offset:38912
    v_mfma_f32_16x16x32_bf16 v[48:51], a[152:155], a[28:31], v[48:51]
    v_add_f32 v158, v168, v158
    v_add_f32 v159, v169, v159
    v_add_f32 v160, v170, v160
    v_add_f32 v161, v171, v161
    v_mov_b32 v162, v152
    v_mov_b32 v163, v153
    v_mfma_f32_16x16x32_bf16 v[52:55], a[156:159], a[28:31], v[52:55]
    v_mov_b32 v164, v154
    v_mov_b32 v165, v155
    v_mov_b32 v166, v156
    v_mov_b32 v167, v157
    v_mov_b32 v168, v158
    v_mov_b32 v169, v159
    v_mov_b32 v170, v160
    v_mfma_f32_16x16x32_bf16 v[56:59], a[160:163], a[28:31], v[56:59]
    v_mov_b32 v171, v161
    v_permlane16_swap_b32 v162, v152
    v_permlane16_swap_b32 v163, v153
    v_permlane16_swap_b32 v164, v154
    v_permlane16_swap_b32 v165, v155
    v_permlane16_swap_b32 v166, v156
    v_permlane16_swap_b32 v167, v157
    v_mfma_f32_16x16x32_bf16 v[60:63], a[164:167], a[28:31], v[60:63]
    v_permlane16_swap_b32 v168, v158
    v_permlane16_swap_b32 v169, v159
    v_permlane16_swap_b32 v170, v160
    v_permlane16_swap_b32 v171, v161
    ds_read_b128 a[28:31], v3 offset:39936
    s_waitcnt lgkmcnt(4)
    v_mfma_f32_16x16x32_bf16 v[64:67], a[152:155], a[0:3], v[64:67]
    v_add_f32 v152, v162, v152
    v_add_f32 v153, v163, v153
    v_add_f32 v154, v164, v154
    v_add_f32 v155, v165, v155
    v_add_f32 v156, v166, v156
    v_add_f32 v157, v167, v157
    v_add_f32 v158, v168, v158
    v_mfma_f32_16x16x32_bf16 v[68:71], a[156:159], a[0:3], v[68:71]
    v_add_f32 v159, v169, v159
    v_add_f32 v160, v170, v160
    v_add_f32 v161, v171, v161
    ds_write_b32 v18, v152 offset:4096
    ds_write_b32 v18, v153 offset:4352
    ds_write_b32 v18, v154 offset:4608
    v_mfma_f32_16x16x32_bf16 v[72:75], a[160:163], a[0:3], v[72:75]
    ds_write_b32 v18, v155 offset:4864
    ds_write_b32 v18, v156 offset:5120
    ds_write_b32 v18, v157 offset:5376
    ds_write_b32 v18, v158 offset:5632
    ds_write_b32 v18, v159 offset:5888
    ds_write_b32 v18, v160 offset:6144
    ds_write_b32 v18, v161 offset:6400
    v_mfma_f32_16x16x32_bf16 v[76:79], a[164:167], a[0:3], v[76:79]
    s_waitcnt vmcnt(12)
    s_waitcnt lgkmcnt(0)
    s_barrier
    ds_read_b128 a[0:3], v2
    v_mfma_f32_16x16x32_bf16 v[80:83], a[152:155], a[4:7], v[80:83]
    ds_read_b64_tr_b16 a[136:137], v6
    ds_read_b64_tr_b16 a[138:139], v6 offset:2048
    v_mfma_f32_16x16x32_bf16 v[84:87], a[156:159], a[4:7], v[84:87]
    ds_read_b64_tr_b16 a[140:141], v7
    ds_read_b64_tr_b16 a[142:143], v7 offset:2048
    v_mfma_f32_16x16x32_bf16 v[88:91], a[160:163], a[4:7], v[88:91]
    ds_write_b128 v16, v[176:179] offset:40960
    v_mfma_f32_16x16x32_bf16 v[92:95], a[164:167], a[4:7], v[92:95]
    ds_read_b128 a[4:7], v2 offset:1024
    v_mfma_f32_16x16x32_bf16 v[96:99], a[152:155], a[8:11], v[96:99]
    ds_read_b64_tr_b16 a[144:145], v8
    ds_read_b64_tr_b16 a[146:147], v8 offset:2048
    v_mfma_f32_16x16x32_bf16 v[100:103], a[156:159], a[8:11], v[100:103]
    ds_read_b64_tr_b16 a[148:149], v9
    v_mfma_f32_16x16x32_bf16 v[104:107], a[160:163], a[8:11], v[104:107]
    ds_read_b64_tr_b16 a[150:151], v9 offset:2048
    v_mfma_f32_16x16x32_bf16 v[108:111], a[164:167], a[8:11], v[108:111]
    ds_read_b128 a[8:11], v2 offset:2048
    v_mfma_f32_16x16x32_bf16 v[112:115], a[152:155], a[12:15], v[112:115]
    v_mfma_f32_16x16x32_bf16 v[116:119], a[156:159], a[12:15], v[116:119]
    v_mfma_f32_16x16x32_bf16 v[120:123], a[160:163], a[12:15], v[120:123]
    v_mov_b32 v172, v15
    v_add_u32 v173, 6144, v15
    v_add_u32 v174, 12288, v15
    v_add_u32 v175, 18432, v15
    s_waitcnt lgkmcnt(1)
    s_add_u32 m0, s29, 0
    s_mov_b32 s33, 0
    buffer_load_dwordx4 v172, s[20:23], s33 offen lds
    v_mfma_f32_16x16x32_bf16 v[124:127], a[164:167], a[12:15], v[124:127]
    ds_read_b128 a[12:15], v2 offset:3072
    v_mfma_f32_16x16x32_bf16 v[128:131], a[152:155], a[16:19], v[128:131]
    v_mfma_f32_16x16x32_bf16 v[132:135], a[156:159], a[16:19], v[132:135]
    buffer_load_dwordx4 v173, s[20:23], s33 offen offset:1024 lds
    v_mfma_f32_16x16x32_bf16 v[136:139], a[160:163], a[16:19], v[136:139]
    v_mfma_f32_16x16x32_bf16 v[140:143], a[164:167], a[16:19], v[140:143]
    ds_read_b128 a[16:19], v2 offset:4096
    v_mfma_f32_16x16x32_bf16 v[144:147], a[152:155], a[20:23], v[144:147]
    buffer_load_dwordx4 v174, s[20:23], s33 offen offset:2048 lds
    ds_write_b128 v16, v[180:183] offset:41984
    v_mfma_f32_16x16x32_bf16 v[148:151], a[156:159], a[20:23], v[148:151]
    v_mfma_f32_16x16x32_bf16 a[96:99], a[160:163], a[20:23], a[96:99]
    v_mfma_f32_16x16x32_bf16 a[100:103], a[164:167], a[20:23], a[100:103]
    buffer_load_dwordx4 v175, s[20:23], s33 offen offset:3072 lds
    ds_read_b128 a[20:23], v2 offset:5120
    v_mfma_f32_16x16x32_bf16 a[104:107], a[152:155], a[24:27], a[104:107]
    v_mfma_f32_16x16x32_bf16 a[108:111], a[156:159], a[24:27], a[108:111]
    v_mfma_f32_16x16x32_bf16 a[112:115], a[160:163], a[24:27], a[112:115]
    v_mfma_f32_16x16x32_bf16 a[116:119], a[164:167], a[24:27], a[116:119]
    ds_read_b128 a[24:27], v2 offset:6144
    v_mfma_f32_16x16x32_bf16 a[120:123], a[152:155], a[28:31], a[120:123]
    v_mfma_f32_16x16x32_bf16 a[124:127], a[156:159], a[28:31], a[124:127]
    v_mfma_f32_16x16x32_bf16 a[128:131], a[160:163], a[28:31], a[128:131]
    v_mfma_f32_16x16x32_bf16 a[132:135], a[164:167], a[28:31], a[132:135]
    ds_read_b128 a[28:31], v2 offset:7168
    s_waitcnt lgkmcnt(5)
    v_mfma_f32_16x16x32_bf16 v[32:35], a[32:35], a[0:3], v[32:35]
    ds_read_b128 v[216:219], v19 offset:4096
    ds_read_b128 v[220:223], v19 offset:4352
    ds_read_b128 v[224:227], v19 offset:4608
    v_mfma_f32_16x16x32_bf16 v[36:39], a[36:39], a[0:3], v[36:39]
    s_waitcnt vmcnt(12)
    ds_read_b64_tr_b16 a[152:153], v6 offset:4096
    v_mfma_f32_16x16x32_bf16 v[40:43], a[40:43], a[0:3], v[40:43]
    ds_write_b128 v16, v[184:187] offset:43008
    v_mfma_f32_16x16x32_bf16 v[44:47], a[44:47], a[0:3], v[44:47]
    ds_read_b128 a[0:3], v2 offset:8192
    v_mfma_f32_16x16x32_bf16 v[48:51], a[32:35], a[4:7], v[48:51]
    ds_read_b64_tr_b16 a[154:155], v6 offset:6144
    ds_read_b64_tr_b16 a[156:157], v7 offset:4096
    v_mfma_f32_16x16x32_bf16 v[52:55], a[36:39], a[4:7], v[52:55]
    ds_read_b64_tr_b16 a[158:159], v7 offset:6144
    ds_read_b64_tr_b16 a[160:161], v8 offset:4096
    v_mfma_f32_16x16x32_bf16 v[56:59], a[40:43], a[4:7], v[56:59]
    ds_read_b64_tr_b16 a[162:163], v8 offset:6144
    ds_read_b64_tr_b16 a[164:165], v9 offset:4096
    v_mfma_f32_16x16x32_bf16 v[60:63], a[44:47], a[4:7], v[60:63]
    ds_read_b64_tr_b16 a[166:167], v9 offset:6144
    ds_read_b128 a[4:7], v2 offset:9216
    v_mfma_f32_16x16x32_bf16 v[64:67], a[32:35], a[8:11], v[64:67]
    ds_read_b128 v[228:231], v19 offset:4864
    v_mfma_f32_16x16x32_bf16 v[68:71], a[36:39], a[8:11], v[68:71]
    ds_read_b128 v[232:235], v19 offset:5120
    ds_read_b128 v[236:239], v19 offset:5376
    ds_read_b128 v[240:243], v19 offset:5632
    v_mfma_f32_16x16x32_bf16 v[72:75], a[40:43], a[8:11], v[72:75]
    ds_read_b128 v[244:247], v19 offset:5888
    ds_read_b128 v[248:251], v19 offset:6144
    v_mfma_f32_16x16x32_bf16 v[76:79], a[44:47], a[8:11], v[76:79]
    ds_read_b128 v[252:255], v19 offset:6400
    ds_read_b128 a[8:11], v2 offset:10240
    v_mfma_f32_16x16x32_bf16 v[80:83], a[32:35], a[12:15], v[80:83]
    s_waitcnt lgkmcnt(15)
    v_add_f32 v216, v216, v217
    v_add_f32 v218, v218, v219
    v_add_f32 v152, v216, v218
    v_mfma_f32_16x16x32_bf16 v[84:87], a[36:39], a[12:15], v[84:87]
    v_add_f32 v220, v220, v221
    v_add_f32 v222, v222, v223
    v_mfma_f32_16x16x32_bf16 v[88:91], a[40:43], a[12:15], v[88:91]
    v_add_f32 v153, v220, v222
    v_add_f32 v224, v224, v225
    v_add_f32 v226, v226, v227
    v_mfma_f32_16x16x32_bf16 v[92:95], a[44:47], a[12:15], v[92:95]
    ds_read_b128 a[12:15], v2 offset:11264
    v_mfma_f32_16x16x32_bf16 v[96:99], a[32:35], a[16:19], v[96:99]
    v_add_f32 v154, v224, v226
    s_waitcnt lgkmcnt(8)
    v_add_f32 v228, v228, v229
    v_add_f32 v230, v230, v231
    v_mfma_f32_16x16x32_bf16 v[100:103], a[36:39], a[16:19], v[100:103]
    ds_write_b128 v16, v[188:191] offset:44032
    v_mfma_f32_16x16x32_bf16 v[104:107], a[40:43], a[16:19], v[104:107]
    v_add_f32 v155, v228, v230
    v_mfma_f32_16x16x32_bf16 v[108:111], a[44:47], a[16:19], v[108:111]
    s_waitcnt lgkmcnt(8)
    v_add_f32 v232, v232, v233
    ds_read_b128 a[16:19], v2 offset:12288
    v_mfma_f32_16x16x32_bf16 v[112:115], a[32:35], a[20:23], v[112:115]
    v_add_f32 v234, v234, v235
    v_add_f32 v156, v232, v234
    s_waitcnt lgkmcnt(8)
    v_add_f32 v236, v236, v237
    v_mfma_f32_16x16x32_bf16 v[116:119], a[36:39], a[20:23], v[116:119]
    v_add_f32 v238, v238, v239
    v_add_f32 v157, v236, v238
    v_mfma_f32_16x16x32_bf16 v[120:123], a[40:43], a[20:23], v[120:123]
    s_add_u32 m0, s29, 4096
    s_mov_b32 s33, 28672
    buffer_load_dwordx4 v172, s[20:23], s33 offen lds
    v_mfma_f32_16x16x32_bf16 v[124:127], a[44:47], a[20:23], v[124:127]
    ds_read_b128 a[20:23], v2 offset:13312
    v_mfma_f32_16x16x32_bf16 v[128:131], a[32:35], a[24:27], v[128:131]
    s_waitcnt lgkmcnt(8)
    v_add_f32 v240, v240, v241
    v_add_f32 v242, v242, v243
    v_mfma_f32_16x16x32_bf16 v[132:135], a[36:39], a[24:27], v[132:135]
    buffer_load_dwordx4 v173, s[20:23], s33 offen offset:1024 lds
    v_mfma_f32_16x16x32_bf16 v[136:139], a[40:43], a[24:27], v[136:139]
    v_add_f32 v158, v240, v242
    v_mfma_f32_16x16x32_bf16 v[140:143], a[44:47], a[24:27], v[140:143]
    s_waitcnt lgkmcnt(7)
    v_add_f32 v244, v244, v245
    ds_read_b128 a[24:27], v2 offset:14336
    v_mfma_f32_16x16x32_bf16 v[144:147], a[32:35], a[28:31], v[144:147]
    buffer_load_dwordx4 v174, s[20:23], s33 offen offset:2048 lds
    v_mfma_f32_16x16x32_bf16 v[148:151], a[36:39], a[28:31], v[148:151]
    v_add_f32 v246, v246, v247
    v_mfma_f32_16x16x32_bf16 a[96:99], a[40:43], a[28:31], a[96:99]
    v_add_f32 v159, v244, v246
    s_waitcnt lgkmcnt(7)
    v_add_f32 v248, v248, v249
    v_mfma_f32_16x16x32_bf16 a[100:103], a[44:47], a[28:31], a[100:103]
    buffer_load_dwordx4 v175, s[20:23], s33 offen offset:3072 lds
    ds_write_b128 v16, v[192:195] offset:45056
    ds_read_b128 a[28:31], v2 offset:15360
    s_waitcnt lgkmcnt(6)
    v_mfma_f32_16x16x32_bf16 a[104:107], a[32:35], a[0:3], a[104:107]
    v_mfma_f32_16x16x32_bf16 a[108:111], a[36:39], a[0:3], a[108:111]
    v_add_f32 v250, v250, v251
    v_add_f32 v160, v248, v250
    v_mfma_f32_16x16x32_bf16 a[112:115], a[40:43], a[0:3], a[112:115]
    v_add_f32 v252, v252, v253
    v_add_f32 v254, v254, v255
    v_mfma_f32_16x16x32_bf16 a[116:119], a[44:47], a[0:3], a[116:119]
    v_add_f32 v161, v252, v254
    ds_read_b128 a[0:3], v2 offset:16384
    v_mfma_f32_16x16x32_bf16 a[120:123], a[32:35], a[4:7], a[120:123]
    v_add_f32 v163, v152, v153
    v_add_f32 v163, v163, v154
    v_mfma_f32_16x16x32_bf16 a[124:127], a[36:39], a[4:7], a[124:127]
    v_add_f32 v163, v163, v155
    v_add_f32 v163, v163, v156
    v_mfma_f32_16x16x32_bf16 a[128:131], a[40:43], a[4:7], a[128:131]
    v_add_f32 v163, v163, v157
    v_add_f32 v163, v163, v158
    v_mfma_f32_16x16x32_bf16 a[132:135], a[44:47], a[4:7], a[132:135]
    v_add_f32 v163, v163, v159
    ds_read_b128 a[4:7], v2 offset:17408
    v_mfma_f32_16x16x32_bf16 v[32:35], a[48:51], a[8:11], v[32:35]
    v_add_f32 v163, v163, v160
    v_add_f32 v163, v163, v161
    v_mfma_f32_16x16x32_bf16 v[36:39], a[52:55], a[8:11], v[36:39]
    s_waitcnt vmcnt(12)
    v_mfma_f32_16x16x32_bf16 v[40:43], a[56:59], a[8:11], v[40:43]
    ds_read_b64_tr_b16 a[32:33], v6 offset:8192
    s_mov_b32 s36, 0x4b800000
    v_cmp_nge_f32 vcc, s36, v163
    s_nop 3
    s_cmp_lg_u64 vcc, 0
    s_cselect_b32 s37, 1, 0
    s_andn2_b32 s37, s37, s35
    s_cmp_lg_u32 s37, 0
    s_cbranch_scc1 L_fallback
    v_mfma_f32_16x16x32_bf16 v[44:47], a[60:63], a[8:11], v[44:47]
    ds_read_b64_tr_b16 a[34:35], v6 offset:10240
    ds_read_b128 a[8:11], v2 offset:18432
    v_mfma_f32_16x16x32_bf16 v[48:51], a[48:51], a[12:15], v[48:51]
    v_rcp_f32 v152, v152
    v_rcp_f32 v153, v153
    v_mfma_f32_16x16x32_bf16 v[52:55], a[52:55], a[12:15], v[52:55]
    ds_read_b64_tr_b16 a[36:37], v7 offset:8192
    v_mfma_f32_16x16x32_bf16 v[56:59], a[56:59], a[12:15], v[56:59]
    ds_write_b128 v16, v[196:199] offset:46080
    v_mfma_f32_16x16x32_bf16 v[60:63], a[60:63], a[12:15], v[60:63]
    ds_read_b128 a[12:15], v2 offset:19456
    s_waitcnt lgkmcnt(8)
    v_mfma_f32_16x16x32_bf16 v[64:67], a[48:51], a[16:19], v[64:67]
    v_mfma_f32_16x16x32_bf16 v[68:71], a[52:55], a[16:19], v[68:71]
    v_rcp_f32 v154, v154
    ds_read_b64_tr_b16 a[38:39], v7 offset:10240
    v_mfma_f32_16x16x32_bf16 v[72:75], a[56:59], a[16:19], v[72:75]
    v_rcp_f32 v155, v155
    ds_read_b64_tr_b16 a[40:41], v8 offset:8192
    v_mfma_f32_16x16x32_bf16 v[76:79], a[60:63], a[16:19], v[76:79]
    v_rcp_f32 v156, v156
    ds_read_b128 a[16:19], v2 offset:20480
    v_mfma_f32_16x16x32_bf16 v[80:83], a[48:51], a[20:23], v[80:83]
    ds_read_b64_tr_b16 a[42:43], v8 offset:10240
    v_mfma_f32_16x16x32_bf16 v[84:87], a[52:55], a[20:23], v[84:87]
    v_rcp_f32 v157, v157
    v_rcp_f32 v158, v158
    v_mfma_f32_16x16x32_bf16 v[88:91], a[56:59], a[20:23], v[88:91]
    ds_read_b64_tr_b16 a[44:45], v9 offset:8192
    v_rcp_f32 v159, v159
    v_mfma_f32_16x16x32_bf16 v[92:95], a[60:63], a[20:23], v[92:95]
    ds_read_b64_tr_b16 a[46:47], v9 offset:10240
    ds_read_b128 a[20:23], v2 offset:21504
    v_mfma_f32_16x16x32_bf16 v[96:99], a[48:51], a[24:27], v[96:99]
    v_rcp_f32 v160, v160
    v_mfma_f32_16x16x32_bf16 v[100:103], a[52:55], a[24:27], v[100:103]
    v_rcp_f32 v161, v161
    v_mfma_f32_16x16x32_bf16 v[104:107], a[56:59], a[24:27], v[104:107]
    v_mfma_f32_16x16x32_bf16 v[108:111], a[60:63], a[24:27], v[108:111]
    ds_read_b128 a[24:27], v2 offset:22528
    v_mfma_f32_16x16x32_bf16 v[112:115], a[48:51], a[28:31], v[112:115]
    ds_write_b128 v16, v[200:203] offset:47104
    v_mfma_f32_16x16x32_bf16 v[116:119], a[52:55], a[28:31], v[116:119]
    v_mfma_f32_16x16x32_bf16 v[120:123], a[56:59], a[28:31], v[120:123]
    s_waitcnt lgkmcnt(2)
    s_add_u32 m0, s29, 8192
    s_mov_b32 s33, 57344
    buffer_load_dwordx4 v172, s[20:23], s33 offen lds
    v_mfma_f32_16x16x32_bf16 v[124:127], a[60:63], a[28:31], v[124:127]
    ds_read_b128 a[28:31], v2 offset:23552
    v_mfma_f32_16x16x32_bf16 v[128:131], a[48:51], a[0:3], v[128:131]
    v_mfma_f32_16x16x32_bf16 v[132:135], a[52:55], a[0:3], v[132:135]
    buffer_load_dwordx4 v173, s[20:23], s33 offen offset:1024 lds
    v_mfma_f32_16x16x32_bf16 v[136:139], a[56:59], a[0:3], v[136:139]
    v_mfma_f32_16x16x32_bf16 v[140:143], a[60:63], a[0:3], v[140:143]
    ds_read_b128 a[0:3], v2 offset:24576
    v_mfma_f32_16x16x32_bf16 v[144:147], a[48:51], a[4:7], v[144:147]
    buffer_load_dwordx4 v174, s[20:23], s33 offen offset:2048 lds
    v_mfma_f32_16x16x32_bf16 v[148:151], a[52:55], a[4:7], v[148:151]
    v_mfma_f32_16x16x32_bf16 a[96:99], a[56:59], a[4:7], a[96:99]
    v_mfma_f32_16x16x32_bf16 a[100:103], a[60:63], a[4:7], a[100:103]
    buffer_load_dwordx4 v175, s[20:23], s33 offen offset:3072 lds
    ds_read_b128 a[4:7], v2 offset:25600
    v_mfma_f32_16x16x32_bf16 a[104:107], a[48:51], a[8:11], a[104:107]
    v_mfma_f32_16x16x32_bf16 a[108:111], a[52:55], a[8:11], a[108:111]
    v_mfma_f32_16x16x32_bf16 a[112:115], a[56:59], a[8:11], a[112:115]
    ds_write_b128 v16, v[204:207] offset:48128
    v_mfma_f32_16x16x32_bf16 a[116:119], a[60:63], a[8:11], a[116:119]
    ds_read_b128 a[8:11], v2 offset:26624
    v_mfma_f32_16x16x32_bf16 a[120:123], a[48:51], a[12:15], a[120:123]
    v_mfma_f32_16x16x32_bf16 a[124:127], a[52:55], a[12:15], a[124:127]
    v_mfma_f32_16x16x32_bf16 a[128:131], a[56:59], a[12:15], a[128:131]
    v_mfma_f32_16x16x32_bf16 a[132:135], a[60:63], a[12:15], a[132:135]
    ds_read_b128 a[12:15], v2 offset:27648
    s_waitcnt lgkmcnt(5)
    v_mfma_f32_16x16x32_bf16 v[32:35], a[64:67], a[16:19], v[32:35]
    v_mfma_f32_16x16x32_bf16 v[36:39], a[68:71], a[16:19], v[36:39]
    s_waitcnt vmcnt(12)
    ds_read_b64_tr_b16 a[48:49], v6 offset:12288
    v_mfma_f32_16x16x32_bf16 v[40:43], a[72:75], a[16:19], v[40:43]
    s_lshl_b32 s36, s28, 11
    s_add_u32 s36, s36, 16384
    v_lshlrev_b32 v17, 4, v1
    v_add_u32 v17, s36, v17
    v_add_u32 v31, 40960, v17
    v_mfma_f32_16x16x32_bf16 v[44:47], a[76:79], a[16:19], v[44:47]
    ds_read_b128 a[16:19], v2 offset:28672
    v_mfma_f32_16x16x32_bf16 v[48:51], a[64:67], a[20:23], v[48:51]
    ds_read_b64_tr_b16 a[50:51], v6 offset:14336
    v_mfma_f32_16x16x32_bf16 v[52:55], a[68:71], a[20:23], v[52:55]
    ds_read_b64_tr_b16 a[52:53], v7 offset:12288
    v_mfma_f32_16x16x32_bf16 v[56:59], a[72:75], a[20:23], v[56:59]
    ds_read_b64_tr_b16 a[54:55], v7 offset:14336
    ds_read_b64_tr_b16 a[56:57], v8 offset:12288
    v_mfma_f32_16x16x32_bf16 v[60:63], a[76:79], a[20:23], v[60:63]
    ds_read_b128 a[20:23], v2 offset:29696
    v_mfma_f32_16x16x32_bf16 v[64:67], a[64:67], a[24:27], v[64:67]
    ds_read_b64_tr_b16 a[58:59], v8 offset:14336
    ds_read_b64_tr_b16 a[60:61], v9 offset:12288
    v_mfma_f32_16x16x32_bf16 v[68:71], a[68:71], a[24:27], v[68:71]
    ds_write_b128 v16, v[208:211] offset:49152
    v_mfma_f32_16x16x32_bf16 v[72:75], a[72:75], a[24:27], v[72:75]
    v_mfma_f32_16x16x32_bf16 v[76:79], a[76:79], a[24:27], v[76:79]
    ds_read_b64_tr_b16 a[62:63], v9 offset:14336
    ds_read_b128 a[24:27], v2 offset:30720
    v_mfma_f32_16x16x32_bf16 v[80:83], a[64:67], a[28:31], v[80:83]
    v_mfma_f32_16x16x32_bf16 v[84:87], a[68:71], a[28:31], v[84:87]
    v_mfma_f32_16x16x32_bf16 v[88:91], a[72:75], a[28:31], v[88:91]
    v_mfma_f32_16x16x32_bf16 v[92:95], a[76:79], a[28:31], v[92:95]
    ds_read_b128 a[28:31], v2 offset:31744
    s_waitcnt lgkmcnt(13)
    v_mfma_f32_16x16x32_bf16 v[96:99], a[64:67], a[0:3], v[96:99]
    v_mfma_f32_16x16x32_bf16 v[100:103], a[68:71], a[0:3], v[100:103]
    v_mfma_f32_16x16x32_bf16 v[104:107], a[72:75], a[0:3], v[104:107]
    v_mfma_f32_16x16x32_bf16 v[108:111], a[76:79], a[0:3], v[108:111]
    ds_read_b128 a[0:3], v2 offset:32768
    v_mfma_f32_16x16x32_bf16 v[112:115], a[64:67], a[4:7], v[112:115]
    v_mfma_f32_16x16x32_bf16 v[116:119], a[68:71], a[4:7], v[116:119]
    v_mfma_f32_16x16x32_bf16 v[120:123], a[72:75], a[4:7], v[120:123]
    s_waitcnt lgkmcnt(2)
    s_add_u32 m0, s29, 12288
    s_mov_b32 s33, 86016
    buffer_load_dwordx4 v172, s[20:23], s33 offen lds
    v_mfma_f32_16x16x32_bf16 v[124:127], a[76:79], a[4:7], v[124:127]
    ds_write_b128 v16, v[212:215] offset:50176
    ds_read_b128 a[4:7], v2 offset:33792
    v_mfma_f32_16x16x32_bf16 v[128:131], a[64:67], a[8:11], v[128:131]
    v_mfma_f32_16x16x32_bf16 v[132:135], a[68:71], a[8:11], v[132:135]
    buffer_load_dwordx4 v173, s[20:23], s33 offen offset:1024 lds
    v_mfma_f32_16x16x32_bf16 v[136:139], a[72:75], a[8:11], v[136:139]
    v_mfma_f32_16x16x32_bf16 v[140:143], a[76:79], a[8:11], v[140:143]
    ds_read_b128 a[8:11], v2 offset:34816
    v_mfma_f32_16x16x32_bf16 v[144:147], a[64:67], a[12:15], v[144:147]
    buffer_load_dwordx4 v174, s[20:23], s33 offen offset:2048 lds
    v_mfma_f32_16x16x32_bf16 v[148:151], a[68:71], a[12:15], v[148:151]
    v_mfma_f32_16x16x32_bf16 a[96:99], a[72:75], a[12:15], a[96:99]
    v_mfma_f32_16x16x32_bf16 a[100:103], a[76:79], a[12:15], a[100:103]
    buffer_load_dwordx4 v175, s[20:23], s33 offen offset:3072 lds
    ds_read_b128 a[12:15], v2 offset:35840
    s_waitcnt lgkmcnt(5)
    v_mfma_f32_16x16x32_bf16 a[104:107], a[64:67], a[16:19], a[104:107]
    v_mfma_f32_16x16x32_bf16 a[108:111], a[68:71], a[16:19], a[108:111]
    v_mfma_f32_16x16x32_bf16 a[112:115], a[72:75], a[16:19], a[112:115]
    v_mfma_f32_16x16x32_bf16 a[116:119], a[76:79], a[16:19], a[116:119]
    ds_read_b128 a[16:19], v2 offset:36864
    v_mfma_f32_16x16x32_bf16 a[120:123], a[64:67], a[20:23], a[120:123]
    v_mfma_f32_16x16x32_bf16 a[124:127], a[68:71], a[20:23], a[124:127]
    v_mfma_f32_16x16x32_bf16 a[128:131], a[72:75], a[20:23], a[128:131]
    v_mfma_f32_16x16x32_bf16 a[132:135], a[76:79], a[20:23], a[132:135]
    ds_read_b128 a[20:23], v2 offset:37888
    v_mfma_f32_16x16x32_bf16 v[32:35], a[80:83], a[24:27], v[32:35]
    v_mfma_f32_16x16x32_bf16 v[36:39], a[84:87], a[24:27], v[36:39]
    v_mfma_f32_16x16x32_bf16 v[40:43], a[88:91], a[24:27], v[40:43]
    v_mfma_f32_16x16x32_bf16 v[44:47], a[92:95], a[24:27], v[44:47]
    ds_read_b128 a[24:27], v2 offset:38912
    v_mfma_f32_16x16x32_bf16 v[48:51], a[80:83], a[28:31], v[48:51]
    v_mfma_f32_16x16x32_bf16 v[52:55], a[84:87], a[28:31], v[52:55]
    v_mfma_f32_16x16x32_bf16 v[56:59], a[88:91], a[28:31], v[56:59]
    v_mfma_f32_16x16x32_bf16 v[60:63], a[92:95], a[28:31], v[60:63]
    ds_read_b128 a[28:31], v2 offset:39936
    s_waitcnt lgkmcnt(4)
    v_mfma_f32_16x16x32_bf16 v[64:67], a[80:83], a[0:3], v[64:67]
    v_mfma_f32_16x16x32_bf16 v[68:71], a[84:87], a[0:3], v[68:71]
    v_mfma_f32_16x16x32_bf16 v[72:75], a[88:91], a[0:3], v[72:75]
    v_mfma_f32_16x16x32_bf16 v[76:79], a[92:95], a[0:3], v[76:79]
    s_waitcnt lgkmcnt(0)
    s_barrier
    ds_read_b128 a[0:3], v3
    v_mfma_f32_16x16x32_bf16 v[80:83], a[80:83], a[4:7], v[80:83]
    v_mfma_f32_16x16x32_bf16 v[84:87], a[84:87], a[4:7], v[84:87]
    v_mfma_f32_16x16x32_bf16 v[88:91], a[88:91], a[4:7], v[88:91]
    v_mfma_f32_16x16x32_bf16 v[92:95], a[92:95], a[4:7], v[92:95]
    ds_read_b128 a[4:7], v3 offset:1024
    v_mfma_f32_16x16x32_bf16 v[96:99], a[80:83], a[8:11], v[96:99]
    v_mfma_f32_16x16x32_bf16 v[100:103], a[84:87], a[8:11], v[100:103]
    v_mfma_f32_16x16x32_bf16 v[104:107], a[88:91], a[8:11], v[104:107]
    v_mfma_f32_16x16x32_bf16 v[108:111], a[92:95], a[8:11], v[108:111]
    ds_read_b128 a[8:11], v3 offset:2048
    v_mfma_f32_16x16x32_bf16 v[112:115], a[80:83], a[12:15], v[112:115]
    v_mfma_f32_16x16x32_bf16 v[116:119], a[84:87], a[12:15], v[116:119]
    v_mfma_f32_16x16x32_bf16 v[120:123], a[88:91], a[12:15], v[120:123]
    v_mfma_f32_16x16x32_bf16 v[124:127], a[92:95], a[12:15], v[124:127]
    ds_read_b128 a[12:15], v3 offset:3072
    v_mfma_f32_16x16x32_bf16 v[128:131], a[80:83], a[16:19], v[128:131]
    v_mfma_f32_16x16x32_bf16 v[132:135], a[84:87], a[16:19], v[132:135]
    v_mfma_f32_16x16x32_bf16 v[136:139], a[88:91], a[16:19], v[136:139]
    v_mfma_f32_16x16x32_bf16 v[140:143], a[92:95], a[16:19], v[140:143]
    ds_read_b128 a[16:19], v3 offset:4096
    v_mfma_f32_16x16x32_bf16 v[144:147], a[80:83], a[20:23], v[144:147]
    v_mfma_f32_16x16x32_bf16 v[148:151], a[84:87], a[20:23], v[148:151]
    v_mfma_f32_16x16x32_bf16 a[96:99], a[88:91], a[20:23], a[96:99]
    v_mfma_f32_16x16x32_bf16 a[100:103], a[92:95], a[20:23], a[100:103]
    ds_read_b128 a[20:23], v3 offset:5120
    v_mfma_f32_16x16x32_bf16 a[104:107], a[80:83], a[24:27], a[104:107]
    v_mfma_f32_16x16x32_bf16 a[108:111], a[84:87], a[24:27], a[108:111]
    v_mfma_f32_16x16x32_bf16 a[112:115], a[88:91], a[24:27], a[112:115]
    v_mfma_f32_16x16x32_bf16 a[116:119], a[92:95], a[24:27], a[116:119]
    ds_read_b128 a[24:27], v3 offset:6144
    v_mfma_f32_16x16x32_bf16 a[120:123], a[80:83], a[28:31], a[120:123]
    v_mfma_f32_16x16x32_bf16 a[124:127], a[84:87], a[28:31], a[124:127]
    v_mfma_f32_16x16x32_bf16 a[128:131], a[88:91], a[28:31], a[128:131]
    v_mfma_f32_16x16x32_bf16 a[132:135], a[92:95], a[28:31], a[132:135]
    ds_read_b128 a[28:31], v3 offset:7168
    s_waitcnt lgkmcnt(4)
    v_mfma_f32_16x16x32_bf16 v[32:35], a[136:139], a[0:3], v[32:35]
    v_mfma_f32_16x16x32_bf16 v[36:39], a[140:143], a[0:3], v[36:39]
    v_mfma_f32_16x16x32_bf16 v[40:43], a[144:147], a[0:3], v[40:43]
    v_mfma_f32_16x16x32_bf16 v[44:47], a[148:151], a[0:3], v[44:47]
    ds_read_b128 a[0:3], v3 offset:8192
    v_mfma_f32_16x16x32_bf16 v[48:51], a[136:139], a[4:7], v[48:51]
    s_waitcnt vmcnt(12)
    ds_read_b64_tr_b16 a[208:209], v6
    ds_read_b64_tr_b16 a[210:211], v6 offset:2048
    v_mfma_f32_16x16x32_bf16 v[52:55], a[140:143], a[4:7], v[52:55]
    ds_read_b64_tr_b16 a[212:213], v7
    ds_read_b64_tr_b16 a[214:215], v7 offset:2048
    v_mfma_f32_16x16x32_bf16 v[56:59], a[144:147], a[4:7], v[56:59]
    ds_read_b64_tr_b16 a[216:217], v8
    ds_read_b64_tr_b16 a[218:219], v8 offset:2048
    v_mfma_f32_16x16x32_bf16 v[60:63], a[148:151], a[4:7], v[60:63]
    ds_read_b64_tr_b16 a[220:221], v9
    ds_read_b128 a[4:7], v3 offset:9216
    v_mfma_f32_16x16x32_bf16 v[64:67], a[136:139], a[8:11], v[64:67]
    ds_read_b64_tr_b16 a[222:223], v9 offset:2048
    v_mfma_f32_16x16x32_bf16 v[68:71], a[140:143], a[8:11], v[68:71]
    v_mfma_f32_16x16x32_bf16 v[72:75], a[144:147], a[8:11], v[72:75]
    v_mfma_f32_16x16x32_bf16 v[76:79], a[148:151], a[8:11], v[76:79]
    ds_read_b128 a[8:11], v3 offset:10240
    v_mfma_f32_16x16x32_bf16 v[80:83], a[136:139], a[12:15], v[80:83]
    v_mfma_f32_16x16x32_bf16 v[84:87], a[140:143], a[12:15], v[84:87]
    v_mfma_f32_16x16x32_bf16 v[88:91], a[144:147], a[12:15], v[88:91]
    s_waitcnt lgkmcnt(1)
    s_add_u32 m0, s29, 0
    s_mov_b32 s33, 114688
    buffer_load_dwordx4 v172, s[20:23], s33 offen lds
    v_mfma_f32_16x16x32_bf16 v[92:95], a[148:151], a[12:15], v[92:95]
    buffer_load_dwordx4 v173, s[20:23], s33 offen offset:1024 lds
    ds_read_b128 a[12:15], v3 offset:11264
    v_mfma_f32_16x16x32_bf16 v[96:99], a[136:139], a[16:19], v[96:99]
    buffer_load_dwordx4 v174, s[20:23], s33 offen offset:2048 lds
    v_mfma_f32_16x16x32_bf16 v[100:103], a[140:143], a[16:19], v[100:103]
    buffer_load_dwordx4 v175, s[20:23], s33 offen offset:3072 lds
    v_mfma_f32_16x16x32_bf16 v[104:107], a[144:147], a[16:19], v[104:107]
    v_mfma_f32_16x16x32_bf16 v[108:111], a[148:151], a[16:19], v[108:111]
    ds_read_b128 a[16:19], v3 offset:12288
    v_mfma_f32_16x16x32_bf16 v[112:115], a[136:139], a[20:23], v[112:115]
    v_mfma_f32_16x16x32_bf16 v[116:119], a[140:143], a[20:23], v[116:119]
    v_mfma_f32_16x16x32_bf16 v[120:123], a[144:147], a[20:23], v[120:123]
    v_mfma_f32_16x16x32_bf16 v[124:127], a[148:151], a[20:23], v[124:127]
    ds_read_b128 a[20:23], v3 offset:13312
    v_mfma_f32_16x16x32_bf16 v[128:131], a[136:139], a[24:27], v[128:131]
    s_waitcnt vmcnt(12)
    ds_read_b64_tr_b16 a[224:225], v6 offset:4096
    ds_read_b64_tr_b16 a[226:227], v6 offset:6144
    v_mfma_f32_16x16x32_bf16 v[132:135], a[140:143], a[24:27], v[132:135]
    ds_read_b64_tr_b16 a[228:229], v7 offset:4096
    ds_read_b64_tr_b16 a[230:231], v7 offset:6144
    v_mfma_f32_16x16x32_bf16 v[136:139], a[144:147], a[24:27], v[136:139]
    ds_read_b64_tr_b16 a[232:233], v8 offset:4096
    ds_read_b64_tr_b16 a[234:235], v8 offset:6144
    v_mfma_f32_16x16x32_bf16 v[140:143], a[148:151], a[24:27], v[140:143]
    ds_read_b64_tr_b16 a[236:237], v9 offset:4096
    ds_read_b128 a[24:27], v3 offset:14336
    v_mfma_f32_16x16x32_bf16 v[144:147], a[136:139], a[28:31], v[144:147]
    ds_read_b64_tr_b16 a[238:239], v9 offset:6144
    v_mfma_f32_16x16x32_bf16 v[148:151], a[140:143], a[28:31], v[148:151]
    v_mfma_f32_16x16x32_bf16 a[96:99], a[144:147], a[28:31], a[96:99]
    v_mfma_f32_16x16x32_bf16 a[100:103], a[148:151], a[28:31], a[100:103]
    ds_read_b128 a[28:31], v3 offset:15360
    s_waitcnt lgkmcnt(12)
    v_mfma_f32_16x16x32_bf16 a[104:107], a[136:139], a[0:3], a[104:107]
    v_mfma_f32_16x16x32_bf16 a[108:111], a[140:143], a[0:3], a[108:111]
    v_mfma_f32_16x16x32_bf16 a[112:115], a[144:147], a[0:3], a[112:115]
    s_waitcnt lgkmcnt(1)
    s_add_u32 m0, s29, 4096
    s_mov_b32 s33, 143360
    buffer_load_dwordx4 v172, s[20:23], s33 offen lds
    v_mfma_f32_16x16x32_bf16 a[116:119], a[148:151], a[0:3], a[116:119]
    buffer_load_dwordx4 v173, s[20:23], s33 offen offset:1024 lds
    ds_read_b128 a[0:3], v3 offset:16384
    v_mfma_f32_16x16x32_bf16 a[120:123], a[136:139], a[4:7], a[120:123]
    buffer_load_dwordx4 v174, s[20:23], s33 offen offset:2048 lds
    v_mfma_f32_16x16x32_bf16 a[124:127], a[140:143], a[4:7], a[124:127]
    buffer_load_dwordx4 v175, s[20:23], s33 offen offset:3072 lds
    v_mfma_f32_16x16x32_bf16 a[128:131], a[144:147], a[4:7], a[128:131]
    v_mfma_f32_16x16x32_bf16 a[132:135], a[148:151], a[4:7], a[132:135]
    ds_read_b128 a[4:7], v3 offset:17408
    v_mfma_f32_16x16x32_bf16 v[32:35], a[152:155], a[8:11], v[32:35]
    v_mfma_f32_16x16x32_bf16 v[36:39], a[156:159], a[8:11], v[36:39]
    v_mfma_f32_16x16x32_bf16 v[40:43], a[160:163], a[8:11], v[40:43]
    v_mfma_f32_16x16x32_bf16 v[44:47], a[164:167], a[8:11], v[44:47]
    ds_read_b128 a[8:11], v3 offset:18432
    v_mfma_f32_16x16x32_bf16 v[48:51], a[152:155], a[12:15], v[48:51]
    s_waitcnt vmcnt(12)
    ds_read_b64_tr_b16 v[224:225], v6 offset:8192
    ds_read_b64_tr_b16 v[226:227], v6 offset:10240
    v_mfma_f32_16x16x32_bf16 v[52:55], a[156:159], a[12:15], v[52:55]
    ds_read_b64_tr_b16 v[228:229], v7 offset:8192
    ds_read_b64_tr_b16 v[230:231], v7 offset:10240
    v_mfma_f32_16x16x32_bf16 v[56:59], a[160:163], a[12:15], v[56:59]
    ds_read_b64_tr_b16 v[232:233], v8 offset:8192
    ds_read_b64_tr_b16 v[234:235], v8 offset:10240
    v_mfma_f32_16x16x32_bf16 v[60:63], a[164:167], a[12:15], v[60:63]
    ds_read_b128 a[12:15], v3 offset:19456
    s_waitcnt lgkmcnt(10)
    v_mfma_f32_16x16x32_bf16 v[64:67], a[152:155], a[16:19], v[64:67]
    ds_read_b64_tr_b16 v[236:237], v9 offset:8192
    ds_read_b64_tr_b16 v[238:239], v9 offset:10240
    v_mfma_f32_16x16x32_bf16 v[68:71], a[156:159], a[16:19], v[68:71]
    v_mfma_f32_16x16x32_bf16 v[72:75], a[160:163], a[16:19], v[72:75]
    v_mfma_f32_16x16x32_bf16 v[76:79], a[164:167], a[16:19], v[76:79]
    ds_read_b128 a[16:19], v3 offset:20480
    v_mfma_f32_16x16x32_bf16 v[80:83], a[152:155], a[20:23], v[80:83]
    v_mfma_f32_16x16x32_bf16 v[84:87], a[156:159], a[20:23], v[84:87]
    v_mfma_f32_16x16x32_bf16 v[88:91], a[160:163], a[20:23], v[88:91]
    s_waitcnt lgkmcnt(1)
    s_add_u32 m0, s29, 8192
    s_mov_b32 s33, 172032
    buffer_load_dwordx4 v172, s[20:23], s33 offen lds
    v_mfma_f32_16x16x32_bf16 v[92:95], a[164:167], a[20:23], v[92:95]
    buffer_load_dwordx4 v173, s[20:23], s33 offen offset:1024 lds
    ds_read_b128 a[20:23], v3 offset:21504
    v_mfma_f32_16x16x32_bf16 v[96:99], a[152:155], a[24:27], v[96:99]
    buffer_load_dwordx4 v174, s[20:23], s33 offen offset:2048 lds
    v_mfma_f32_16x16x32_bf16 v[100:103], a[156:159], a[24:27], v[100:103]
    buffer_load_dwordx4 v175, s[20:23], s33 offen offset:3072 lds
    v_mfma_f32_16x16x32_bf16 v[104:107], a[160:163], a[24:27], v[104:107]
    v_mfma_f32_16x16x32_bf16 v[108:111], a[164:167], a[24:27], v[108:111]
    ds_read_b128 a[24:27], v3 offset:22528
    v_mfma_f32_16x16x32_bf16 v[112:115], a[152:155], a[28:31], v[112:115]
    v_mfma_f32_16x16x32_bf16 v[116:119], a[156:159], a[28:31], v[116:119]
    v_mfma_f32_16x16x32_bf16 v[120:123], a[160:163], a[28:31], v[120:123]
    v_mfma_f32_16x16x32_bf16 v[124:127], a[164:167], a[28:31], v[124:127]
    ds_read_b128 a[28:31], v3 offset:23552
    v_mfma_f32_16x16x32_bf16 v[128:131], a[152:155], a[0:3], v[128:131]
    s_waitcnt vmcnt(12)
    ds_read_b64_tr_b16 v[240:241], v6 offset:12288
    ds_read_b64_tr_b16 v[242:243], v6 offset:14336
    v_mfma_f32_16x16x32_bf16 v[132:135], a[156:159], a[0:3], v[132:135]
    ds_read_b64_tr_b16 v[244:245], v7 offset:12288
    ds_read_b64_tr_b16 v[246:247], v7 offset:14336
    v_mfma_f32_16x16x32_bf16 v[136:139], a[160:163], a[0:3], v[136:139]
    ds_read_b64_tr_b16 v[248:249], v8 offset:12288
    ds_read_b64_tr_b16 v[250:251], v8 offset:14336
    v_mfma_f32_16x16x32_bf16 v[140:143], a[164:167], a[0:3], v[140:143]
    ds_read_b64_tr_b16 v[252:253], v9 offset:12288
    ds_read_b64_tr_b16 v[254:255], v9 offset:14336
    ds_read_b128 a[0:3], v3 offset:24576
    v_mfma_f32_16x16x32_bf16 v[144:147], a[152:155], a[4:7], v[144:147]
    v_mfma_f32_16x16x32_bf16 v[148:151], a[156:159], a[4:7], v[148:151]
    v_mfma_f32_16x16x32_bf16 a[96:99], a[160:163], a[4:7], a[96:99]
    v_mfma_f32_16x16x32_bf16 a[100:103], a[164:167], a[4:7], a[100:103]
    ds_read_b128 a[4:7], v3 offset:25600
    v_mfma_f32_16x16x32_bf16 a[104:107], a[152:155], a[8:11], a[104:107]
    v_mfma_f32_16x16x32_bf16 a[108:111], a[156:159], a[8:11], a[108:111]
    v_mfma_f32_16x16x32_bf16 a[112:115], a[160:163], a[8:11], a[112:115]
    s_waitcnt lgkmcnt(2)
    s_add_u32 m0, s29, 12288
    s_mov_b32 s33, 200704
    buffer_load_dwordx4 v172, s[20:23], s33 offen lds
    v_mfma_f32_16x16x32_bf16 a[116:119], a[164:167], a[8:11], a[116:119]
    buffer_load_dwordx4 v173, s[20:23], s33 offen offset:1024 lds
    ds_read_b128 a[8:11], v3 offset:26624
    v_mfma_f32_16x16x32_bf16 a[120:123], a[152:155], a[12:15], a[120:123]
    buffer_load_dwordx4 v174, s[20:23], s33 offen offset:2048 lds
    v_mfma_f32_16x16x32_bf16 a[124:127], a[156:159], a[12:15], a[124:127]
    buffer_load_dwordx4 v175, s[20:23], s33 offen offset:3072 lds
    v_mfma_f32_16x16x32_bf16 a[128:131], a[160:163], a[12:15], a[128:131]
    v_mfma_f32_16x16x32_bf16 a[132:135], a[164:167], a[12:15], a[132:135]
    ds_read_b128 a[12:15], v3 offset:27648
    v_mfma_f32_16x16x32_bf16 v[32:35], a[32:35], a[16:19], v[32:35]
    v_mfma_f32_16x16x32_bf16 v[36:39], a[36:39], a[16:19], v[36:39]
    v_mfma_f32_16x16x32_bf16 v[40:43], a[40:43], a[16:19], v[40:43]
    v_mfma_f32_16x16x32_bf16 v[44:47], a[44:47], a[16:19], v[44:47]
    ds_read_b128 a[16:19], v3 offset:28672
    v_mfma_f32_16x16x32_bf16 v[48:51], a[32:35], a[20:23], v[48:51]
    v_mfma_f32_16x16x32_bf16 v[52:55], a[36:39], a[20:23], v[52:55]
    v_mfma_f32_16x16x32_bf16 v[56:59], a[40:43], a[20:23], v[56:59]
    v_mfma_f32_16x16x32_bf16 v[60:63], a[44:47], a[20:23], v[60:63]
    ds_read_b128 a[20:23], v3 offset:29696
    v_mfma_f32_16x16x32_bf16 v[64:67], a[32:35], a[24:27], v[64:67]
    v_mfma_f32_16x16x32_bf16 v[68:71], a[36:39], a[24:27], v[68:71]
    v_mfma_f32_16x16x32_bf16 v[72:75], a[40:43], a[24:27], v[72:75]
    s_waitcnt vmcnt(12)
    ds_read_b64_tr_b16 v[176:177], v6
    ds_read_b64_tr_b16 v[178:179], v6 offset:2048
    v_mfma_f32_16x16x32_bf16 v[76:79], a[44:47], a[24:27], v[76:79]
    ds_read_b64_tr_b16 v[180:181], v7
    ds_read_b64_tr_b16 v[182:183], v7 offset:2048
    ds_read_b128 a[24:27], v3 offset:30720
    v_mfma_f32_16x16x32_bf16 v[80:83], a[32:35], a[28:31], v[80:83]
    ds_read_b64_tr_b16 v[184:185], v8
    ds_read_b64_tr_b16 v[186:187], v8 offset:2048
    ds_read_b64_tr_b16 v[188:189], v9
    v_mfma_f32_16x16x32_bf16 v[84:87], a[36:39], a[28:31], v[84:87]
    ds_read_b64_tr_b16 v[190:191], v9 offset:2048
    v_mfma_f32_16x16x32_bf16 v[88:91], a[40:43], a[28:31], v[88:91]
    v_mfma_f32_16x16x32_bf16 v[92:95], a[44:47], a[28:31], v[92:95]
    ds_read_b128 a[28:31], v3 offset:31744
    s_waitcnt lgkmcnt(12)
    v_mfma_f32_16x16x32_bf16 v[96:99], a[32:35], a[0:3], v[96:99]
    v_mfma_f32_16x16x32_bf16 v[100:103], a[36:39], a[0:3], v[100:103]
    v_mfma_f32_16x16x32_bf16 v[104:107], a[40:43], a[0:3], v[104:107]
    v_mfma_f32_16x16x32_bf16 v[108:111], a[44:47], a[0:3], v[108:111]
    ds_read_b128 a[0:3], v3 offset:32768
    v_mfma_f32_16x16x32_bf16 v[112:115], a[32:35], a[4:7], v[112:115]
    s_waitcnt lgkmcnt(2)
    s_add_u32 m0, s29, 0
    s_mov_b32 s33, 128
    buffer_load_dwordx4 v172, s[20:23], s33 offen lds
    v_mfma_f32_16x16x32_bf16 v[116:119], a[36:39], a[4:7], v[116:119]
    buffer_load_dwordx4 v173, s[20:23], s33 offen offset:1024 lds
    v_mfma_f32_16x16x32_bf16 v[120:123], a[40:43], a[4:7], v[120:123]
    buffer_load_dwordx4 v174, s[20:23], s33 offen offset:2048 lds
    v_mfma_f32_16x16x32_bf16 v[124:127], a[44:47], a[4:7], v[124:127]
    buffer_load_dwordx4 v175, s[20:23], s33 offen offset:3072 lds
    ds_read_b128 a[4:7], v3 offset:33792
    v_mfma_f32_16x16x32_bf16 v[128:131], a[32:35], a[8:11], v[128:131]
    v_mfma_f32_16x16x32_bf16 v[132:135], a[36:39], a[8:11], v[132:135]
    v_mfma_f32_16x16x32_bf16 v[136:139], a[40:43], a[8:11], v[136:139]
    v_mfma_f32_16x16x32_bf16 v[140:143], a[44:47], a[8:11], v[140:143]
    ds_read_b128 a[8:11], v3 offset:34816
    v_mfma_f32_16x16x32_bf16 v[144:147], a[32:35], a[12:15], v[144:147]
    v_mfma_f32_16x16x32_bf16 v[148:151], a[36:39], a[12:15], v[148:151]
    v_mfma_f32_16x16x32_bf16 a[96:99], a[40:43], a[12:15], a[96:99]
    v_mfma_f32_16x16x32_bf16 a[100:103], a[44:47], a[12:15], a[100:103]
    ds_read_b128 a[12:15], v3 offset:35840
    s_waitcnt lgkmcnt(4)
    v_mfma_f32_16x16x32_bf16 a[104:107], a[32:35], a[16:19], a[104:107]
    v_mfma_f32_16x16x32_bf16 a[108:111], a[36:39], a[16:19], a[108:111]
    v_mfma_f32_16x16x32_bf16 a[112:115], a[40:43], a[16:19], a[112:115]
    v_mfma_f32_16x16x32_bf16 a[116:119], a[44:47], a[16:19], a[116:119]
    ds_read_b128 a[16:19], v3 offset:36864
    v_mfma_f32_16x16x32_bf16 a[120:123], a[32:35], a[20:23], a[120:123]
    v_mfma_f32_16x16x32_bf16 a[124:127], a[36:39], a[20:23], a[124:127]
    v_mfma_f32_16x16x32_bf16 a[128:131], a[40:43], a[20:23], a[128:131]
    v_mfma_f32_16x16x32_bf16 a[132:135], a[44:47], a[20:23], a[132:135]
    ds_read_b128 a[20:23], v3 offset:37888
    v_mfma_f32_16x16x32_bf16 v[32:35], a[48:51], a[24:27], v[32:35]
    s_waitcnt vmcnt(12)
    ds_read_b64_tr_b16 v[192:193], v6 offset:4096
    ds_read_b64_tr_b16 v[194:195], v6 offset:6144
    ds_read_b64_tr_b16 v[196:197], v7 offset:4096
    ds_read_b64_tr_b16 v[198:199], v7 offset:6144
    v_mfma_f32_16x16x32_bf16 v[36:39], a[52:55], a[24:27], v[36:39]
    ds_read_b64_tr_b16 v[200:201], v8 offset:4096
    ds_read_b64_tr_b16 v[202:203], v8 offset:6144
    ds_read_b64_tr_b16 v[204:205], v9 offset:4096
    ds_read_b64_tr_b16 v[206:207], v9 offset:6144
    v_mfma_f32_16x16x32_bf16 v[40:43], a[56:59], a[24:27], v[40:43]
    v_mfma_f32_16x16x32_bf16 v[44:47], a[60:63], a[24:27], v[44:47]
    ds_read_b128 a[24:27], v3 offset:38912
    v_mfma_f32_16x16x32_bf16 v[48:51], a[48:51], a[28:31], v[48:51]
    v_mfma_f32_16x16x32_bf16 v[52:55], a[52:55], a[28:31], v[52:55]
    v_mfma_f32_16x16x32_bf16 v[56:59], a[56:59], a[28:31], v[56:59]
    v_mfma_f32_16x16x32_bf16 v[60:63], a[60:63], a[28:31], v[60:63]
    v_mul_f32 v32, v32, v152
    v_mul_f32 v33, v33, v152
    v_mul_f32 v34, v34, v152
    v_mul_f32 v35, v35, v152
    v_mul_f32 v36, v36, v152
    ds_read_b128 a[28:31], v3 offset:39936
    s_waitcnt lgkmcnt(12)
    v_mfma_f32_16x16x32_bf16 v[64:67], a[48:51], a[0:3], v[64:67]
    v_mul_f32 v37, v37, v152
    v_mul_f32 v38, v38, v152
    v_mul_f32 v39, v39, v152
    v_cvt_pk_bf16_f32 v32, v32, v33
    v_cvt_pk_bf16_f32 v33, v34, v35
    v_cvt_pk_bf16_f32 v34, v36, v37
    v_cvt_pk_bf16_f32 v35, v38, v39
    v_mfma_f32_16x16x32_bf16 v[68:71], a[52:55], a[0:3], v[68:71]
    ds_write_b128 v17, v[32:35]
    v_mul_f32 v40, v40, v152
    v_mul_f32 v41, v41, v152
    v_mul_f32 v42, v42, v152
    v_mul_f32 v43, v43, v152
    v_mul_f32 v44, v44, v152
    v_mfma_f32_16x16x32_bf16 v[72:75], a[56:59], a[0:3], v[72:75]
    s_waitcnt lgkmcnt(3)
    s_add_u32 m0, s29, 4096
    s_mov_b32 s33, 28800
    buffer_load_dwordx4 v172, s[20:23], s33 offen lds
    v_mfma_f32_16x16x32_bf16 v[76:79], a[60:63], a[0:3], v[76:79]
    v_mul_f32 v45, v45, v152
    buffer_load_dwordx4 v173, s[20:23], s33 offen offset:1024 lds
    v_mfma_f32_16x16x32_bf16 v[80:83], a[48:51], a[4:7], v[80:83]
    v_mul_f32 v46, v46, v152
    v_mul_f32 v47, v47, v152
    buffer_load_dwordx4 v174, s[20:23], s33 offen offset:2048 lds
    v_mfma_f32_16x16x32_bf16 v[84:87], a[52:55], a[4:7], v[84:87]
    v_cvt_pk_bf16_f32 v40, v40, v41
    v_cvt_pk_bf16_f32 v41, v42, v43
    buffer_load_dwordx4 v175, s[20:23], s33 offen offset:3072 lds
    v_mfma_f32_16x16x32_bf16 v[88:91], a[56:59], a[4:7], v[88:91]
    v_cvt_pk_bf16_f32 v42, v44, v45
    v_cvt_pk_bf16_f32 v43, v46, v47
    v_mul_f32 v48, v48, v153
    ds_write_b128 v17, v[40:43] offset:1024
    v_mul_f32 v49, v49, v153
    v_mul_f32 v50, v50, v153
    v_mfma_f32_16x16x32_bf16 v[92:95], a[60:63], a[4:7], v[92:95]
    v_mul_f32 v51, v51, v153
    v_mul_f32 v52, v52, v153
    v_mul_f32 v53, v53, v153
    v_mul_f32 v54, v54, v153
    v_mul_f32 v55, v55, v153
    v_cvt_pk_bf16_f32 v48, v48, v49
    v_cvt_pk_bf16_f32 v49, v50, v51
    v_mfma_f32_16x16x32_bf16 v[96:99], a[48:51], a[8:11], v[96:99]
    v_cvt_pk_bf16_f32 v50, v52, v53
    v_cvt_pk_bf16_f32 v51, v54, v55
    ds_write_b128 v17, v[48:51] offset:8192
    v_mul_f32 v56, v56, v153
    v_mul_f32 v57, v57, v153
    v_mul_f32 v58, v58, v153
    v_mfma_f32_16x16x32_bf16 v[100:103], a[52:55], a[8:11], v[100:103]
    v_mul_f32 v59, v59, v153
    v_mul_f32 v60, v60, v153
    v_mul_f32 v61, v61, v153
    v_mul_f32 v62, v62, v153
    v_mul_f32 v63, v63, v153
    v_cvt_pk_bf16_f32 v56, v56, v57
    v_mfma_f32_16x16x32_bf16 v[104:107], a[56:59], a[8:11], v[104:107]
    v_cvt_pk_bf16_f32 v57, v58, v59
    s_waitcnt vmcnt(12)
    v_cvt_pk_bf16_f32 v58, v60, v61
    ds_read_b64_tr_b16 v[208:209], v6 offset:8192
    v_cvt_pk_bf16_f32 v59, v62, v63
    ds_read_b64_tr_b16 v[210:211], v6 offset:10240
    v_mfma_f32_16x16x32_bf16 v[108:111], a[60:63], a[8:11], v[108:111]
    ds_write_b128 v17, v[56:59] offset:9216
    v_mul_f32 v64, v64, v154
    ds_read_b64_tr_b16 v[212:213], v7 offset:8192
    v_mul_f32 v65, v65, v154
    v_mul_f32 v66, v66, v154
    ds_read_b64_tr_b16 v[214:215], v7 offset:10240
    v_mfma_f32_16x16x32_bf16 v[112:115], a[48:51], a[12:15], v[112:115]
    v_mul_f32 v67, v67, v154
    ds_read_b64_tr_b16 v[216:217], v8 offset:8192
    v_mul_f32 v68, v68, v154
    ds_read_b64_tr_b16 v[218:219], v8 offset:10240
    v_mul_f32 v69, v69, v154
    ds_read_b64_tr_b16 v[220:221], v9 offset:8192
    v_mfma_f32_16x16x32_bf16 v[116:119], a[52:55], a[12:15], v[116:119]
    v_mul_f32 v70, v70, v154
    v_mul_f32 v71, v71, v154
    ds_read_b64_tr_b16 v[222:223], v9 offset:10240
    v_cvt_pk_bf16_f32 v64, v64, v65
    v_cvt_pk_bf16_f32 v65, v66, v67
    v_cvt_pk_bf16_f32 v66, v68, v69
    v_cvt_pk_bf16_f32 v67, v70, v71
    v_mfma_f32_16x16x32_bf16 v[120:123], a[56:59], a[12:15], v[120:123]
    ds_write_b128 v17, v[64:67] offset:16384
    v_mul_f32 v72, v72, v154
    v_mul_f32 v73, v73, v154
    v_mul_f32 v74, v74, v154
    v_mul_f32 v75, v75, v154
    v_mul_f32 v76, v76, v154
    v_mfma_f32_16x16x32_bf16 v[124:127], a[60:63], a[12:15], v[124:127]
    v_mul_f32 v77, v77, v154
    v_mul_f32 v78, v78, v154
    v_mul_f32 v79, v79, v154
    v_cvt_pk_bf16_f32 v72, v72, v73
    v_cvt_pk_bf16_f32 v73, v74, v75
    v_cvt_pk_bf16_f32 v74, v76, v77
    s_waitcnt lgkmcnt(13)
    v_mfma_f32_16x16x32_bf16 v[128:131], a[48:51], a[16:19], v[128:131]
    s_waitcnt lgkmcnt(1)
    s_add_u32 m0, s29, 8192
    s_mov_b32 s33, 57472
    buffer_load_dwordx4 v172, s[20:23], s33 offen lds
    v_mfma_f32_16x16x32_bf16 v[132:135], a[52:55], a[16:19], v[132:135]
    v_cvt_pk_bf16_f32 v75, v78, v79
    buffer_load_dwordx4 v173, s[20:23], s33 offen offset:1024 lds
    v_mfma_f32_16x16x32_bf16 v[136:139], a[56:59], a[16:19], v[136:139]
    ds_write_b128 v17, v[72:75] offset:17408
    buffer_load_dwordx4 v174, s[20:23], s33 offen offset:2048 lds
    v_mfma_f32_16x16x32_bf16 v[140:143], a[60:63], a[16:19], v[140:143]
    buffer_load_dwordx4 v175, s[20:23], s33 offen offset:3072 lds
    v_mfma_f32_16x16x32_bf16 v[144:147], a[48:51], a[20:23], v[144:147]
    v_mfma_f32_16x16x32_bf16 v[148:151], a[52:55], a[20:23], v[148:151]
    s_waitcnt vmcnt(12)
    ds_read_b64_tr_b16 a[168:169], v6 offset:12288
    v_mfma_f32_16x16x32_bf16 a[96:99], a[56:59], a[20:23], a[96:99]
    ds_read_b64_tr_b16 a[170:171], v6 offset:14336
    ds_read_b64_tr_b16 a[172:173], v7 offset:12288
    v_mfma_f32_16x16x32_bf16 a[100:103], a[60:63], a[20:23], a[100:103]
    ds_read_b64_tr_b16 a[174:175], v7 offset:14336
    v_mfma_f32_16x16x32_bf16 a[104:107], a[48:51], a[24:27], a[104:107]
    ds_read_b64_tr_b16 a[176:177], v8 offset:12288
    ds_read_b64_tr_b16 a[178:179], v8 offset:14336
    v_mfma_f32_16x16x32_bf16 a[108:111], a[52:55], a[24:27], a[108:111]
    ds_read_b64_tr_b16 a[180:181], v9 offset:12288
    v_mfma_f32_16x16x32_bf16 a[112:115], a[56:59], a[24:27], a[112:115]
    ds_read_b64_tr_b16 a[182:183], v9 offset:14336
    v_mfma_f32_16x16x32_bf16 a[116:119], a[60:63], a[24:27], a[116:119]
    v_mfma_f32_16x16x32_bf16 a[120:123], a[48:51], a[28:31], a[120:123]
    s_waitcnt lgkmcnt(0)
    s_add_u32 m0, s29, 12288
    s_mov_b32 s33, 86144
    buffer_load_dwordx4 v172, s[20:23], s33 offen lds
    v_mfma_f32_16x16x32_bf16 a[124:127], a[52:55], a[28:31], a[124:127]
    buffer_load_dwordx4 v173, s[20:23], s33 offen offset:1024 lds
    v_mfma_f32_16x16x32_bf16 a[128:131], a[56:59], a[28:31], a[128:131]
    buffer_load_dwordx4 v174, s[20:23], s33 offen offset:2048 lds
    v_mfma_f32_16x16x32_bf16 a[132:135], a[60:63], a[28:31], a[132:135]
    buffer_load_dwordx4 v175, s[20:23], s33 offen offset:3072 lds
    v_mul_f32 v80, v80, v155
    v_mul_f32 v81, v81, v155
    v_mul_f32 v82, v82, v155
    v_mul_f32 v83, v83, v155
    v_mul_f32 v84, v84, v155
    v_mul_f32 v85, v85, v155
    v_mul_f32 v86, v86, v155
    v_mul_f32 v87, v87, v155
    v_cvt_pk_bf16_f32 v80, v80, v81
    v_cvt_pk_bf16_f32 v81, v82, v83
    v_cvt_pk_bf16_f32 v82, v84, v85
    v_cvt_pk_bf16_f32 v83, v86, v87
    ds_write_b128 v17, v[80:83] offset:24576
    v_mul_f32 v88, v88, v155
    v_mul_f32 v89, v89, v155
    v_mul_f32 v90, v90, v155
    v_mul_f32 v91, v91, v155
    v_mul_f32 v92, v92, v155
    v_mul_f32 v93, v93, v155
    v_mul_f32 v94, v94, v155
    v_mul_f32 v95, v95, v155
    v_cvt_pk_bf16_f32 v88, v88, v89
    v_cvt_pk_bf16_f32 v89, v90, v91
    v_cvt_pk_bf16_f32 v90, v92, v93
    v_cvt_pk_bf16_f32 v91, v94, v95
    ds_write_b128 v17, v[88:91] offset:25600
    v_mul_f32 v96, v96, v156
    v_mul_f32 v97, v97, v156
    v_mul_f32 v98, v98, v156
    v_mul_f32 v99, v99, v156
    v_mul_f32 v100, v100, v156
    v_mul_f32 v101, v101, v156
    v_mul_f32 v102, v102, v156
    v_mul_f32 v103, v103, v156
    v_cvt_pk_bf16_f32 v96, v96, v97
    v_cvt_pk_bf16_f32 v97, v98, v99
    v_cvt_pk_bf16_f32 v98, v100, v101
    v_cvt_pk_bf16_f32 v99, v102, v103
    ds_write_b128 v17, v[96:99] offset:32768
    v_mul_f32 v104, v104, v156
    v_mul_f32 v105, v105, v156
    v_mul_f32 v106, v106, v156
    v_mul_f32 v107, v107, v156
    v_mul_f32 v108, v108, v156
    v_mul_f32 v109, v109, v156
    v_mul_f32 v110, v110, v156
    v_mul_f32 v111, v111, v156
    v_cvt_pk_bf16_f32 v104, v104, v105
    v_cvt_pk_bf16_f32 v105, v106, v107
    v_cvt_pk_bf16_f32 v106, v108, v109
    v_cvt_pk_bf16_f32 v107, v110, v111
    ds_write_b128 v17, v[104:107] offset:33792
    s_memrealtime s[92:93]
    s_waitcnt lgkmcnt(0)
    s_barrier
    s_mov_b32 s35, 0x7ff00000
    ds_read_b128 a[0:3], v2
    ds_read_b128 a[4:7], v2 offset:1024
    ds_read_b128 a[8:11], v2 offset:2048
    ds_read_b128 a[12:15], v2 offset:3072
    ds_read_b128 a[16:19], v2 offset:4096
    ds_read_b128 a[20:23], v2 offset:8192
    ds_read_b128 a[24:27], v2 offset:9216
    ds_read_b128 a[28:31], v2 offset:10240
    s_waitcnt lgkmcnt(4)
    v_mfma_f32_16x16x32_bf16 v[32:35], a[208:211], a[0:3], 0
    v_mul_f32 v112, v112, v157
    v_mul_f32 v113, v113, v157
    v_mul_f32 v114, v114, v157
    v_mfma_f32_16x16x32_bf16 v[36:39], a[212:215], a[0:3], 0
    v_mul_f32 v115, v115, v157
    v_mul_f32 v116, v116, v157
    v_mul_f32 v117, v117, v157
    v_mfma_f32_16x16x32_bf16 v[40:43], a[216:219], a[0:3], 0
    v_mul_f32 v118, v118, v157
    v_mul_f32 v119, v119, v157
    v_cvt_pk_bf16_f32 v112, v112, v113
    v_cvt_pk_bf16_f32 v113, v114, v115
    v_mfma_f32_16x16x32_bf16 v[44:47], a[220:223], a[0:3], 0
    v_cvt_pk_bf16_f32 v114, v116, v117
    v_cvt_pk_bf16_f32 v115, v118, v119
    ds_read_b128 a[0:3], v2 offset:11264
    v_mfma_f32_16x16x32_bf16 v[32:35], a[224:227], a[4:7], v[32:35]
    ds_write_b128 v31, v[112:115]
    v_mul_f32 v120, v120, v157
    v_mfma_f32_16x16x32_bf16 v[36:39], a[228:231], a[4:7], v[36:39]
    v_mul_f32 v121, v121, v157
    v_mul_f32 v122, v122, v157
    v_mul_f32 v123, v123, v157
    v_mfma_f32_16x16x32_bf16 v[40:43], a[232:235], a[4:7], v[40:43]
    v_mul_f32 v124, v124, v157
    v_mul_f32 v125, v125, v157
    v_mul_f32 v126, v126, v157
    v_mfma_f32_16x16x32_bf16 v[44:47], a[236:239], a[4:7], v[44:47]
    v_mul_f32 v127, v127, v157
    v_cvt_pk_bf16_f32 v120, v120, v121
    ds_read_b128 a[4:7], v2 offset:12288
    v_mfma_f32_16x16x32_bf16 v[32:35], v[224:227], a[8:11], v[32:35]
    s_waitcnt vmcnt(12)
    ds_read_b64_tr_b16 a[32:33], v6
    ds_read_b64_tr_b16 a[34:35], v6 offset:2048
    v_mfma_f32_16x16x32_bf16 v[36:39], v[228:231], a[8:11], v[36:39]
    ds_read_b64_tr_b16 a[36:37], v7
    ds_read_b64_tr_b16 a[38:39], v7 offset:2048
    ds_read_b64_tr_b16 a[40:41], v8
    v_mfma_f32_16x16x32_bf16 v[40:43], v[232:235], a[8:11], v[40:43]
    ds_read_b64_tr_b16 a[42:43], v8 offset:2048
    v_cvt_pk_bf16_f32 v121, v122, v123
    v_cvt_pk_bf16_f32 v122, v124, v125
    v_mfma_f32_16x16x32_bf16 v[44:47], v[236:239], a[8:11], v[44:47]
    v_cvt_pk_bf16_f32 v123, v126, v127
    ds_read_b128 a[8:11], v2 offset:5120
    v_mfma_f32_16x16x32_bf16 v[32:35], v[240:243], a[12:15], v[32:35]
    ds_write_b128 v31, v[120:123] offset:1024
    v_mul_f32 v128, v128, v158
    v_mul_f32 v129, v129, v158
    v_mfma_f32_16x16x32_bf16 v[36:39], v[244:247], a[12:15], v[36:39]
    v_mul_f32 v130, v130, v158
    v_mul_f32 v131, v131, v158
    v_mul_f32 v132, v132, v158
    v_mfma_f32_16x16x32_bf16 v[40:43], v[248:251], a[12:15], v[40:43]
    v_mul_f32 v133, v133, v158
    v_mul_f32 v134, v134, v158
    v_mul_f32 v135, v135, v158
    v_mfma_f32_16x16x32_bf16 v[44:47], v[252:255], a[12:15], v[44:47]
    v_cvt_pk_bf16_f32 v128, v128, v129
    ds_read_b128 a[12:15], v2 offset:6144
    s_waitcnt lgkmcnt(12)
    v_mfma_f32_16x16x32_bf16 v[32:35], v[176:179], a[16:19], v[32:35]
    v_cvt_pk_bf16_f32 v129, v130, v131
    v_cvt_pk_bf16_f32 v130, v132, v133
    v_cvt_pk_bf16_f32 v131, v134, v135
    v_mfma_f32_16x16x32_bf16 v[36:39], v[180:183], a[16:19], v[36:39]
    ds_write_b128 v31, v[128:131] offset:8192
    v_mul_f32 v136, v136, v158
    v_mul_f32 v137, v137, v158
    v_mfma_f32_16x16x32_bf16 v[40:43], v[184:187], a[16:19], v[40:43]
    v_mul_f32 v138, v138, v158
    v_mul_f32 v139, v139, v158
    v_mul_f32 v140, v140, v158
    v_mfma_f32_16x16x32_bf16 v[44:47], v[188:191], a[16:19], v[44:47]
    v_mul_f32 v141, v141, v158
    v_mul_f32 v142, v142, v158
    ds_read_b128 a[16:19], v2 offset:7168
    v_mfma_f32_16x16x32_bf16 v[48:51], a[208:211], a[20:23], 0
    v_mul_f32 v143, v143, v158
    v_cvt_pk_bf16_f32 v136, v136, v137
    v_cvt_pk_bf16_f32 v137, v138, v139
    v_mfma_f32_16x16x32_bf16 v[52:55], a[212:215], a[20:23], 0
    v_cvt_pk_bf16_f32 v138, v140, v141
    v_cvt_pk_bf16_f32 v139, v142, v143
    v_mfma_f32_16x16x32_bf16 v[56:59], a[216:219], a[20:23], 0
    s_waitcnt lgkmcnt(5)
    s_add_u32 m0, s29, 0
    s_mov_b32 s33, 114816
    buffer_load_dwordx4 v172, s[20:23], s33 offen lds
    v_mfma_f32_16x16x32_bf16 v[60:63], a[220:223], a[20:23], 0
    ds_read_b128 a[20:23], v2 offset:13312
    v_mfma_f32_16x16x32_bf16 v[48:51], a[224:227], a[24:27], v[48:51]
    buffer_load_dwordx4 v173, s[20:23], s33 offen offset:1024 lds
    v_mfma_f32_16x16x32_bf16 v[52:55], a[228:231], a[24:27], v[52:55]
    s_waitcnt vmcnt(10)
    ds_read_b64_tr_b16 a[48:49], v6 offset:4096
    v_mfma_f32_16x16x32_bf16 v[56:59], a[232:235], a[24:27], v[56:59]
    buffer_load_dwordx4 v174, s[20:23], s33 offen offset:2048 lds
    v_mfma_f32_16x16x32_bf16 v[60:63], a[236:239], a[24:27], v[60:63]
    ds_read_b128 a[24:27], v2 offset:14336
    v_mfma_f32_16x16x32_bf16 v[48:51], v[224:227], a[28:31], v[48:51]
    buffer_load_dwordx4 v175, s[20:23], s33 offen offset:3072 lds
    v_mfma_f32_16x16x32_bf16 v[52:55], v[228:231], a[28:31], v[52:55]
    ds_read_b64_tr_b16 a[50:51], v6 offset:6144
    v_mfma_f32_16x16x32_bf16 v[56:59], v[232:235], a[28:31], v[56:59]
    ds_read_b64_tr_b16 a[52:53], v7 offset:4096
    ds_read_b64_tr_b16 a[54:55], v7 offset:6144
    ds_read_b64_tr_b16 a[56:57], v8 offset:4096
    v_mfma_f32_16x16x32_bf16 v[60:63], v[236:239], a[28:31], v[60:63]
    ds_read_b64_tr_b16 a[58:59], v8 offset:6144
    ds_read_b128 a[28:31], v2 offset:15360
    s_waitcnt lgkmcnt(11)
    v_mfma_f32_16x16x32_bf16 v[48:51], v[240:243], a[0:3], v[48:51]
    ds_write_b128 v31, v[136:139] offset:9216
    v_mul_f32 v144, v144, v159
    v_mfma_f32_16x16x32_bf16 v[52:55], v[244:247], a[0:3], v[52:55]
    v_mul_f32 v145, v145, v159
    v_mul_f32 v146, v146, v159
    v_mul_f32 v147, v147, v159
    v_mfma_f32_16x16x32_bf16 v[56:59], v[248:251], a[0:3], v[56:59]
    v_mul_f32 v148, v148, v159
    v_mul_f32 v149, v149, v159
    v_mul_f32 v150, v150, v159
    v_mfma_f32_16x16x32_bf16 v[60:63], v[252:255], a[0:3], v[60:63]
    v_mul_f32 v151, v151, v159
    v_cvt_pk_bf16_f32 v144, v144, v145
    ds_read_b128 a[0:3], v2 offset:16384
    v_mfma_f32_16x16x32_bf16 v[48:51], v[176:179], a[4:7], v[48:51]
    v_cvt_pk_bf16_f32 v145, v146, v147
    v_cvt_pk_bf16_f32 v146, v148, v149
    v_cvt_pk_bf16_f32 v147, v150, v151
    v_mfma_f32_16x16x32_bf16 v[52:55], v[180:183], a[4:7], v[52:55]
    ds_write_b128 v31, v[144:147] offset:16384
    v_accvgpr_read_b32 v164, a96
    v_accvgpr_read_b32 v165, a97
    v_mfma_f32_16x16x32_bf16 v[56:59], v[184:187], a[4:7], v[56:59]
    s_waitcnt lgkmcnt(4)
    s_add_u32 m0, s29, 4096
    s_mov_b32 s33, 143488
    buffer_load_dwordx4 v172, s[20:23], s33 offen lds
    v_mfma_f32_16x16x32_bf16 v[60:63], v[188:191], a[4:7], v[60:63]
    ds_read_b128 a[4:7], v2 offset:17408
    v_mfma_f32_16x16x32_bf16 v[32:35], v[192:195], a[8:11], v[32:35]
    buffer_load_dwordx4 v173, s[20:23], s33 offen offset:1024 lds
    v_mfma_f32_16x16x32_bf16 v[36:39], v[196:199], a[8:11], v[36:39]
    s_waitcnt vmcnt(10)
    ds_read_b64_tr_b16 a[64:65], v6 offset:8192
    v_mfma_f32_16x16x32_bf16 v[40:43], v[200:203], a[8:11], v[40:43]
    buffer_load_dwordx4 v174, s[20:23], s33 offen offset:2048 lds
    v_mfma_f32_16x16x32_bf16 v[44:47], v[204:207], a[8:11], v[44:47]
    ds_read_b128 a[8:11], v2 offset:18432
    v_mfma_f32_16x16x32_bf16 v[32:35], v[208:211], a[12:15], v[32:35]
    buffer_load_dwordx4 v175, s[20:23], s33 offen offset:3072 lds
    v_mfma_f32_16x16x32_bf16 v[36:39], v[212:215], a[12:15], v[36:39]
    ds_read_b64_tr_b16 a[66:67], v6 offset:10240
    v_mfma_f32_16x16x32_bf16 v[40:43], v[216:219], a[12:15], v[40:43]
    ds_read_b64_tr_b16 a[68:69], v7 offset:8192
    ds_read_b64_tr_b16 a[70:71], v7 offset:10240
    ds_read_b64_tr_b16 a[72:73], v8 offset:8192
    v_mfma_f32_16x16x32_bf16 v[44:47], v[220:223], a[12:15], v[44:47]
    ds_read_b64_tr_b16 a[74:75], v8 offset:10240
    ds_read_b128 a[12:15], v2 offset:19456
    s_waitcnt lgkmcnt(12)
    v_mfma_f32_16x16x32_bf16 v[32:35], a[168:171], a[16:19], v[32:35]
    v_accvgpr_read_b32 v166, a98
    v_accvgpr_read_b32 v167, a99
    v_accvgpr_read_b32 v168, a100
    v_mfma_f32_16x16x32_bf16 v[36:39], a[172:175], a[16:19], v[36:39]
    v_accvgpr_read_b32 v169, a101
    v_accvgpr_read_b32 v170, a102
    v_accvgpr_read_b32 v171, a103
    v_mfma_f32_16x16x32_bf16 v[40:43], a[176:179], a[16:19], v[40:43]
    v_mul_f32 v164, v164, v159
    v_mul_f32 v165, v165, v159
    v_mul_f32 v166, v166, v159
    v_mfma_f32_16x16x32_bf16 v[44:47], a[180:183], a[16:19], v[44:47]
    v_mul_f32 v167, v167, v159
    v_mul_f32 v168, v168, v159
    ds_read_b128 a[16:19], v2 offset:20480
    v_mfma_f32_16x16x32_bf16 v[48:51], v[192:195], a[20:23], v[48:51]
    v_mul_f32 v169, v169, v159
    v_mul_f32 v170, v170, v159
    v_mul_f32 v171, v171, v159
    v_mfma_f32_16x16x32_bf16 v[52:55], v[196:199], a[20:23], v[52:55]
    v_cvt_pk_bf16_f32 v164, v164, v165
    v_cvt_pk_bf16_f32 v165, v166, v167
    v_cvt_pk_bf16_f32 v166, v168, v169
    v_mfma_f32_16x16x32_bf16 v[56:59], v[200:203], a[20:23], v[56:59]
    s_waitcnt lgkmcnt(2)
    s_add_u32 m0, s29, 8192
    s_mov_b32 s33, 172160
    buffer_load_dwordx4 v172, s[20:23], s33 offen lds
    v_mfma_f32_16x16x32_bf16 v[60:63], v[204:207], a[20:23], v[60:63]
    v_cvt_pk_bf16_f32 v64, v32, v33
    v_cvt_pk_bf16_f32 v65, v34, v35
    ds_read_b128 a[20:23], v2 offset:21504
    v_mfma_f32_16x16x32_bf16 v[48:51], v[208:211], a[24:27], v[48:51]
    buffer_load_dwordx4 v173, s[20:23], s33 offen offset:1024 lds
    v_mfma_f32_16x16x32_bf16 v[52:55], v[212:215], a[24:27], v[52:55]
    v_cvt_pk_bf16_f32 v66, v36, v37
    v_cvt_pk_bf16_f32 v67, v38, v39
    v_mfma_f32_16x16x32_bf16 v[56:59], v[216:219], a[24:27], v[56:59]
    buffer_load_dwordx4 v174, s[20:23], s33 offen offset:2048 lds
    v_mfma_f32_16x16x32_bf16 v[60:63], v[220:223], a[24:27], v[60:63]
    ds_read_b128 a[24:27], v2 offset:22528
    v_mfma_f32_16x16x32_bf16 v[48:51], a[168:171], a[28:31], v[48:51]
    buffer_load_dwordx4 v175, s[20:23], s33 offen offset:3072 lds
    v_mfma_f32_16x16x32_bf16 v[52:55], a[172:175], a[28:31], v[52:55]
    s_cmp_eq_u32 s60, 0
    s_cselect_b32 s57, s35, 0
    s_cbranch_scc0 L_keep0
    v_mov_b32 v21, v64
    v_mov_b32 v22, v65
    v_mov_b32 v23, v66
    v_mov_b32 v24, v67
L_keep0:
    buffer_store_dwordx4 v[64:67], v20, s[24:27], s57 offen sc1
    v_cvt_pk_bf16_f32 v68, v40, v41
    v_cvt_pk_bf16_f32 v69, v42, v43
    v_mfma_f32_16x16x32_bf16 v[56:59], a[176:179], a[28:31], v[56:59]
    v_cvt_pk_bf16_f32 v70, v44, v45
    v_cvt_pk_bf16_f32 v71, v46, v47
    s_cmp_eq_u32 s60, 10
    s_cselect_b32 s57, s35, 40960
    s_cbranch_scc0 L_keep10
    v_mov_b32 v21, v68
    v_mov_b32 v22, v69
    v_mov_b32 v23, v70
    v_mov_b32 v24, v71
L_keep10:
    buffer_store_dwordx4 v[68:71], v20, s[24:27], s57 offen sc1
    v_mfma_f32_16x16x32_bf16 v[60:63], a[180:183], a[28:31], v[60:63]
    s_waitcnt vmcnt(14)
    ds_read_b128 a[28:31], v2 offset:23552
    s_waitcnt lgkmcnt(4)
    v_mfma_f32_16x16x32_bf16 v[32:35], a[208:211], a[0:3], 0
    ds_read_b64_tr_b16 a[80:81], v6 offset:12288
    ds_read_b64_tr_b16 a[82:83], v6 offset:14336
    v_mfma_f32_16x16x32_bf16 v[36:39], a[212:215], a[0:3], 0
    ds_read_b64_tr_b16 a[84:85], v7 offset:12288
    ds_read_b64_tr_b16 a[86:87], v7 offset:14336
    ds_read_b64_tr_b16 a[88:89], v8 offset:12288
    v_mfma_f32_16x16x32_bf16 v[40:43], a[216:219], a[0:3], 0
    ds_read_b64_tr_b16 a[90:91], v8 offset:14336
    v_cvt_pk_bf16_f32 v167, v170, v171
    v_mfma_f32_16x16x32_bf16 v[44:47], a[220:223], a[0:3], 0
    v_cvt_pk_bf16_f32 v72, v48, v49
    v_cvt_pk_bf16_f32 v73, v50, v51
    ds_read_b128 a[0:3], v2 offset:24576
    v_mfma_f32_16x16x32_bf16 v[32:35], a[224:227], a[4:7], v[32:35]
    v_cvt_pk_bf16_f32 v74, v52, v53
    v_cvt_pk_bf16_f32 v75, v54, v55
    v_mfma_f32_16x16x32_bf16 v[36:39], a[228:231], a[4:7], v[36:39]
    v_mfma_f32_16x16x32_bf16 v[40:43], a[232:235], a[4:7], v[40:43]
    s_waitcnt lgkmcnt(1)
    s_add_u32 m0, s29, 12288
    s_mov_b32 s33, 200832
    buffer_load_dwordx4 v172, s[20:23], s33 offen lds
    v_mfma_f32_16x16x32_bf16 v[44:47], a[236:239], a[4:7], v[44:47]
    ds_read_b128 a[4:7], v2 offset:25600
    v_mfma_f32_16x16x32_bf16 v[32:35], v[224:227], a[8:11], v[32:35]
    buffer_load_dwordx4 v173, s[20:23], s33 offen offset:1024 lds
    v_mfma_f32_16x16x32_bf16 v[36:39], v[228:231], a[8:11], v[36:39]
    v_mfma_f32_16x16x32_bf16 v[40:43], v[232:235], a[8:11], v[40:43]
    buffer_load_dwordx4 v174, s[20:23], s33 offen offset:2048 lds
    v_mfma_f32_16x16x32_bf16 v[44:47], v[236:239], a[8:11], v[44:47]
    ds_read_b128 a[8:11], v2 offset:26624
    v_mfma_f32_16x16x32_bf16 v[32:35], v[240:243], a[12:15], v[32:35]
    buffer_load_dwordx4 v175, s[20:23], s33 offen offset:3072 lds
    v_mfma_f32_16x16x32_bf16 v[36:39], v[244:247], a[12:15], v[36:39]
    v_mfma_f32_16x16x32_bf16 v[40:43], v[248:251], a[12:15], v[40:43]
    v_mfma_f32_16x16x32_bf16 v[44:47], v[252:255], a[12:15], v[44:47]
    ds_read_b128 a[12:15], v2 offset:27648
    v_mfma_f32_16x16x32_bf16 v[32:35], v[176:179], a[16:19], v[32:35]
    v_mfma_f32_16x16x32_bf16 v[36:39], v[180:183], a[16:19], v[36:39]
    v_mfma_f32_16x16x32_bf16 v[40:43], v[184:187], a[16:19], v[40:43]
    v_mfma_f32_16x16x32_bf16 v[44:47], v[188:191], a[16:19], v[44:47]
    ds_read_b128 a[16:19], v2 offset:28672
    v_mfma_f32_16x16x32_bf16 v[32:35], v[192:195], a[20:23], v[32:35]
    s_cmp_eq_u32 s60, 1
    s_cselect_b32 s57, s35, 4096
    s_cbranch_scc0 L_keep1
    v_mov_b32 v21, v72
    v_mov_b32 v22, v73
    v_mov_b32 v23, v74
    v_mov_b32 v24, v75
L_keep1:
    buffer_store_dwordx4 v[72:75], v20, s[24:27], s57 offen sc1
    v_cvt_pk_bf16_f32 v76, v56, v57
    v_cvt_pk_bf16_f32 v77, v58, v59
    v_mfma_f32_16x16x32_bf16 v[36:39], v[196:199], a[20:23], v[36:39]
    v_cvt_pk_bf16_f32 v78, v60, v61
    v_cvt_pk_bf16_f32 v79, v62, v63
    s_cmp_eq_u32 s60, 11
    s_cselect_b32 s57, s35, 45056
    s_cbranch_scc0 L_keep11
    v_mov_b32 v21, v76
    v_mov_b32 v22, v77
    v_mov_b32 v23, v78
    v_mov_b32 v24, v79
L_keep11:
    buffer_store_dwordx4 v[76:79], v20, s[24:27], s57 offen sc1
    v_mfma_f32_16x16x32_bf16 v[40:43], v[200:203], a[20:23], v[40:43]
    ds_write_b128 v31, v[164:167] offset:17408
    s_nop 1
    v_accvgpr_read_b32 v164, a104
    v_accvgpr_read_b32 v165, a105
    v_mfma_f32_16x16x32_bf16 v[44:47], v[204:207], a[20:23], v[44:47]
    v_accvgpr_read_b32 v166, a106
    ds_read_b128 a[20:23], v2 offset:29696
    v_mfma_f32_16x16x32_bf16 v[32:35], v[208:211], a[24:27], v[32:35]
    v_accvgpr_read_b32 v167, a107
    v_accvgpr_read_b32 v168, a108
    v_accvgpr_read_b32 v169, a109
    v_mfma_f32_16x16x32_bf16 v[36:39], v[212:215], a[24:27], v[36:39]
    v_accvgpr_read_b32 v170, a110
    v_accvgpr_read_b32 v171, a111
    v_mul_f32 v164, v164, v160
    v_mfma_f32_16x16x32_bf16 v[40:43], v[216:219], a[24:27], v[40:43]
    v_mul_f32 v165, v165, v160
    v_mul_f32 v166, v166, v160
    v_mul_f32 v167, v167, v160
    v_mfma_f32_16x16x32_bf16 v[44:47], v[220:223], a[24:27], v[44:47]
    v_mul_f32 v168, v168, v160
    v_mul_f32 v169, v169, v160
    ds_read_b128 a[24:27], v2 offset:30720
    v_mfma_f32_16x16x32_bf16 v[32:35], a[168:171], a[28:31], v[32:35]
    v_mul_f32 v170, v170, v160
    v_mul_f32 v171, v171, v160
    v_cvt_pk_bf16_f32 v164, v164, v165
    v_mfma_f32_16x16x32_bf16 v[36:39], a[172:175], a[28:31], v[36:39]
    v_cvt_pk_bf16_f32 v165, v166, v167
    v_cvt_pk_bf16_f32 v166, v168, v169
    v_cvt_pk_bf16_f32 v167, v170, v171
    v_mfma_f32_16x16x32_bf16 v[40:43], a[176:179], a[28:31], v[40:43]
    ds_write_b128 v31, v[164:167] offset:24576
    s_nop 1
    v_accvgpr_read_b32 v164, a112
    v_mfma_f32_16x16x32_bf16 v[44:47], a[180:183], a[28:31], v[44:47]
    v_accvgpr_read_b32 v165, a113
    ds_read_b128 a[28:31], v2 offset:31744
    s_waitcnt lgkmcnt(6)
    v_mfma_f32_16x16x32_bf16 v[48:51], a[208:211], a[0:3], 0
    v_accvgpr_read_b32 v166, a114
    v_accvgpr_read_b32 v167, a115
    v_accvgpr_read_b32 v168, a116
    v_mfma_f32_16x16x32_bf16 v[52:55], a[212:215], a[0:3], 0
    v_accvgpr_read_b32 v169, a117
    v_accvgpr_read_b32 v170, a118
    v_accvgpr_read_b32 v171, a119
    v_mfma_f32_16x16x32_bf16 v[56:59], a[216:219], a[0:3], 0
    v_mul_f32 v164, v164, v160
    v_mul_f32 v165, v165, v160
    v_mul_f32 v166, v166, v160
    v_mfma_f32_16x16x32_bf16 v[60:63], a[220:223], a[0:3], 0
    v_mul_f32 v167, v167, v160
    v_mul_f32 v168, v168, v160
    ds_read_b128 a[0:3], v2 offset:32768
    v_mfma_f32_16x16x32_bf16 v[48:51], a[224:227], a[4:7], v[48:51]
    v_mul_f32 v169, v169, v160
    v_mul_f32 v170, v170, v160
    v_mul_f32 v171, v171, v160
    v_mfma_f32_16x16x32_bf16 v[52:55], a[228:231], a[4:7], v[52:55]
    v_cvt_pk_bf16_f32 v164, v164, v165
    v_cvt_pk_bf16_f32 v165, v166, v167
    v_cvt_pk_bf16_f32 v166, v168, v169
    v_mfma_f32_16x16x32_bf16 v[56:59], a[232:235], a[4:7], v[56:59]
    v_cvt_pk_bf16_f32 v167, v170, v171
    ds_write_b128 v31, v[164:167] offset:25600
    v_mfma_f32_16x16x32_bf16 v[60:63], a[236:239], a[4:7], v[60:63]
    s_nop 0
    v_accvgpr_read_b32 v164, a120
    v_accvgpr_read_b32 v165, a121
    ds_read_b128 a[4:7], v2 offset:33792
    v_mfma_f32_16x16x32_bf16 v[48:51], v[224:227], a[8:11], v[48:51]
    v_cvt_pk_bf16_f32 v64, v32, v33
    v_accvgpr_read_b32 v166, a122
    v_cvt_pk_bf16_f32 v65, v34, v35
    v_mfma_f32_16x16x32_bf16 v[52:55], v[228:231], a[8:11], v[52:55]
    v_accvgpr_read_b32 v167, a123
    v_cvt_pk_bf16_f32 v66, v36, v37
    v_accvgpr_read_b32 v168, a124
    v_mfma_f32_16x16x32_bf16 v[56:59], v[232:235], a[8:11], v[56:59]
    v_cvt_pk_bf16_f32 v67, v38, v39
    v_accvgpr_read_b32 v169, a125
    v_mfma_f32_16x16x32_bf16 v[60:63], v[236:239], a[8:11], v[60:63]
    ds_read_b128 a[8:11], v2 offset:34816
    v_mfma_f32_16x16x32_bf16 v[48:51], v[240:243], a[12:15], v[48:51]
    v_mfma_f32_16x16x32_bf16 v[52:55], v[244:247], a[12:15], v[52:55]
    v_mfma_f32_16x16x32_bf16 v[56:59], v[248:251], a[12:15], v[56:59]
    v_mfma_f32_16x16x32_bf16 v[60:63], v[252:255], a[12:15], v[60:63]
    ds_read_b128 a[12:15], v2 offset:35840
    s_waitcnt lgkmcnt(5)
    v_mfma_f32_16x16x32_bf16 v[48:51], v[176:179], a[16:19], v[48:51]
    v_mfma_f32_16x16x32_bf16 v[52:55], v[180:183], a[16:19], v[52:55]
    v_mfma_f32_16x16x32_bf16 v[56:59], v[184:187], a[16:19], v[56:59]
    v_mfma_f32_16x16x32_bf16 v[60:63], v[188:191], a[16:19], v[60:63]
    ds_read_b128 a[16:19], v2 offset:36864
    v_mfma_f32_16x16x32_bf16 v[48:51], v[192:195], a[20:23], v[48:51]
    s_cmp_eq_u32 s60, 2
    s_cselect_b32 s57, s35, 8192
    s_cbranch_scc0 L_keep2
    v_mov_b32 v21, v64
    v_mov_b32 v22, v65
    v_mov_b32 v23, v66
    v_mov_b32 v24, v67
L_keep2:
    buffer_store_dwordx4 v[64:67], v20, s[24:27], s57 offen sc1
    v_cvt_pk_bf16_f32 v68, v40, v41
    v_cvt_pk_bf16_f32 v69, v42, v43
    v_mfma_f32_16x16x32_bf16 v[52:55], v[196:199], a[20:23], v[52:55]
    v_cvt_pk_bf16_f32 v70, v44, v45
    v_cvt_pk_bf16_f32 v71, v46, v47
    s_cmp_eq_u32 s60, 12
    s_cselect_b32 s57, s35, 49152
    s_cbranch_scc0 L_keep12
    v_mov_b32 v21, v68
    v_mov_b32 v22, v69
    v_mov_b32 v23, v70
    v_mov_b32 v24, v71
L_keep12:
    buffer_store_dwordx4 v[68:71], v20, s[24:27], s57 offen sc1
    v_mfma_f32_16x16x32_bf16 v[56:59], v[200:203], a[20:23], v[56:59]
    v_accvgpr_read_b32 v170, a126
    v_accvgpr_read_b32 v171, a127
    v_mul_f32 v164, v164, v161
    v_mul_f32 v165, v165, v161
    v_mul_f32 v166, v166, v161
    v_mfma_f32_16x16x32_bf16 v[60:63], v[204:207], a[20:23], v[60:63]
    v_mul_f32 v167, v167, v161
    v_mul_f32 v168, v168, v161
    v_mul_f32 v169, v169, v161
    ds_read_b128 a[20:23], v2 offset:37888
    v_mfma_f32_16x16x32_bf16 v[48:51], v[208:211], a[24:27], v[48:51]
    v_mul_f32 v170, v170, v161
    v_mul_f32 v171, v171, v161
    v_cvt_pk_bf16_f32 v164, v164, v165
    v_cvt_pk_bf16_f32 v165, v166, v167
    v_cvt_pk_bf16_f32 v166, v168, v169
    v_mfma_f32_16x16x32_bf16 v[52:55], v[212:215], a[24:27], v[52:55]
    v_cvt_pk_bf16_f32 v167, v170, v171
    ds_write_b128 v31, v[164:167] offset:32768
    s_nop 1
    v_accvgpr_read_b32 v164, a128
    v_mfma_f32_16x16x32_bf16 v[56:59], v[216:219], a[24:27], v[56:59]
    v_accvgpr_read_b32 v165, a129
    v_accvgpr_read_b32 v166, a130
    v_accvgpr_read_b32 v167, a131
    v_accvgpr_read_b32 v168, a132
    v_mfma_f32_16x16x32_bf16 v[60:63], v[220:223], a[24:27], v[60:63]
    v_accvgpr_read_b32 v169, a133
    v_accvgpr_read_b32 v170, a134
    v_accvgpr_read_b32 v171, a135
    v_mul_f32 v164, v164, v161
    ds_read_b128 a[24:27], v2 offset:38912
    v_mfma_f32_16x16x32_bf16 v[48:51], a[168:171], a[28:31], v[48:51]
    v_mul_f32 v165, v165, v161
    v_mul_f32 v166, v166, v161
    v_mul_f32 v167, v167, v161
    v_mul_f32 v168, v168, v161
    v_mfma_f32_16x16x32_bf16 v[52:55], a[172:175], a[28:31], v[52:55]
    v_mul_f32 v169, v169, v161
    v_mul_f32 v170, v170, v161
    v_mul_f32 v171, v171, v161
    v_cvt_pk_bf16_f32 v164, v164, v165
    v_cvt_pk_bf16_f32 v165, v166, v167
    v_mfma_f32_16x16x32_bf16 v[56:59], a[176:179], a[28:31], v[56:59]
    v_cvt_pk_bf16_f32 v166, v168, v169
    v_cvt_pk_bf16_f32 v167, v170, v171
    ds_write_b128 v31, v[164:167] offset:33792
    v_mfma_f32_16x16x32_bf16 v[60:63], a[180:183], a[28:31], v[60:63]
    s_waitcnt lgkmcnt(0)
    s_barrier
    ds_read_b128 a[28:31], v2 offset:39936
    v_mfma_f32_16x16x32_bf16 v[32:35], a[208:211], a[0:3], 0
    v_mfma_f32_16x16x32_bf16 v[36:39], a[212:215], a[0:3], 0
    v_mfma_f32_16x16x32_bf16 v[40:43], a[216:219], a[0:3], 0
    v_mfma_f32_16x16x32_bf16 v[44:47], a[220:223], a[0:3], 0
    v_cvt_pk_bf16_f32 v72, v48, v49
    ds_read_b128 a[0:3], v3
    v_mfma_f32_16x16x32_bf16 v[32:35], a[224:227], a[4:7], v[32:35]
    v_cvt_pk_bf16_f32 v73, v50, v51
    v_cvt_pk_bf16_f32 v74, v52, v53
    v_mfma_f32_16x16x32_bf16 v[36:39], a[228:231], a[4:7], v[36:39]
    v_cvt_pk_bf16_f32 v75, v54, v55
    v_mfma_f32_16x16x32_bf16 v[40:43], a[232:235], a[4:7], v[40:43]
    v_mfma_f32_16x16x32_bf16 v[44:47], a[236:239], a[4:7], v[44:47]
    ds_read_b128 a[4:7], v3 offset:1024
    v_mfma_f32_16x16x32_bf16 v[32:35], v[224:227], a[8:11], v[32:35]
    v_mfma_f32_16x16x32_bf16 v[36:39], v[228:231], a[8:11], v[36:39]
    v_mfma_f32_16x16x32_bf16 v[40:43], v[232:235], a[8:11], v[40:43]
    v_mfma_f32_16x16x32_bf16 v[44:47], v[236:239], a[8:11], v[44:47]
    ds_read_b128 a[8:11], v3 offset:2048
    v_mfma_f32_16x16x32_bf16 v[32:35], v[240:243], a[12:15], v[32:35]
    v_mfma_f32_16x16x32_bf16 v[36:39], v[244:247], a[12:15], v[36:39]
    v_mfma_f32_16x16x32_bf16 v[40:43], v[248:251], a[12:15], v[40:43]
    v_mfma_f32_16x16x32_bf16 v[44:47], v[252:255], a[12:15], v[44:47]
    ds_read_b128 a[12:15], v3 offset:3072
    s_waitcnt lgkmcnt(4)
    v_mfma_f32_16x16x32_bf16 v[32:35], v[176:179], a[16:19], v[32:35]
    v_mfma_f32_16x16x32_bf16 v[36:39], v[180:183], a[16:19], v[36:39]
    v_mfma_f32_16x16x32_bf16 v[40:43], v[184:187], a[16:19], v[40:43]
    v_mfma_f32_16x16x32_bf16 v[44:47], v[188:191], a[16:19], v[44:47]
    ds_read_b128 a[16:19], v3 offset:4096
    v_mfma_f32_16x16x32_bf16 v[32:35], v[192:195], a[20:23], v[32:35]
    s_cmp_eq_u32 s60, 3
    s_cselect_b32 s57, s35, 12288
    s_cbranch_scc0 L_keep3
    v_mov_b32 v21, v72
    v_mov_b32 v22, v73
    v_mov_b32 v23, v74
    v_mov_b32 v24, v75
L_keep3:
    buffer_store_dwordx4 v[72:75], v20, s[24:27], s57 offen sc1
    v_cvt_pk_bf16_f32 v76, v56, v57
    v_cvt_pk_bf16_f32 v77, v58, v59
    v_mfma_f32_16x16x32_bf16 v[36:39], v[196:199], a[20:23], v[36:39]
    v_cvt_pk_bf16_f32 v78, v60, v61
    v_cvt_pk_bf16_f32 v79, v62, v63
    s_cmp_eq_u32 s60, 13
    s_cselect_b32 s57, s35, 53248
    s_cbranch_scc0 L_keep13
    v_mov_b32 v21, v76
    v_mov_b32 v22, v77
    v_mov_b32 v23, v78
    v_mov_b32 v24, v79
L_keep13:
    buffer_store_dwordx4 v[76:79], v20, s[24:27], s57 offen sc1
    v_mfma_f32_16x16x32_bf16 v[40:43], v[200:203], a[20:23], v[40:43]
    v_mfma_f32_16x16x32_bf16 v[44:47], v[204:207], a[20:23], v[44:47]
    ds_read_b128 a[20:23], v3 offset:5120
    v_mfma_f32_16x16x32_bf16 v[32:35], v[208:211], a[24:27], v[32:35]
    v_mfma_f32_16x16x32_bf16 v[36:39], v[212:215], a[24:27], v[36:39]
    v_mfma_f32_16x16x32_bf16 v[40:43], v[216:219], a[24:27], v[40:43]
    v_mfma_f32_16x16x32_bf16 v[44:47], v[220:223], a[24:27], v[44:47]
    ds_read_b128 a[24:27], v3 offset:6144
    v_mfma_f32_16x16x32_bf16 v[32:35], a[168:171], a[28:31], v[32:35]
    v_mfma_f32_16x16x32_bf16 v[36:39], a[172:175], a[28:31], v[36:39]
    v_mfma_f32_16x16x32_bf16 v[40:43], a[176:179], a[28:31], v[40:43]
    v_mfma_f32_16x16x32_bf16 v[44:47], a[180:183], a[28:31], v[44:47]
    ds_read_b128 a[28:31], v3 offset:7168
    s_waitcnt lgkmcnt(4)
    v_mfma_f32_16x16x32_bf16 v[48:51], a[208:211], a[0:3], 0
    v_mfma_f32_16x16x32_bf16 v[52:55], a[212:215], a[0:3], 0
    v_mfma_f32_16x16x32_bf16 v[56:59], a[216:219], a[0:3], 0
    v_mfma_f32_16x16x32_bf16 v[60:63], a[220:223], a[0:3], 0
    v_cvt_pk_bf16_f32 v64, v32, v33
    ds_read_b128 a[0:3], v3 offset:8192
    v_mfma_f32_16x16x32_bf16 v[48:51], a[224:227], a[4:7], v[48:51]
    v_cvt_pk_bf16_f32 v65, v34, v35
    v_cvt_pk_bf16_f32 v66, v36, v37
    v_mfma_f32_16x16x32_bf16 v[52:55], a[228:231], a[4:7], v[52:55]
    v_cvt_pk_bf16_f32 v67, v38, v39
    v_mfma_f32_16x16x32_bf16 v[56:59], a[232:235], a[4:7], v[56:59]
    v_mfma_f32_16x16x32_bf16 v[60:63], a[236:239], a[4:7], v[60:63]
    ds_read_b128 a[4:7], v3 offset:9216
    v_mfma_f32_16x16x32_bf16 v[48:51], v[224:227], a[8:11], v[48:51]
    v_mfma_f32_16x16x32_bf16 v[52:55], v[228:231], a[8:11], v[52:55]
    v_mfma_f32_16x16x32_bf16 v[56:59], v[232:235], a[8:11], v[56:59]
    v_mfma_f32_16x16x32_bf16 v[60:63], v[236:239], a[8:11], v[60:63]
    ds_read_b128 a[8:11], v3 offset:10240
    v_mfma_f32_16x16x32_bf16 v[48:51], v[240:243], a[12:15], v[48:51]
    v_mfma_f32_16x16x32_bf16 v[52:55], v[244:247], a[12:15], v[52:55]
    v_mfma_f32_16x16x32_bf16 v[56:59], v[248:251], a[12:15], v[56:59]
    v_mfma_f32_16x16x32_bf16 v[60:63], v[252:255], a[12:15], v[60:63]
    ds_read_b128 a[12:15], v3 offset:11264
    s_waitcnt lgkmcnt(4)
    v_mfma_f32_16x16x32_bf16 v[48:51], v[176:179], a[16:19], v[48:51]
    v_mfma_f32_16x16x32_bf16 v[52:55], v[180:183], a[16:19], v[52:55]
    v_mfma_f32_16x16x32_bf16 v[56:59], v[184:187], a[16:19], v[56:59]
    v_mfma_f32_16x16x32_bf16 v[60:63], v[188:191], a[16:19], v[60:63]
    ds_read_b128 a[16:19], v3 offset:12288
    v_mfma_f32_16x16x32_bf16 v[48:51], v[192:195], a[20:23], v[48:51]
    s_cmp_eq_u32 s60, 4
    s_cselect_b32 s57, s35, 16384
    s_cbranch_scc0 L_keep4
    v_mov_b32 v21, v64
    v_mov_b32 v22, v65
    v_mov_b32 v23, v66
    v_mov_b32 v24, v67
L_keep4:
    buffer_store_dwordx4 v[64:67], v20, s[24:27], s57 offen sc1
    v_cvt_pk_bf16_f32 v68, v40, v41
    v_cvt_pk_bf16_f32 v69, v42, v43
    v_mfma_f32_16x16x32_bf16 v[52:55], v[196:199], a[20:23], v[52:55]
    v_cvt_pk_bf16_f32 v70, v44, v45
    v_cvt_pk_bf16_f32 v71, v46, v47
    s_cmp_eq_u32 s60, 14
    s_cselect_b32 s57, s35, 57344
    s_cbranch_scc0 L_keep14
    v_mov_b32 v21, v68
    v_mov_b32 v22, v69
    v_mov_b32 v23, v70
    v_mov_b32 v24, v71
L_keep14:
    buffer_store_dwordx4 v[68:71], v20, s[24:27], s57 offen sc1
    v_mfma_f32_16x16x32_bf16 v[56:59], v[200:203], a[20:23], v[56:59]
    v_mfma_f32_16x16x32_bf16 v[60:63], v[204:207], a[20:23], v[60:63]
    ds_read_b128 a[20:23], v3 offset:13312
    v_mfma_f32_16x16x32_bf16 v[48:51], v[208:211], a[24:27], v[48:51]
    v_mfma_f32_16x16x32_bf16 v[52:55], v[212:215], a[24:27], v[52:55]
    v_mfma_f32_16x16x32_bf16 v[56:59], v[216:219], a[24:27], v[56:59]
    v_mfma_f32_16x16x32_bf16 v[60:63], v[220:223], a[24:27], v[60:63]
    ds_read_b128 a[24:27], v3 offset:14336
    v_mfma_f32_16x16x32_bf16 v[48:51], a[168:171], a[28:31], v[48:51]
    v_mfma_f32_16x16x32_bf16 v[52:55], a[172:175], a[28:31], v[52:55]
    v_mfma_f32_16x16x32_bf16 v[56:59], a[176:179], a[28:31], v[56:59]
    v_mfma_f32_16x16x32_bf16 v[60:63], a[180:183], a[28:31], v[60:63]
    ds_read_b128 a[28:31], v3 offset:15360
    s_waitcnt lgkmcnt(4)
    v_mfma_f32_16x16x32_bf16 v[32:35], a[208:211], a[0:3], 0
    v_mfma_f32_16x16x32_bf16 v[36:39], a[212:215], a[0:3], 0
    v_mfma_f32_16x16x32_bf16 v[40:43], a[216:219], a[0:3], 0
    v_mfma_f32_16x16x32_bf16 v[44:47], a[220:223], a[0:3], 0
    v_cvt_pk_bf16_f32 v72, v48, v49
    ds_read_b128 a[0:3], v3 offset:16384
    v_mfma_f32_16x16x32_bf16 v[32:35], a[224:227], a[4:7], v[32:35]
    v_cvt_pk_bf16_f32 v73, v50, v51
    v_cvt_pk_bf16_f32 v74, v52, v53
    v_mfma_f32_16x16x32_bf16 v[36:39], a[228:231], a[4:7], v[36:39]
    v_cvt_pk_bf16_f32 v75, v54, v55
    v_mfma_f32_16x16x32_bf16 v[40:43], a[232:235], a[4:7], v[40:43]
    v_mfma_f32_16x16x32_bf16 v[44:47], a[236:239], a[4:7], v[44:47]
    ds_read_b128 a[4:7], v3 offset:17408
    v_mfma_f32_16x16x32_bf16 v[32:35], v[224:227], a[8:11], v[32:35]
    v_mfma_f32_16x16x32_bf16 v[36:39], v[228:231], a[8:11], v[36:39]
    v_mfma_f32_16x16x32_bf16 v[40:43], v[232:235], a[8:11], v[40:43]
    v_mfma_f32_16x16x32_bf16 v[44:47], v[236:239], a[8:11], v[44:47]
    ds_read_b128 a[8:11], v3 offset:18432
    v_mfma_f32_16x16x32_bf16 v[32:35], v[240:243], a[12:15], v[32:35]
    v_mfma_f32_16x16x32_bf16 v[36:39], v[244:247], a[12:15], v[36:39]
    v_mfma_f32_16x16x32_bf16 v[40:43], v[248:251], a[12:15], v[40:43]
    v_mfma_f32_16x16x32_bf16 v[44:47], v[252:255], a[12:15], v[44:47]
    ds_read_b128 a[12:15], v3 offset:19456
    s_waitcnt lgkmcnt(4)
    v_mfma_f32_16x16x32_bf16 v[32:35], v[176:179], a[16:19], v[32:35]
    v_mfma_f32_16x16x32_bf16 v[36:39], v[180:183], a[16:19], v[36:39]
    v_mfma_f32_16x16x32_bf16 v[40:43], v[184:187], a[16:19], v[40:43]
    v_mfma_f32_16x16x32_bf16 v[44:47], v[188:191], a[16:19], v[44:47]
    ds_read_b128 a[16:19], v3 offset:20480
    v_mfma_f32_16x16x32_bf16 v[32:35], v[192:195], a[20:23], v[32:35]
    s_cmp_eq_u32 s60, 5
    s_cselect_b32 s57, s35, 20480
    s_cbranch_scc0 L_keep5
    v_mov_b32 v21, v72
    v_mov_b32 v22, v73
    v_mov_b32 v23, v74
    v_mov_b32 v24, v75
L_keep5:
    buffer_store_dwordx4 v[72:75], v20, s[24:27], s57 offen sc1
    v_cvt_pk_bf16_f32 v76, v56, v57
    v_cvt_pk_bf16_f32 v77, v58, v59
    v_mfma_f32_16x16x32_bf16 v[36:39], v[196:199], a[20:23], v[36:39]
    v_cvt_pk_bf16_f32 v78, v60, v61
    v_cvt_pk_bf16_f32 v79, v62, v63
    s_cmp_eq_u32 s60, 15
    s_cselect_b32 s57, s35, 61440
    s_cbranch_scc0 L_keep15
    v_mov_b32 v21, v76
    v_mov_b32 v22, v77
    v_mov_b32 v23, v78
    v_mov_b32 v24, v79
L_keep15:
    buffer_store_dwordx4 v[76:79], v20, s[24:27], s57 offen sc1
    v_mfma_f32_16x16x32_bf16 v[40:43], v[200:203], a[20:23], v[40:43]
    v_mfma_f32_16x16x32_bf16 v[44:47], v[204:207], a[20:23], v[44:47]
    ds_read_b128 a[20:23], v3 offset:21504
    v_mfma_f32_16x16x32_bf16 v[32:35], v[208:211], a[24:27], v[32:35]
    v_mfma_f32_16x16x32_bf16 v[36:39], v[212:215], a[24:27], v[36:39]
    v_mfma_f32_16x16x32_bf16 v[40:43], v[216:219], a[24:27], v[40:43]
    v_mfma_f32_16x16x32_bf16 v[44:47], v[220:223], a[24:27], v[44:47]
    ds_read_b128 a[24:27], v3 offset:22528
    v_mfma_f32_16x16x32_bf16 v[32:35], a[168:171], a[28:31], v[32:35]
    v_mfma_f32_16x16x32_bf16 v[36:39], a[172:175], a[28:31], v[36:39]
    v_mfma_f32_16x16x32_bf16 v[40:43], a[176:179], a[28:31], v[40:43]
    v_mfma_f32_16x16x32_bf16 v[44:47], a[180:183], a[28:31], v[44:47]
    ds_read_b128 a[28:31], v3 offset:23552
    s_waitcnt lgkmcnt(4)
    v_mfma_f32_16x16x32_bf16 v[48:51], a[208:211], a[0:3], 0
    v_mfma_f32_16x16x32_bf16 v[52:55], a[212:215], a[0:3], 0
    v_mfma_f32_16x16x32_bf16 v[56:59], a[216:219], a[0:3], 0
    v_mfma_f32_16x16x32_bf16 v[60:63], a[220:223], a[0:3], 0
    v_cvt_pk_bf16_f32 v64, v32, v33
    ds_read_b128 a[0:3], v3 offset:24576
    v_mfma_f32_16x16x32_bf16 v[48:51], a[224:227], a[4:7], v[48:51]
    v_cvt_pk_bf16_f32 v65, v34, v35
    v_cvt_pk_bf16_f32 v66, v36, v37
    v_mfma_f32_16x16x32_bf16 v[52:55], a[228:231], a[4:7], v[52:55]
    v_cvt_pk_bf16_f32 v67, v38, v39
    v_mfma_f32_16x16x32_bf16 v[56:59], a[232:235], a[4:7], v[56:59]
    v_mfma_f32_16x16x32_bf16 v[60:63], a[236:239], a[4:7], v[60:63]
    ds_read_b128 a[4:7], v3 offset:25600
    v_mfma_f32_16x16x32_bf16 v[48:51], v[224:227], a[8:11], v[48:51]
    v_mfma_f32_16x16x32_bf16 v[52:55], v[228:231], a[8:11], v[52:55]
    v_mfma_f32_16x16x32_bf16 v[56:59], v[232:235], a[8:11], v[56:59]
    v_mfma_f32_16x16x32_bf16 v[60:63], v[236:239], a[8:11], v[60:63]
    ds_read_b128 a[8:11], v3 offset:26624
    v_mfma_f32_16x16x32_bf16 v[48:51], v[240:243], a[12:15], v[48:51]
    v_mfma_f32_16x16x32_bf16 v[52:55], v[244:247], a[12:15], v[52:55]
    v_mfma_f32_16x16x32_bf16 v[56:59], v[248:251], a[12:15], v[56:59]
    v_mfma_f32_16x16x32_bf16 v[60:63], v[252:255], a[12:15], v[60:63]
    ds_read_b128 a[12:15], v3 offset:27648
    s_waitcnt lgkmcnt(4)
    v_mfma_f32_16x16x32_bf16 v[48:51], v[176:179], a[16:19], v[48:51]
    v_mfma_f32_16x16x32_bf16 v[52:55], v[180:183], a[16:19], v[52:55]
    v_mfma_f32_16x16x32_bf16 v[56:59], v[184:187], a[16:19], v[56:59]
    v_mfma_f32_16x16x32_bf16 v[60:63], v[188:191], a[16:19], v[60:63]
    ds_read_b128 a[16:19], v3 offset:28672
    v_mfma_f32_16x16x32_bf16 v[48:51], v[192:195], a[20:23], v[48:51]
    s_cmp_eq_u32 s60, 6
    s_cselect_b32 s57, s35, 24576
    s_cbranch_scc0 L_keep6
    v_mov_b32 v21, v64
    v_mov_b32 v22, v65
    v_mov_b32 v23, v66
    v_mov_b32 v24, v67
L_keep6:
    buffer_store_dwordx4 v[64:67], v20, s[24:27], s57 offen sc1
    v_cvt_pk_bf16_f32 v68, v40, v41
    v_cvt_pk_bf16_f32 v69, v42, v43
    v_mfma_f32_16x16x32_bf16 v[52:55], v[196:199], a[20:23], v[52:55]
    v_cvt_pk_bf16_f32 v70, v44, v45
    v_cvt_pk_bf16_f32 v71, v46, v47
    s_mov_b32 s57, 65536
    buffer_store_dwordx4 v[68:71], v20, s[24:27], s57 offen sc1
    v_mfma_f32_16x16x32_bf16 v[56:59], v[200:203], a[20:23], v[56:59]
    v_mfma_f32_16x16x32_bf16 v[60:63], v[204:207], a[20:23], v[60:63]
    ds_read_b128 a[20:23], v3 offset:29696
    v_mfma_f32_16x16x32_bf16 v[48:51], v[208:211], a[24:27], v[48:51]
    v_mfma_f32_16x16x32_bf16 v[52:55], v[212:215], a[24:27], v[52:55]
    v_mfma_f32_16x16x32_bf16 v[56:59], v[216:219], a[24:27], v[56:59]
    v_mfma_f32_16x16x32_bf16 v[60:63], v[220:223], a[24:27], v[60:63]
    ds_read_b128 a[24:27], v3 offset:30720
    v_mfma_f32_16x16x32_bf16 v[48:51], a[168:171], a[28:31], v[48:51]
    v_mfma_f32_16x16x32_bf16 v[52:55], a[172:175], a[28:31], v[52:55]
    v_mfma_f32_16x16x32_bf16 v[56:59], a[176:179], a[28:31], v[56:59]
    v_mfma_f32_16x16x32_bf16 v[60:63], a[180:183], a[28:31], v[60:63]
    ds_read_b128 a[28:31], v3 offset:31744
    s_waitcnt lgkmcnt(4)
    v_mfma_f32_16x16x32_bf16 v[32:35], a[208:211], a[0:3], 0
    s_waitcnt vmcnt(26)
    ds_read_b64_tr_b16 a[136:137], v6
    v_mfma_f32_16x16x32_bf16 v[36:39], a[212:215], a[0:3], 0
    ds_read_b64_tr_b16 a[138:139], v6 offset:2048
    v_mfma_f32_16x16x32_bf16 v[40:43], a[216:219], a[0:3], 0
    ds_read_b64_tr_b16 a[140:141], v7
    ds_read_b64_tr_b16 a[142:143], v7 offset:2048
    v_mfma_f32_16x16x32_bf16 v[44:47], a[220:223], a[0:3], 0
    v_cvt_pk_bf16_f32 v72, v48, v49
    ds_read_b128 a[0:3], v3 offset:32768
    v_mfma_f32_16x16x32_bf16 v[32:35], a[224:227], a[4:7], v[32:35]
    v_cvt_pk_bf16_f32 v73, v50, v51
    v_cvt_pk_bf16_f32 v74, v52, v53
    v_mfma_f32_16x16x32_bf16 v[36:39], a[228:231], a[4:7], v[36:39]
    v_cvt_pk_bf16_f32 v75, v54, v55
    v_mfma_f32_16x16x32_bf16 v[40:43], a[232:235], a[4:7], v[40:43]
    v_mfma_f32_16x16x32_bf16 v[44:47], a[236:239], a[4:7], v[44:47]
    ds_read_b128 a[4:7], v3 offset:33792
    v_mfma_f32_16x16x32_bf16 v[32:35], v[224:227], a[8:11], v[32:35]
    v_mfma_f32_16x16x32_bf16 v[36:39], v[228:231], a[8:11], v[36:39]
    v_mfma_f32_16x16x32_bf16 v[40:43], v[232:235], a[8:11], v[40:43]
    v_mfma_f32_16x16x32_bf16 v[44:47], v[236:239], a[8:11], v[44:47]
    ds_read_b128 a[8:11], v3 offset:34816
    v_mfma_f32_16x16x32_bf16 v[32:35], v[240:243], a[12:15], v[32:35]
    ds_read_b64_tr_b16 a[144:145], v8
    v_mfma_f32_16x16x32_bf16 v[36:39], v[244:247], a[12:15], v[36:39]
    ds_read_b64_tr_b16 a[146:147], v8 offset:2048
    v_mfma_f32_16x16x32_bf16 v[40:43], v[248:251], a[12:15], v[40:43]
    v_mfma_f32_16x16x32_bf16 v[44:47], v[252:255], a[12:15], v[44:47]
    ds_read_b128 a[12:15], v3 offset:35840
    s_waitcnt lgkmcnt(10)
    v_mfma_f32_16x16x32_bf16 v[32:35], v[176:179], a[16:19], v[32:35]
    v_mfma_f32_16x16x32_bf16 v[36:39], v[180:183], a[16:19], v[36:39]
    v_mfma_f32_16x16x32_bf16 v[40:43], v[184:187], a[16:19], v[40:43]
    v_mfma_f32_16x16x32_bf16 v[44:47], v[188:191], a[16:19], v[44:47]
    ds_read_b128 a[16:19], v3 offset:36864
    v_mfma_f32_16x16x32_bf16 v[32:35], v[192:195], a[20:23], v[32:35]
    s_cmp_eq_u32 s60, 7
    s_cselect_b32 s57, s35, 28672
    s_cbranch_scc0 L_keep7
    v_mov_b32 v21, v72
    v_mov_b32 v22, v73
    v_mov_b32 v23, v74
    v_mov_b32 v24, v75
L_keep7:
    buffer_store_dwordx4 v[72:75], v20, s[24:27], s57 offen sc1
    v_cvt_pk_bf16_f32 v76, v56, v57
    v_cvt_pk_bf16_f32 v77, v58, v59
    v_mfma_f32_16x16x32_bf16 v[36:39], v[196:199], a[20:23], v[36:39]
    v_cvt_pk_bf16_f32 v78, v60, v61
    v_cvt_pk_bf16_f32 v79, v62, v63
    s_mov_b32 s57, 69632
    buffer_store_dwordx4 v[76:79], v20, s[24:27], s57 offen sc1
    v_mfma_f32_16x16x32_bf16 v[40:43], v[200:203], a[20:23], v[40:43]
    s_waitcnt vmcnt(24)
    ds_read_b64_tr_b16 a[152:153], v6 offset:4096
    v_mfma_f32_16x16x32_bf16 v[44:47], v[204:207], a[20:23], v[44:47]
    ds_read_b64_tr_b16 a[154:155], v6 offset:6144
    ds_read_b128 a[20:23], v3 offset:37888
    v_mfma_f32_16x16x32_bf16 v[32:35], v[208:211], a[24:27], v[32:35]
    ds_read_b64_tr_b16 a[156:157], v7 offset:4096
    v_mfma_f32_16x16x32_bf16 v[36:39], v[212:215], a[24:27], v[36:39]
    ds_read_b64_tr_b16 a[158:159], v7 offset:6144
    ds_read_b64_tr_b16 a[160:161], v8 offset:4096
    v_mfma_f32_16x16x32_bf16 v[40:43], v[216:219], a[24:27], v[40:43]
    ds_read_b64_tr_b16 a[162:163], v8 offset:6144
    v_mfma_f32_16x16x32_bf16 v[44:47], v[220:223], a[24:27], v[44:47]
    ds_read_b128 a[24:27], v3 offset:38912
    v_mfma_f32_16x16x32_bf16 v[32:35], a[168:171], a[28:31], v[32:35]
    s_waitcnt vmcnt(20)
    ds_read_b64_tr_b16 a[184:185], v6 offset:8192
    v_mfma_f32_16x16x32_bf16 v[36:39], a[172:175], a[28:31], v[36:39]
    ds_read_b64_tr_b16 a[186:187], v6 offset:10240
    ds_read_b64_tr_b16 a[188:189], v7 offset:8192
    v_mfma_f32_16x16x32_bf16 v[40:43], a[176:179], a[28:31], v[40:43]
    ds_read_b64_tr_b16 a[190:191], v7 offset:10240
    v_mfma_f32_16x16x32_bf16 v[44:47], a[180:183], a[28:31], v[44:47]
    ds_read_b128 a[28:31], v3 offset:39936
    s_waitcnt lgkmcnt(14)
    v_mfma_f32_16x16x32_bf16 v[48:51], a[208:211], a[0:3], 0
    ds_read_b64_tr_b16 a[192:193], v8 offset:8192
    ds_read_b64_tr_b16 a[194:195], v8 offset:10240
    v_mfma_f32_16x16x32_bf16 v[52:55], a[212:215], a[0:3], 0
    v_mfma_f32_16x16x32_bf16 v[56:59], a[216:219], a[0:3], 0
    v_mfma_f32_16x16x32_bf16 v[60:63], a[220:223], a[0:3], 0
    v_cvt_pk_bf16_f32 v64, v32, v33
    ds_read_b128 a[0:3], v2
    v_mfma_f32_16x16x32_bf16 v[48:51], a[224:227], a[4:7], v[48:51]
    v_cvt_pk_bf16_f32 v65, v34, v35
    v_cvt_pk_bf16_f32 v66, v36, v37
    v_mfma_f32_16x16x32_bf16 v[52:55], a[228:231], a[4:7], v[52:55]
    v_cvt_pk_bf16_f32 v67, v38, v39
    v_mfma_f32_16x16x32_bf16 v[56:59], a[232:235], a[4:7], v[56:59]
    v_mfma_f32_16x16x32_bf16 v[60:63], a[236:239], a[4:7], v[60:63]
    ds_read_b128 a[4:7], v2 offset:1024
    v_mfma_f32_16x16x32_bf16 v[48:51], v[224:227], a[8:11], v[48:51]
    v_mfma_f32_16x16x32_bf16 v[52:55], v[228:231], a[8:11], v[52:55]
    v_mfma_f32_16x16x32_bf16 v[56:59], v[232:235], a[8:11], v[56:59]
    v_mfma_f32_16x16x32_bf16 v[60:63], v[236:239], a[8:11], v[60:63]
    ds_read_b128 a[8:11], v2 offset:2048
    v_mfma_f32_16x16x32_bf16 v[48:51], v[240:243], a[12:15], v[48:51]
    v_mfma_f32_16x16x32_bf16 v[52:55], v[244:247], a[12:15], v[52:55]
    v_mfma_f32_16x16x32_bf16 v[56:59], v[248:251], a[12:15], v[56:59]
    v_mfma_f32_16x16x32_bf16 v[60:63], v[252:255], a[12:15], v[60:63]
    ds_read_b128 a[12:15], v2 offset:3072
    s_waitcnt lgkmcnt(6)
    v_mfma_f32_16x16x32_bf16 v[48:51], v[176:179], a[16:19], v[48:51]
    v_mfma_f32_16x16x32_bf16 v[52:55], v[180:183], a[16:19], v[52:55]
    v_mfma_f32_16x16x32_bf16 v[56:59], v[184:187], a[16:19], v[56:59]
    v_mfma_f32_16x16x32_bf16 v[60:63], v[188:191], a[16:19], v[60:63]
    ds_read_b128 a[16:19], v2 offset:4096
    v_mfma_f32_16x16x32_bf16 v[48:51], v[192:195], a[20:23], v[48:51]
    s_cmp_eq_u32 s60, 8
    s_cselect_b32 s57, s35, 32768
    s_cbranch_scc0 L_keep8
    v_mov_b32 v21, v64
    v_mov_b32 v22, v65
    v_mov_b32 v23, v66
    v_mov_b32 v24, v67
L_keep8:
    buffer_store_dwordx4 v[64:67], v20, s[24:27], s57 offen sc1
    v_cvt_pk_bf16_f32 v68, v40, v41
    v_cvt_pk_bf16_f32 v69, v42, v43
    v_mfma_f32_16x16x32_bf16 v[52:55], v[196:199], a[20:23], v[52:55]
    v_cvt_pk_bf16_f32 v70, v44, v45
    v_cvt_pk_bf16_f32 v71, v46, v47
    s_mov_b32 s57, 73728
    buffer_store_dwordx4 v[68:71], v20, s[24:27], s57 offen sc1
    v_mfma_f32_16x16x32_bf16 v[56:59], v[200:203], a[20:23], v[56:59]
    s_waitcnt vmcnt(16)
    ds_read_b64_tr_b16 a[196:197], v6 offset:12288
    ds_read_b64_tr_b16 a[198:199], v6 offset:14336
    ds_read_b64_tr_b16 a[200:201], v7 offset:12288
    v_mfma_f32_16x16x32_bf16 v[60:63], v[204:207], a[20:23], v[60:63]
    ds_read_b64_tr_b16 a[202:203], v7 offset:14336
    ds_read_b64_tr_b16 a[204:205], v8 offset:12288
    ds_read_b64_tr_b16 a[206:207], v8 offset:14336
    ds_read_b128 a[20:23], v2 offset:5120
    v_mfma_f32_16x16x32_bf16 v[48:51], v[208:211], a[24:27], v[48:51]
    v_mfma_f32_16x16x32_bf16 v[52:55], v[212:215], a[24:27], v[52:55]
    v_mfma_f32_16x16x32_bf16 v[56:59], v[216:219], a[24:27], v[56:59]
    v_mfma_f32_16x16x32_bf16 v[60:63], v[220:223], a[24:27], v[60:63]
    ds_read_b128 a[24:27], v2 offset:6144
    v_mfma_f32_16x16x32_bf16 v[48:51], a[168:171], a[28:31], v[48:51]
    v_mfma_f32_16x16x32_bf16 v[52:55], a[172:175], a[28:31], v[52:55]
    v_mfma_f32_16x16x32_bf16 v[56:59], a[176:179], a[28:31], v[56:59]
    v_mfma_f32_16x16x32_bf16 v[60:63], a[180:183], a[28:31], v[60:63]
    ds_read_b128 a[28:31], v2 offset:7168
    s_waitcnt lgkmcnt(10)
    v_mfma_f32_16x16x32_bf16 v[80:83], a[32:35], a[0:3], 0
    v_mfma_f32_16x16x32_bf16 v[84:87], a[36:39], a[0:3], 0
    v_mfma_f32_16x16x32_bf16 v[88:91], a[40:43], a[0:3], 0
    ds_read_b128 a[0:3], v2 offset:8192
    v_mfma_f32_16x16x32_bf16 v[80:83], a[48:51], a[4:7], v[80:83]
    v_cvt_pk_bf16_f32 v72, v48, v49
    v_cvt_pk_bf16_f32 v73, v50, v51
    v_mfma_f32_16x16x32_bf16 v[84:87], a[52:55], a[4:7], v[84:87]
    v_cvt_pk_bf16_f32 v74, v52, v53
    v_cvt_pk_bf16_f32 v75, v54, v55
    v_mfma_f32_16x16x32_bf16 v[88:91], a[56:59], a[4:7], v[88:91]
    ds_read_b128 a[4:7], v2 offset:9216
    v_mfma_f32_16x16x32_bf16 v[80:83], a[64:67], a[8:11], v[80:83]
    v_mfma_f32_16x16x32_bf16 v[84:87], a[68:71], a[8:11], v[84:87]
    v_mfma_f32_16x16x32_bf16 v[88:91], a[72:75], a[8:11], v[88:91]
    ds_read_b128 a[8:11], v2 offset:10240
    v_mfma_f32_16x16x32_bf16 v[80:83], a[80:83], a[12:15], v[80:83]
    v_mfma_f32_16x16x32_bf16 v[84:87], a[84:87], a[12:15], v[84:87]
    v_mfma_f32_16x16x32_bf16 v[88:91], a[88:91], a[12:15], v[88:91]
    ds_read_b128 a[12:15], v2 offset:11264
    s_waitcnt lgkmcnt(4)
    v_mfma_f32_16x16x32_bf16 v[80:83], a[136:139], a[16:19], v[80:83]
    v_mfma_f32_16x16x32_bf16 v[84:87], a[140:143], a[16:19], v[84:87]
    v_mfma_f32_16x16x32_bf16 v[88:91], a[144:147], a[16:19], v[88:91]
    ds_read_b128 a[16:19], v2 offset:12288
    v_mfma_f32_16x16x32_bf16 v[80:83], a[152:155], a[20:23], v[80:83]
    v_mfma_f32_16x16x32_bf16 v[84:87], a[156:159], a[20:23], v[84:87]
    v_mfma_f32_16x16x32_bf16 v[88:91], a[160:163], a[20:23], v[88:91]
    ds_read_b128 a[20:23], v2 offset:13312
    v_mfma_f32_16x16x32_bf16 v[80:83], a[184:187], a[24:27], v[80:83]
    v_mfma_f32_16x16x32_bf16 v[84:87], a[188:191], a[24:27], v[84:87]
    s_cmp_eq_u32 s60, 9
    s_cselect_b32 s57, s35, 36864
    s_cbranch_scc0 L_keep9
    v_mov_b32 v21, v72
    v_mov_b32 v22, v73
    v_mov_b32 v23, v74
    v_mov_b32 v24, v75
L_keep9:
    buffer_store_dwordx4 v[72:75], v20, s[24:27], s57 offen sc1
    v_mfma_f32_16x16x32_bf16 v[88:91], a[192:195], a[24:27], v[88:91]
    v_cvt_pk_bf16_f32 v76, v56, v57
    v_cvt_pk_bf16_f32 v77, v58, v59
    v_cvt_pk_bf16_f32 v78, v60, v61
    v_cvt_pk_bf16_f32 v79, v62, v63
    ds_read_b128 a[24:27], v2 offset:14336
    v_mfma_f32_16x16x32_bf16 v[80:83], a[196:199], a[28:31], v[80:83]
    s_mov_b32 s57, 77824
    buffer_store_dwordx4 v[76:79], v20, s[24:27], s57 offen sc1
    v_mfma_f32_16x16x32_bf16 v[84:87], a[200:203], a[28:31], v[84:87]
    v_mfma_f32_16x16x32_bf16 v[88:91], a[204:207], a[28:31], v[88:91]
    ds_read_b128 a[28:31], v2 offset:15360
    s_waitcnt lgkmcnt(4)
    v_mfma_f32_16x16x32_bf16 v[92:95], a[32:35], a[0:3], 0
    s_mul_i32 s41, s60, 143360
    v_mfma_f32_16x16x32_bf16 v[96:99], a[36:39], a[0:3], 0
    s_sub_u32 s4, s24, s41
    s_subb_u32 s5, s25, 0
    v_mfma_f32_16x16x32_bf16 v[100:103], a[40:43], a[0:3], 0
    s_mov_b32 s6, 2293760
    ds_read_b128 a[0:3], v2 offset:16384
    v_mfma_f32_16x16x32_bf16 v[92:95], a[48:51], a[4:7], v[92:95]
    v_cvt_pk_bf16_f32 v64, v80, v81
    v_cvt_pk_bf16_f32 v65, v82, v83
    v_mfma_f32_16x16x32_bf16 v[96:99], a[52:55], a[4:7], v[96:99]
    v_cvt_pk_bf16_f32 v66, v84, v85
    v_cvt_pk_bf16_f32 v67, v86, v87
    v_mfma_f32_16x16x32_bf16 v[100:103], a[56:59], a[4:7], v[100:103]
    ds_read_b128 a[4:7], v2 offset:17408
    v_mfma_f32_16x16x32_bf16 v[92:95], a[64:67], a[8:11], v[92:95]
    v_mfma_f32_16x16x32_bf16 v[96:99], a[68:71], a[8:11], v[96:99]
    v_mfma_f32_16x16x32_bf16 v[100:103], a[72:75], a[8:11], v[100:103]
    ds_read_b128 a[8:11], v2 offset:18432
    v_mfma_f32_16x16x32_bf16 v[92:95], a[80:83], a[12:15], v[92:95]
    v_mfma_f32_16x16x32_bf16 v[96:99], a[84:87], a[12:15], v[96:99]
    v_mfma_f32_16x16x32_bf16 v[100:103], a[88:91], a[12:15], v[100:103]
    ds_read_b128 a[12:15], v2 offset:19456
    s_waitcnt lgkmcnt(4)
    v_mfma_f32_16x16x32_bf16 v[92:95], a[136:139], a[16:19], v[92:95]
    v_mfma_f32_16x16x32_bf16 v[96:99], a[140:143], a[16:19], v[96:99]
    v_mfma_f32_16x16x32_bf16 v[100:103], a[144:147], a[16:19], v[100:103]
    ds_read_b128 a[16:19], v2 offset:20480
    v_mfma_f32_16x16x32_bf16 v[92:95], a[152:155], a[20:23], v[92:95]
    v_mfma_f32_16x16x32_bf16 v[96:99], a[156:159], a[20:23], v[96:99]
    v_mfma_f32_16x16x32_bf16 v[100:103], a[160:163], a[20:23], v[100:103]
    ds_read_b128 a[20:23], v2 offset:21504
    v_mfma_f32_16x16x32_bf16 v[92:95], a[184:187], a[24:27], v[92:95]
    v_mfma_f32_16x16x32_bf16 v[96:99], a[188:191], a[24:27], v[96:99]
    s_cmp_eq_u32 s60, 0
    s_cselect_b32 s57, s35, 81920
    s_cbranch_scc0 L_keep20
    v_mov_b32 v25, v64
    v_mov_b32 v26, v65
    v_mov_b32 v27, v66
    v_mov_b32 v28, v67
L_keep20:
    buffer_store_dwordx4 v[64:67], v20, s[24:27], s57 offen sc1
    v_cvt_pk_bf16_f32 v104, v88, v89
    v_cvt_pk_bf16_f32 v105, v90, v91
    v_mfma_f32_16x16x32_bf16 v[100:103], a[192:195], a[24:27], v[100:103]
    s_mov_b32 s7, 0x00020000
    ds_read_b128 a[24:27], v2 offset:22528
    v_mfma_f32_16x16x32_bf16 v[92:95], a[196:199], a[28:31], v[92:95]
    s_mov_b32 s8, s90
    s_mov_b32 s9, s91
    v_mfma_f32_16x16x32_bf16 v[96:99], a[200:203], a[28:31], v[96:99]
    s_mov_b32 s10, 2293760
    s_mov_b32 s11, 0x00020000
    v_mfma_f32_16x16x32_bf16 v[100:103], a[204:207], a[28:31], v[100:103]
    ds_read_b128 a[28:31], v2 offset:23552
    s_waitcnt lgkmcnt(4)
    v_mfma_f32_16x16x32_bf16 v[80:83], a[32:35], a[0:3], 0
    s_lshl_b32 s38, s60, 2
    s_add_u32 s38, s38, s28
    v_mfma_f32_16x16x32_bf16 v[84:87], a[36:39], a[0:3], 0
    s_mov_b32 s39, s28
    s_mov_b32 s40, s60
    v_mfma_f32_16x16x32_bf16 v[88:91], a[40:43], a[0:3], 0
    s_lshl_b32 s45, s39, 10
    ds_read_b128 a[0:3], v2 offset:24576
    v_mfma_f32_16x16x32_bf16 v[80:83], a[48:51], a[4:7], v[80:83]
    v_cvt_pk_bf16_f32 v68, v92, v93
    v_cvt_pk_bf16_f32 v69, v94, v95
    v_mfma_f32_16x16x32_bf16 v[84:87], a[52:55], a[4:7], v[84:87]
    v_cvt_pk_bf16_f32 v70, v96, v97
    v_cvt_pk_bf16_f32 v71, v98, v99
    v_mfma_f32_16x16x32_bf16 v[88:91], a[56:59], a[4:7], v[88:91]
    ds_read_b128 a[4:7], v2 offset:25600
    v_mfma_f32_16x16x32_bf16 v[80:83], a[64:67], a[8:11], v[80:83]
    v_mfma_f32_16x16x32_bf16 v[84:87], a[68:71], a[8:11], v[84:87]
    v_mfma_f32_16x16x32_bf16 v[88:91], a[72:75], a[8:11], v[88:91]
    ds_read_b128 a[8:11], v2 offset:26624
    v_mfma_f32_16x16x32_bf16 v[80:83], a[80:83], a[12:15], v[80:83]
    v_mfma_f32_16x16x32_bf16 v[84:87], a[84:87], a[12:15], v[84:87]
    v_mfma_f32_16x16x32_bf16 v[88:91], a[88:91], a[12:15], v[88:91]
    ds_read_b128 a[12:15], v2 offset:27648
    s_waitcnt lgkmcnt(4)
    v_mfma_f32_16x16x32_bf16 v[80:83], a[136:139], a[16:19], v[80:83]
    v_mfma_f32_16x16x32_bf16 v[84:87], a[140:143], a[16:19], v[84:87]
    v_mfma_f32_16x16x32_bf16 v[88:91], a[144:147], a[16:19], v[88:91]
    ds_read_b128 a[16:19], v2 offset:28672
    v_mfma_f32_16x16x32_bf16 v[80:83], a[152:155], a[20:23], v[80:83]
    v_mfma_f32_16x16x32_bf16 v[84:87], a[156:159], a[20:23], v[84:87]
    v_mfma_f32_16x16x32_bf16 v[88:91], a[160:163], a[20:23], v[88:91]
    ds_read_b128 a[20:23], v2 offset:29696
    v_mfma_f32_16x16x32_bf16 v[80:83], a[184:187], a[24:27], v[80:83]
    v_mfma_f32_16x16x32_bf16 v[84:87], a[188:191], a[24:27], v[84:87]
    s_cmp_eq_u32 s60, 1
    s_cselect_b32 s57, s35, 86016
    s_cbranch_scc0 L_keep21
    v_mov_b32 v25, v68
    v_mov_b32 v26, v69
    v_mov_b32 v27, v70
    v_mov_b32 v28, v71
L_keep21:
    buffer_store_dwordx4 v[68:71], v20, s[24:27], s57 offen sc1
    v_cvt_pk_bf16_f32 v106, v100, v101
    v_cvt_pk_bf16_f32 v107, v102, v103
    s_cmp_eq_u32 s60, 10
    s_cselect_b32 s57, s35, 122880
    s_cbranch_scc0 L_keep30
    v_mov_b32 v25, v104
    v_mov_b32 v26, v105
    v_mov_b32 v27, v106
    v_mov_b32 v28, v107
L_keep30:
    buffer_store_dwordx4 v[104:107], v20, s[24:27], s57 offen sc1
    v_mfma_f32_16x16x32_bf16 v[88:91], a[192:195], a[24:27], v[88:91]
    s_lshl_b32 s46, s40, 12
    ds_read_b128 a[24:27], v2 offset:30720
    v_mfma_f32_16x16x32_bf16 v[80:83], a[196:199], a[28:31], v[80:83]
    s_add_u32 s45, s45, s46
    v_lshlrev_b32 v240, 4, v1
    v_mfma_f32_16x16x32_bf16 v[84:87], a[200:203], a[28:31], v[84:87]
    v_add_u32 v240, s45, v240
    v_and_b32 v244, 15, v1
    v_mfma_f32_16x16x32_bf16 v[88:91], a[204:207], a[28:31], v[88:91]
    ds_read_b128 a[28:31], v2 offset:31744
    s_waitcnt lgkmcnt(4)
    v_mfma_f32_16x16x32_bf16 v[92:95], a[32:35], a[0:3], 0
    v_lshrrev_b32 v245, 4, v1
    v_and_b32 v246, 1, v245
    v_mfma_f32_16x16x32_bf16 v[96:99], a[36:39], a[0:3], 0
    v_lshrrev_b32 v247, 1, v245
    v_lshlrev_b32 v247, 3, v247
    v_mfma_f32_16x16x32_bf16 v[100:103], a[40:43], a[0:3], 0
    s_mul_hi_u32 s48, s40, 429496730
    ds_read_b128 a[0:3], v2 offset:32768
    v_mfma_f32_16x16x32_bf16 v[92:95], a[48:51], a[4:7], v[92:95]
    v_cvt_pk_bf16_f32 v72, v80, v81
    v_cvt_pk_bf16_f32 v73, v82, v83
    v_mfma_f32_16x16x32_bf16 v[96:99], a[52:55], a[4:7], v[96:99]
    v_cvt_pk_bf16_f32 v74, v84, v85
    v_cvt_pk_bf16_f32 v75, v86, v87
    v_mfma_f32_16x16x32_bf16 v[100:103], a[56:59], a[4:7], v[100:103]
    ds_read_b128 a[4:7], v2 offset:33792
    v_mfma_f32_16x16x32_bf16 v[92:95], a[64:67], a[8:11], v[92:95]
    v_mfma_f32_16x16x32_bf16 v[96:99], a[68:71], a[8:11], v[96:99]
    v_mfma_f32_16x16x32_bf16 v[100:103], a[72:75], a[8:11], v[100:103]
    ds_read_b128 a[8:11], v2 offset:34816
    v_mfma_f32_16x16x32_bf16 v[92:95], a[80:83], a[12:15], v[92:95]
    v_mfma_f32_16x16x32_bf16 v[96:99], a[84:87], a[12:15], v[96:99]
    v_mfma_f32_16x16x32_bf16 v[100:103], a[88:91], a[12:15], v[100:103]
    ds_read_b128 a[12:15], v2 offset:35840
    s_waitcnt lgkmcnt(4)
    v_mfma_f32_16x16x32_bf16 v[92:95], a[136:139], a[16:19], v[92:95]
    v_mfma_f32_16x16x32_bf16 v[96:99], a[140:143], a[16:19], v[96:99]
    v_mfma_f32_16x16x32_bf16 v[100:103], a[144:147], a[16:19], v[100:103]
    ds_read_b128 a[16:19], v2 offset:36864
    v_mfma_f32_16x16x32_bf16 v[92:95], a[152:155], a[20:23], v[92:95]
    v_mfma_f32_16x16x32_bf16 v[96:99], a[156:159], a[20:23], v[96:99]
    v_mfma_f32_16x16x32_bf16 v[100:103], a[160:163], a[20:23], v[100:103]
    ds_read_b128 a[20:23], v2 offset:37888
    v_mfma_f32_16x16x32_bf16 v[92:95], a[184:187], a[24:27], v[92:95]
    v_mfma_f32_16x16x32_bf16 v[96:99], a[188:191], a[24:27], v[96:99]
    s_cmp_eq_u32 s60, 2
    s_cselect_b32 s57, s35, 90112
    s_cbranch_scc0 L_keep22
    v_mov_b32 v25, v72
    v_mov_b32 v26, v73
    v_mov_b32 v27, v74
    v_mov_b32 v28, v75
L_keep22:
    buffer_store_dwordx4 v[72:75], v20, s[24:27], s57 offen sc1
    v_cvt_pk_bf16_f32 v108, v88, v89
    v_cvt_pk_bf16_f32 v109, v90, v91
    v_mfma_f32_16x16x32_bf16 v[100:103], a[192:195], a[24:27], v[100:103]
    s_mul_i32 s49, s48, 10
    ds_read_b128 a[24:27], v2 offset:38912
    v_mfma_f32_16x16x32_bf16 v[92:95], a[196:199], a[28:31], v[92:95]
    s_sub_u32 s49, s40, s49
    s_sub_u32 s52, s40, 30
    v_mfma_f32_16x16x32_bf16 v[96:99], a[200:203], a[28:31], v[96:99]
    s_lshl_b32 s52, s52, 1
    s_lshl_b32 s53, s48, 5
    v_mfma_f32_16x16x32_bf16 v[100:103], a[204:207], a[28:31], v[100:103]
    ds_read_b128 a[28:31], v2 offset:39936
    s_waitcnt lgkmcnt(4)
    v_mfma_f32_16x16x32_bf16 v[80:83], a[32:35], a[0:3], 0
    v_mfma_f32_16x16x32_bf16 v[84:87], a[36:39], a[0:3], 0
    v_mfma_f32_16x16x32_bf16 v[88:91], a[40:43], a[0:3], 0
    ds_read_b128 a[0:3], v3
    v_mfma_f32_16x16x32_bf16 v[80:83], a[48:51], a[4:7], v[80:83]
    v_cvt_pk_bf16_f32 v76, v92, v93
    v_cvt_pk_bf16_f32 v77, v94, v95
    v_mfma_f32_16x16x32_bf16 v[84:87], a[52:55], a[4:7], v[84:87]
    v_cvt_pk_bf16_f32 v78, v96, v97
    v_cvt_pk_bf16_f32 v79, v98, v99
    v_mfma_f32_16x16x32_bf16 v[88:91], a[56:59], a[4:7], v[88:91]
    ds_read_b128 a[4:7], v3 offset:1024
    v_mfma_f32_16x16x32_bf16 v[80:83], a[64:67], a[8:11], v[80:83]
    v_mfma_f32_16x16x32_bf16 v[84:87], a[68:71], a[8:11], v[84:87]
    v_mfma_f32_16x16x32_bf16 v[88:91], a[72:75], a[8:11], v[88:91]
    ds_read_b128 a[8:11], v3 offset:2048
    v_mfma_f32_16x16x32_bf16 v[80:83], a[80:83], a[12:15], v[80:83]
    v_mfma_f32_16x16x32_bf16 v[84:87], a[84:87], a[12:15], v[84:87]
    v_mfma_f32_16x16x32_bf16 v[88:91], a[88:91], a[12:15], v[88:91]
    ds_read_b128 a[12:15], v3 offset:3072
    s_waitcnt lgkmcnt(4)
    v_mfma_f32_16x16x32_bf16 v[80:83], a[136:139], a[16:19], v[80:83]
    v_mfma_f32_16x16x32_bf16 v[84:87], a[140:143], a[16:19], v[84:87]
    v_mfma_f32_16x16x32_bf16 v[88:91], a[144:147], a[16:19], v[88:91]
    ds_read_b128 a[16:19], v3 offset:4096
    v_mfma_f32_16x16x32_bf16 v[80:83], a[152:155], a[20:23], v[80:83]
    v_mfma_f32_16x16x32_bf16 v[84:87], a[156:159], a[20:23], v[84:87]
    v_mfma_f32_16x16x32_bf16 v[88:91], a[160:163], a[20:23], v[88:91]
    ds_read_b128 a[20:23], v3 offset:5120
    v_mfma_f32_16x16x32_bf16 v[80:83], a[184:187], a[24:27], v[80:83]
    v_mfma_f32_16x16x32_bf16 v[84:87], a[188:191], a[24:27], v[84:87]
    s_cmp_eq_u32 s60, 3
    s_cselect_b32 s57, s35, 94208
    s_cbranch_scc0 L_keep23
    v_mov_b32 v25, v76
    v_mov_b32 v26, v77
    v_mov_b32 v27, v78
    v_mov_b32 v28, v79
L_keep23:
    buffer_store_dwordx4 v[76:79], v20, s[24:27], s57 offen sc1
    v_cvt_pk_bf16_f32 v110, v100, v101
    v_cvt_pk_bf16_f32 v111, v102, v103
    s_cmp_eq_u32 s60, 11
    s_cselect_b32 s57, s35, 126976
    s_cbranch_scc0 L_keep31
    v_mov_b32 v25, v108
    v_mov_b32 v26, v109
    v_mov_b32 v27, v110
    v_mov_b32 v28, v111
L_keep31:
    buffer_store_dwordx4 v[108:111], v20, s[24:27], s57 offen sc1
    v_mfma_f32_16x16x32_bf16 v[88:91], a[192:195], a[24:27], v[88:91]
    ds_read_b128 a[24:27], v3 offset:6144
    v_mfma_f32_16x16x32_bf16 v[80:83], a[196:199], a[28:31], v[80:83]
    v_mfma_f32_16x16x32_bf16 v[84:87], a[200:203], a[28:31], v[84:87]
    v_mfma_f32_16x16x32_bf16 v[88:91], a[204:207], a[28:31], v[88:91]
    ds_read_b128 a[28:31], v3 offset:7168
    s_waitcnt lgkmcnt(4)
    v_mfma_f32_16x16x32_bf16 v[92:95], a[32:35], a[0:3], 0
    v_mfma_f32_16x16x32_bf16 v[96:99], a[36:39], a[0:3], 0
    v_mfma_f32_16x16x32_bf16 v[100:103], a[40:43], a[0:3], 0
    ds_read_b128 a[0:3], v3 offset:8192
    v_mfma_f32_16x16x32_bf16 v[92:95], a[48:51], a[4:7], v[92:95]
    v_cvt_pk_bf16_f32 v64, v80, v81
    v_cvt_pk_bf16_f32 v65, v82, v83
    v_cvt_pk_bf16_f32 v66, v84, v85
    v_mfma_f32_16x16x32_bf16 v[96:99], a[52:55], a[4:7], v[96:99]
    v_cvt_pk_bf16_f32 v67, v86, v87
    v_mfma_f32_16x16x32_bf16 v[100:103], a[56:59], a[4:7], v[100:103]
    ds_read_b128 a[4:7], v3 offset:9216
    v_mfma_f32_16x16x32_bf16 v[92:95], a[64:67], a[8:11], v[92:95]
    v_mfma_f32_16x16x32_bf16 v[96:99], a[68:71], a[8:11], v[96:99]
    v_mfma_f32_16x16x32_bf16 v[100:103], a[72:75], a[8:11], v[100:103]
    ds_read_b128 a[8:11], v3 offset:10240
    v_mfma_f32_16x16x32_bf16 v[92:95], a[80:83], a[12:15], v[92:95]
    v_mfma_f32_16x16x32_bf16 v[96:99], a[84:87], a[12:15], v[96:99]
    v_mfma_f32_16x16x32_bf16 v[100:103], a[88:91], a[12:15], v[100:103]
    ds_read_b128 a[12:15], v3 offset:11264
    s_waitcnt lgkmcnt(4)
    v_mfma_f32_16x16x32_bf16 v[92:95], a[136:139], a[16:19], v[92:95]
    v_mfma_f32_16x16x32_bf16 v[96:99], a[140:143], a[16:19], v[96:99]
    v_mfma_f32_16x16x32_bf16 v[100:103], a[144:147], a[16:19], v[100:103]
    ds_read_b128 a[16:19], v3 offset:12288
    v_mfma_f32_16x16x32_bf16 v[92:95], a[152:155], a[20:23], v[92:95]
    v_mfma_f32_16x16x32_bf16 v[96:99], a[156:159], a[20:23], v[96:99]
    v_mfma_f32_16x16x32_bf16 v[100:103], a[160:163], a[20:23], v[100:103]
    ds_read_b128 a[20:23], v3 offset:13312
    v_mfma_f32_16x16x32_bf16 v[92:95], a[184:187], a[24:27], v[92:95]
    v_mfma_f32_16x16x32_bf16 v[96:99], a[188:191], a[24:27], v[96:99]
    s_cmp_eq_u32 s60, 4
    s_cselect_b32 s57, s35, 98304
    s_cbranch_scc0 L_keep24
    v_mov_b32 v25, v64
    v_mov_b32 v26, v65
    v_mov_b32 v27, v66
    v_mov_b32 v28, v67
L_keep24:
    buffer_store_dwordx4 v[64:67], v20, s[24:27], s57 offen sc1
    v_cvt_pk_bf16_f32 v104, v88, v89
    v_cvt_pk_bf16_f32 v105, v90, v91
    v_mfma_f32_16x16x32_bf16 v[100:103], a[192:195], a[24:27], v[100:103]
    ds_read_b128 a[24:27], v3 offset:14336
    v_mfma_f32_16x16x32_bf16 v[92:95], a[196:199], a[28:31], v[92:95]
    v_mfma_f32_16x16x32_bf16 v[96:99], a[200:203], a[28:31], v[96:99]
    v_mfma_f32_16x16x32_bf16 v[100:103], a[204:207], a[28:31], v[100:103]
    ds_read_b128 a[28:31], v3 offset:15360
    s_waitcnt lgkmcnt(4)
    v_mfma_f32_16x16x32_bf16 v[80:83], a[32:35], a[0:3], 0
    v_mfma_f32_16x16x32_bf16 v[84:87], a[36:39], a[0:3], 0
    v_mfma_f32_16x16x32_bf16 v[88:91], a[40:43], a[0:3], 0
    ds_read_b128 a[0:3], v3 offset:16384
    v_mfma_f32_16x16x32_bf16 v[80:83], a[48:51], a[4:7], v[80:83]
    v_cvt_pk_bf16_f32 v68, v92, v93
    v_cvt_pk_bf16_f32 v69, v94, v95
    v_cvt_pk_bf16_f32 v70, v96, v97
    v_mfma_f32_16x16x32_bf16 v[84:87], a[52:55], a[4:7], v[84:87]
    v_cvt_pk_bf16_f32 v71, v98, v99
    v_mfma_f32_16x16x32_bf16 v[88:91], a[56:59], a[4:7], v[88:91]
    ds_read_b128 a[4:7], v3 offset:17408
    v_mfma_f32_16x16x32_bf16 v[80:83], a[64:67], a[8:11], v[80:83]
    v_mfma_f32_16x16x32_bf16 v[84:87], a[68:71], a[8:11], v[84:87]
    v_mfma_f32_16x16x32_bf16 v[88:91], a[72:75], a[8:11], v[88:91]
    ds_read_b128 a[8:11], v3 offset:18432
    v_mfma_f32_16x16x32_bf16 v[80:83], a[80:83], a[12:15], v[80:83]
    v_mfma_f32_16x16x32_bf16 v[84:87], a[84:87], a[12:15], v[84:87]
    v_mfma_f32_16x16x32_bf16 v[88:91], a[88:91], a[12:15], v[88:91]
    ds_read_b128 a[12:15], v3 offset:19456
    s_waitcnt lgkmcnt(4)
    v_mfma_f32_16x16x32_bf16 v[80:83], a[136:139], a[16:19], v[80:83]
    v_mfma_f32_16x16x32_bf16 v[84:87], a[140:143], a[16:19], v[84:87]
    v_mfma_f32_16x16x32_bf16 v[88:91], a[144:147], a[16:19], v[88:91]
    ds_read_b128 a[16:19], v3 offset:20480
    v_mfma_f32_16x16x32_bf16 v[80:83], a[152:155], a[20:23], v[80:83]
    v_mfma_f32_16x16x32_bf16 v[84:87], a[156:159], a[20:23], v[84:87]
    v_mfma_f32_16x16x32_bf16 v[88:91], a[160:163], a[20:23], v[88:91]
    ds_read_b128 a[20:23], v3 offset:21504
    v_mfma_f32_16x16x32_bf16 v[80:83], a[184:187], a[24:27], v[80:83]
    v_mfma_f32_16x16x32_bf16 v[84:87], a[188:191], a[24:27], v[84:87]
    s_cmp_eq_u32 s60, 5
    s_cselect_b32 s57, s35, 102400
    s_cbranch_scc0 L_keep25
    v_mov_b32 v25, v68
    v_mov_b32 v26, v69
    v_mov_b32 v27, v70
    v_mov_b32 v28, v71
L_keep25:
    buffer_store_dwordx4 v[68:71], v20, s[24:27], s57 offen sc1
    v_cvt_pk_bf16_f32 v106, v100, v101
    v_cvt_pk_bf16_f32 v107, v102, v103
    s_cmp_eq_u32 s60, 12
    s_cselect_b32 s57, s35, 131072
    s_cbranch_scc0 L_keep32
    v_mov_b32 v25, v104
    v_mov_b32 v26, v105
    v_mov_b32 v27, v106
    v_mov_b32 v28, v107
L_keep32:
    buffer_store_dwordx4 v[104:107], v20, s[24:27], s57 offen sc1
    v_mfma_f32_16x16x32_bf16 v[88:91], a[192:195], a[24:27], v[88:91]
    ds_read_b128 a[24:27], v3 offset:22528
    v_mfma_f32_16x16x32_bf16 v[80:83], a[196:199], a[28:31], v[80:83]
    v_mfma_f32_16x16x32_bf16 v[84:87], a[200:203], a[28:31], v[84:87]
    v_mfma_f32_16x16x32_bf16 v[88:91], a[204:207], a[28:31], v[88:91]
    ds_read_b128 a[28:31], v3 offset:23552
    s_waitcnt lgkmcnt(4)
    v_mfma_f32_16x16x32_bf16 v[92:95], a[32:35], a[0:3], 0
    v_mfma_f32_16x16x32_bf16 v[96:99], a[36:39], a[0:3], 0
    v_mfma_f32_16x16x32_bf16 v[100:103], a[40:43], a[0:3], 0
    ds_read_b128 a[0:3], v3 offset:24576
    v_mfma_f32_16x16x32_bf16 v[92:95], a[48:51], a[4:7], v[92:95]
    s_cmp_lt_u32 s40, 30
    s_cselect_b32 s52, s49, s52
    s_cselect_b32 s53, s53, 96
    s_cselect_b32 s54, 16, 0
    s_cselect_b32 s55, 0, 16
    v_mfma_f32_16x16x32_bf16 v[96:99], a[52:55], a[4:7], v[96:99]
    s_mul_i32 s56, s61, 160
    s_lshl_b32 s52, s52, 4
    s_add_u32 s56, s56, s52
    s_mul_i32 s50, s62, 448
    v_mfma_f32_16x16x32_bf16 v[100:103], a[56:59], a[4:7], v[100:103]
    s_mul_i32 s58, s39, 112
    s_add_u32 s50, s50, s58
    s_add_u32 s50, s50, s53
    ds_read_b128 a[4:7], v3 offset:25600
    v_mfma_f32_16x16x32_bf16 v[92:95], a[64:67], a[8:11], v[92:95]
    v_mad_u32_u24 v241, v246, s55, v244
    v_add_u32 v241, s56, v241
    v_mad_u32_u24 v244, v246, s54, v247
    v_add_u32 v244, s50, v244
    v_mfma_f32_16x16x32_bf16 v[96:99], a[68:71], a[8:11], v[96:99]
    s_mov_b32 s59, 1792
    v_lshlrev_b32 v244, 1, v244
    v_mad_u32_u24 v241, v241, s59, v244
    v_and_b32 v248, 15, v1
    v_mfma_f32_16x16x32_bf16 v[100:103], a[72:75], a[8:11], v[100:103]
    v_lshlrev_b32 v248, 3, v248
    v_bfe_u32 v249, v1, 4, 1
    v_lshl_add_u32 v248, v249, 12, v248
    ds_read_b128 a[8:11], v3 offset:26624
    v_mfma_f32_16x16x32_bf16 v[92:95], a[80:83], a[12:15], v[92:95]
    v_mov_b32 v249, s79
    s_lshl_b32 s43, 0x10001, s60
    s_lshl_b32 s41, s60, 7
    s_add_u32 s41, s41, s100
    v_mfma_f32_16x16x32_bf16 v[96:99], a[84:87], a[12:15], v[96:99]
    s_lshr_b32 s40, s60, 2
    s_add_u32 s40, s40, 16
    s_and_b32 s39, s60, 3
    s_add_u32 s38, s60, 64
    s_lshl_b32 s45, s39, 10
    v_mfma_f32_16x16x32_bf16 v[100:103], a[88:91], a[12:15], v[100:103]
    s_lshl_b32 s46, s40, 12
    s_add_u32 s45, s45, s46
    ds_read_b128 a[12:15], v3 offset:27648
    s_waitcnt lgkmcnt(4)
    v_mfma_f32_16x16x32_bf16 v[92:95], a[136:139], a[16:19], v[92:95]
    v_lshlrev_b32 v242, 4, v1
    v_add_u32 v242, s45, v242
    v_and_b32 v244, 15, v1
    v_lshrrev_b32 v245, 4, v1
    v_mfma_f32_16x16x32_bf16 v[96:99], a[140:143], a[16:19], v[96:99]
    v_and_b32 v246, 1, v245
    v_lshrrev_b32 v247, 1, v245
    v_cvt_pk_bf16_f32 v72, v80, v81
    v_lshlrev_b32 v247, 3, v247
    v_mfma_f32_16x16x32_bf16 v[100:103], a[144:147], a[16:19], v[100:103]
    v_cvt_pk_bf16_f32 v73, v82, v83
    s_mul_hi_u32 s48, s40, 429496730
    v_cvt_pk_bf16_f32 v74, v84, v85
    ds_read_b128 a[16:19], v3 offset:28672
    v_mfma_f32_16x16x32_bf16 v[92:95], a[152:155], a[20:23], v[92:95]
    s_mul_i32 s49, s48, 10
    v_cvt_pk_bf16_f32 v75, v86, v87
    s_sub_u32 s49, s40, s49
    v_mfma_f32_16x16x32_bf16 v[96:99], a[156:159], a[20:23], v[96:99]
    v_mfma_f32_16x16x32_bf16 v[100:103], a[160:163], a[20:23], v[100:103]
    ds_read_b128 a[20:23], v3 offset:29696
    v_mfma_f32_16x16x32_bf16 v[92:95], a[184:187], a[24:27], v[92:95]
    s_cmp_eq_u32 s60, 6
    s_cselect_b32 s57, s35, 106496
    s_cbranch_scc0 L_keep26
    v_mov_b32 v25, v72
    v_mov_b32 v26, v73
    v_mov_b32 v27, v74
    v_mov_b32 v28, v75
L_keep26:
    buffer_store_dwordx4 v[72:75], v20, s[24:27], s57 offen sc1
    v_mfma_f32_16x16x32_bf16 v[96:99], a[188:191], a[24:27], v[96:99]
    v_cvt_pk_bf16_f32 v108, v88, v89
    v_cvt_pk_bf16_f32 v109, v90, v91
    s_sub_u32 s52, s40, 30
    s_lshl_b32 s52, s52, 1
    s_lshl_b32 s53, s48, 5
    v_mfma_f32_16x16x32_bf16 v[100:103], a[192:195], a[24:27], v[100:103]
    s_cmp_lt_u32 s40, 30
    s_cselect_b32 s52, s49, s52
    s_cselect_b32 s53, s53, 96
    s_cselect_b32 s54, 16, 0
    s_cselect_b32 s55, 0, 16
    ds_read_b128 a[24:27], v3 offset:30720
    v_mfma_f32_16x16x32_bf16 v[92:95], a[196:199], a[28:31], v[92:95]
    s_mul_i32 s56, s61, 160
    s_lshl_b32 s52, s52, 4
    s_add_u32 s56, s56, s52
    s_mul_i32 s50, s62, 448
    s_mul_i32 s58, s39, 112
    v_mfma_f32_16x16x32_bf16 v[96:99], a[200:203], a[28:31], v[96:99]
    s_add_u32 s50, s50, s58
    s_add_u32 s50, s50, s53
    v_mad_u32_u24 v243, v246, s55, v244
    v_add_u32 v243, s56, v243
    v_mad_u32_u24 v244, v246, s54, v247
    v_add_u32 v244, s50, v244
    v_mfma_f32_16x16x32_bf16 v[100:103], a[204:207], a[28:31], v[100:103]
    s_mov_b32 s59, 1792
    v_lshlrev_b32 v244, 1, v244
    v_mad_u32_u24 v243, v243, s59, v244
    ds_read_b128 a[28:31], v3 offset:31744
    s_waitcnt lgkmcnt(4)
    v_mfma_f32_16x16x32_bf16 v[80:83], a[32:35], a[0:3], 0
    v_mfma_f32_16x16x32_bf16 v[84:87], a[36:39], a[0:3], 0
    v_mfma_f32_16x16x32_bf16 v[88:91], a[40:43], a[0:3], 0
    ds_read_b128 a[0:3], v3 offset:32768
    v_mfma_f32_16x16x32_bf16 v[80:83], a[48:51], a[4:7], v[80:83]
    v_cvt_pk_bf16_f32 v76, v92, v93
    v_cvt_pk_bf16_f32 v77, v94, v95
    v_mfma_f32_16x16x32_bf16 v[84:87], a[52:55], a[4:7], v[84:87]
    v_cvt_pk_bf16_f32 v78, v96, v97
    v_cvt_pk_bf16_f32 v79, v98, v99
    v_mfma_f32_16x16x32_bf16 v[88:91], a[56:59], a[4:7], v[88:91]
    ds_read_b128 a[4:7], v3 offset:33792
    v_mfma_f32_16x16x32_bf16 v[80:83], a[64:67], a[8:11], v[80:83]
    v_mfma_f32_16x16x32_bf16 v[84:87], a[68:71], a[8:11], v[84:87]
    v_mfma_f32_16x16x32_bf16 v[88:91], a[72:75], a[8:11], v[88:91]
    ds_read_b128 a[8:11], v3 offset:34816
    v_mfma_f32_16x16x32_bf16 v[80:83], a[80:83], a[12:15], v[80:83]
    v_mfma_f32_16x16x32_bf16 v[84:87], a[84:87], a[12:15], v[84:87]
    v_mfma_f32_16x16x32_bf16 v[88:91], a[88:91], a[12:15], v[88:91]
    ds_read_b128 a[12:15], v3 offset:35840
    s_waitcnt lgkmcnt(4)
    v_mfma_f32_16x16x32_bf16 v[80:83], a[136:139], a[16:19], v[80:83]
    v_mfma_f32_16x16x32_bf16 v[84:87], a[140:143], a[16:19], v[84:87]
    v_mfma_f32_16x16x32_bf16 v[88:91], a[144:147], a[16:19], v[88:91]
    ds_read_b128 a[16:19], v3 offset:36864
    v_mfma_f32_16x16x32_bf16 v[80:83], a[152:155], a[20:23], v[80:83]
    v_mfma_f32_16x16x32_bf16 v[84:87], a[156:159], a[20:23], v[84:87]
    v_mfma_f32_16x16x32_bf16 v[88:91], a[160:163], a[20:23], v[88:91]
    ds_read_b128 a[20:23], v3 offset:37888
    v_mfma_f32_16x16x32_bf16 v[80:83], a[184:187], a[24:27], v[80:83]
    v_mfma_f32_16x16x32_bf16 v[84:87], a[188:191], a[24:27], v[84:87]
    s_cmp_eq_u32 s60, 7
    s_cselect_b32 s57, s35, 110592
    s_cbranch_scc0 L_keep27
    v_mov_b32 v25, v76
    v_mov_b32 v26, v77
    v_mov_b32 v27, v78
    v_mov_b32 v28, v79
L_keep27:
    buffer_store_dwordx4 v[76:79], v20, s[24:27], s57 offen sc1
    v_cvt_pk_bf16_f32 v110, v100, v101
    v_cvt_pk_bf16_f32 v111, v102, v103
    s_cmp_eq_u32 s60, 13
    s_cselect_b32 s57, s35, 135168
    s_cbranch_scc0 L_keep33
    v_mov_b32 v25, v108
    v_mov_b32 v26, v109
    v_mov_b32 v27, v110
    v_mov_b32 v28, v111
L_keep33:
    buffer_store_dwordx4 v[108:111], v20, s[24:27], s57 offen sc1
    v_mfma_f32_16x16x32_bf16 v[88:91], a[192:195], a[24:27], v[88:91]
    ds_read_b128 a[24:27], v3 offset:38912
    v_mfma_f32_16x16x32_bf16 v[80:83], a[196:199], a[28:31], v[80:83]
    v_mfma_f32_16x16x32_bf16 v[84:87], a[200:203], a[28:31], v[84:87]
    v_mfma_f32_16x16x32_bf16 v[88:91], a[204:207], a[28:31], v[88:91]
    ds_read_b128 a[28:31], v3 offset:39936
    s_waitcnt lgkmcnt(4)
    v_mfma_f32_16x16x32_bf16 v[92:95], a[32:35], a[0:3], 0
    v_mfma_f32_16x16x32_bf16 v[96:99], a[36:39], a[0:3], 0
    v_mfma_f32_16x16x32_bf16 v[100:103], a[40:43], a[0:3], 0
    v_mfma_f32_16x16x32_bf16 v[92:95], a[48:51], a[4:7], v[92:95]
    v_cvt_pk_bf16_f32 v64, v80, v81
    v_cvt_pk_bf16_f32 v65, v82, v83
    v_mfma_f32_16x16x32_bf16 v[96:99], a[52:55], a[4:7], v[96:99]
    s_waitcnt vmcnt(12)
    s_barrier
    s_cmp_lg_u32 s28, 0
    s_cbranch_scc1 L_sig0
    s_mov_b64 exec, 0xffff
    v_mov_b32 v30, s92
    v_mov_b32 v31, s93
    v_lshlrev_b32 v29, 7, v1
    s_lshl_b32 s36, s60, 3
    s_add_u32 s36, s36, s100
    s_add_u32 s36, s36, 0
    buffer_store_dwordx2 v[30:31], v29, s[96:99], s36 offen sc1
    s_mov_b64 exec, -1
L_sig0:
    v_mfma_f32_16x16x32_bf16 v[100:103], a[56:59], a[4:7], v[100:103]
    v_mfma_f32_16x16x32_bf16 v[92:95], a[64:67], a[8:11], v[92:95]
    v_cvt_pk_bf16_f32 v66, v84, v85
    v_cvt_pk_bf16_f32 v67, v86, v87
    v_mfma_f32_16x16x32_bf16 v[96:99], a[68:71], a[8:11], v[96:99]
    v_mfma_f32_16x16x32_bf16 v[100:103], a[72:75], a[8:11], v[100:103]
    v_mfma_f32_16x16x32_bf16 v[92:95], a[80:83], a[12:15], v[92:95]
    v_mfma_f32_16x16x32_bf16 v[96:99], a[84:87], a[12:15], v[96:99]
    v_mfma_f32_16x16x32_bf16 v[100:103], a[88:91], a[12:15], v[100:103]
    s_waitcnt lgkmcnt(0)
    v_mfma_f32_16x16x32_bf16 v[92:95], a[136:139], a[16:19], v[92:95]
    v_mfma_f32_16x16x32_bf16 v[96:99], a[140:143], a[16:19], v[96:99]
    v_mfma_f32_16x16x32_bf16 v[100:103], a[144:147], a[16:19], v[100:103]
    v_mfma_f32_16x16x32_bf16 v[92:95], a[152:155], a[20:23], v[92:95]
    v_mfma_f32_16x16x32_bf16 v[96:99], a[156:159], a[20:23], v[96:99]
    v_mfma_f32_16x16x32_bf16 v[100:103], a[160:163], a[20:23], v[100:103]
    v_mfma_f32_16x16x32_bf16 v[92:95], a[184:187], a[24:27], v[92:95]
    v_mfma_f32_16x16x32_bf16 v[96:99], a[188:191], a[24:27], v[96:99]
    s_cmp_eq_u32 s60, 8
    s_cselect_b32 s57, s35, 114688
    s_cbranch_scc0 L_keep28
    v_mov_b32 v25, v64
    v_mov_b32 v26, v65
    v_mov_b32 v27, v66
    v_mov_b32 v28, v67
L_keep28:
    buffer_store_dwordx4 v[64:67], v20, s[24:27], s57 offen sc1
    v_cvt_pk_bf16_f32 v104, v88, v89
    v_cvt_pk_bf16_f32 v105, v90, v91
    v_mfma_f32_16x16x32_bf16 v[100:103], a[192:195], a[24:27], v[100:103]
    v_mfma_f32_16x16x32_bf16 v[92:95], a[196:199], a[28:31], v[92:95]
    v_mfma_f32_16x16x32_bf16 v[96:99], a[200:203], a[28:31], v[96:99]
    v_mfma_f32_16x16x32_bf16 v[100:103], a[204:207], a[28:31], v[100:103]
    s_nop 5
    v_cvt_pk_bf16_f32 v68, v92, v93
    v_cvt_pk_bf16_f32 v69, v94, v95
    v_cvt_pk_bf16_f32 v70, v96, v97
    v_cvt_pk_bf16_f32 v71, v98, v99
    s_cmp_eq_u32 s60, 9
    s_cselect_b32 s57, s35, 118784
    s_cbranch_scc0 L_keep29
    v_mov_b32 v25, v68
    v_mov_b32 v26, v69
    v_mov_b32 v27, v70
    v_mov_b32 v28, v71
L_keep29:
    buffer_store_dwordx4 v[68:71], v20, s[24:27], s57 offen sc1
    v_cvt_pk_bf16_f32 v106, v100, v101
    v_cvt_pk_bf16_f32 v107, v102, v103
    s_cmp_eq_u32 s60, 14
    s_cselect_b32 s57, s35, 139264
    s_cbranch_scc0 L_keep34
    v_mov_b32 v25, v104
    v_mov_b32 v26, v105
    v_mov_b32 v27, v106
    v_mov_b32 v28, v107
L_keep34:
    buffer_store_dwordx4 v[104:107], v20, s[24:27], s57 offen sc1
    s_waitcnt vmcnt(0)
    s_barrier
    s_cmp_lg_u32 s28, 0
    s_cbranch_scc1 L_sig1
    s_mov_b64 exec, 0xffff
    v_mov_b32 v30, s92
    v_mov_b32 v31, s93
    v_lshlrev_b32 v29, 7, v1
    s_lshl_b32 s36, s60, 3
    s_add_u32 s36, s36, s100
    s_add_u32 s36, s36, 4096
    buffer_store_dwordx2 v[30:31], v29, s[96:99], s36 offen sc1
    s_mov_b64 exec, -1
L_sig1:
    s_lshl_b32 s38, s60, 2
    s_add_u32 s38, s38, s28
    s_mov_b32 s39, s28
    s_add_u32 s40, s60, 20
    s_lshl_b32 s45, s39, 10
    s_lshl_b32 s46, s40, 12
    s_add_u32 s45, s45, s46
    v_lshlrev_b32 v254, 4, v1
    v_add_u32 v254, s45, v254
    v_and_b32 v244, 15, v1
    v_lshrrev_b32 v245, 4, v1
    v_and_b32 v246, 1, v245
    v_lshrrev_b32 v247, 1, v245
    v_lshlrev_b32 v247, 3, v247
    s_mul_hi_u32 s48, s40, 429496730
    s_mul_i32 s49, s48, 10
    s_sub_u32 s49, s40, s49
    s_sub_u32 s52, s40, 30
    s_lshl_b32 s52, s52, 1
    s_lshl_b32 s53, s48, 5
    s_cmp_lt_u32 s40, 30
    s_cselect_b32 s52, s49, s52
    s_cselect_b32 s53, s53, 96
    s_cselect_b32 s54, 16, 0
    s_cselect_b32 s55, 0, 16
    s_mul_i32 s56, s61, 160
    s_lshl_b32 s52, s52, 4
    s_add_u32 s56, s56, s52
    s_mul_i32 s50, s62, 448
    s_mul_i32 s58, s39, 112
    s_add_u32 s50, s50, s58
    s_add_u32 s50, s50, s53
    v_mad_u32_u24 v255, v246, s55, v244
    v_add_u32 v255, s56, v255
    v_mad_u32_u24 v244, v246, s54, v247
    v_add_u32 v244, s50, v244
    s_mov_b32 s59, 1792
    v_lshlrev_b32 v244, 1, v244
    v_mad_u32_u24 v255, v255, s59, v244
    s_mov_b32 s47, s38
    s_cmp_lg_u32 s28, 0
    s_cbranch_scc1 L_pw0_bar
    s_mov_b32 s42, 20000
L_pw0:
    buffer_load_dwordx2 v[250:251], v248, s[96:99], s41 offen sc1
    s_waitcnt vmcnt(0)
    v_subrev_co_u32 v252, vcc, s78, v250
    s_nop 1
    v_subb_co_u32 v253, vcc, v251, v249, vcc
    v_lshrrev_b32 v252, 24, v252
    v_or_b32 v252, v252, v253
    v_cmp_eq_u32 vcc, 0, v252
    s_nop 4
    s_or_b32 s44, vcc_lo, s43
    s_and_b32 s45, s44, 0xffff
    s_cmp_eq_u32 s45, 0xffff
    s_cbranch_scc1 L_pw0_ok
    s_sub_u32 s42, s42, 1
    s_cmp_eq_u32 s42, 0
    s_cbranch_scc1 L_pw0_ok
    s_sleep 4
    s_branch L_pw0
L_pw0_ok:
    v_mov_b32 v252, s44
    v_mov_b32 v253, 12288
    ds_write_b32 v253, v252
    s_waitcnt lgkmcnt(0)
L_pw0_bar:
    s_barrier
    v_mov_b32 v253, 12288
    ds_read_b32 v252, v253
    s_waitcnt lgkmcnt(0)
    v_readfirstlane_b32 s44, v252
    s_nop 3
    s_lshr_b32 s51, s44, 16
    s_cmp_eq_u32 s51, 0xffff
    s_cselect_b32 s51, 1, 0
    s_add_u32 s46, s60, 1
    s_and_b32 s46, s46, 15
    s_mul_i32 s32, s46, 143360
    buffer_load_dwordx4 v[112:115], v240, s[4:7], s32 offen sc1
    s_add_u32 s46, s60, 2
    s_and_b32 s46, s46, 15
    s_mul_i32 s32, s46, 143360
    buffer_load_dwordx4 v[116:119], v240, s[4:7], s32 offen sc1
    s_add_u32 s46, s60, 3
    s_and_b32 s46, s46, 15
    s_mul_i32 s32, s46, 143360
    buffer_load_dwordx4 v[120:123], v240, s[4:7], s32 offen sc1
    s_add_u32 s46, s60, 4
    s_and_b32 s46, s46, 15
    s_mul_i32 s32, s46, 143360
    buffer_load_dwordx4 v[124:127], v240, s[4:7], s32 offen sc1
    s_add_u32 s46, s60, 5
    s_and_b32 s46, s46, 15
    s_mul_i32 s32, s46, 143360
    buffer_load_dwordx4 v[128:131], v240, s[4:7], s32 offen sc1
    s_add_u32 s46, s60, 6
    s_and_b32 s46, s46, 15
    s_mul_i32 s32, s46, 143360
    buffer_load_dwordx4 v[132:135], v240, s[4:7], s32 offen sc1
    s_add_u32 s46, s60, 7
    s_and_b32 s46, s46, 15
    s_mul_i32 s32, s46, 143360
    buffer_load_dwordx4 v[136:139], v240, s[4:7], s32 offen sc1
    s_add_u32 s46, s60, 8
    s_and_b32 s46, s46, 15
    s_mul_i32 s32, s46, 143360
    buffer_load_dwordx4 v[140:143], v240, s[4:7], s32 offen sc1
    s_add_u32 s46, s60, 9
    s_and_b32 s46, s46, 15
    s_mul_i32 s32, s46, 143360
    buffer_load_dwordx4 v[144:147], v240, s[4:7], s32 offen sc1
    s_add_u32 s46, s60, 10
    s_and_b32 s46, s46, 15
    s_mul_i32 s32, s46, 143360
    buffer_load_dwordx4 v[148:151], v240, s[4:7], s32 offen sc1
    s_add_u32 s46, s60, 11
    s_and_b32 s46, s46, 15
    s_mul_i32 s32, s46, 143360
    buffer_load_dwordx4 v[152:155], v240, s[4:7], s32 offen sc1
    s_add_u32 s46, s60, 12
    s_and_b32 s46, s46, 15
    s_mul_i32 s32, s46, 143360
    buffer_load_dwordx4 v[156:159], v240, s[4:7], s32 offen sc1
    s_add_u32 s46, s60, 13
    s_and_b32 s46, s46, 15
    s_mul_i32 s32, s46, 143360
    buffer_load_dwordx4 v[160:163], v240, s[4:7], s32 offen sc1
    s_add_u32 s46, s60, 14
    s_and_b32 s46, s46, 15
    s_mul_i32 s32, s46, 143360
    buffer_load_dwordx4 v[164:167], v240, s[4:7], s32 offen sc1
    s_add_u32 s46, s60, 15
    s_and_b32 s46, s46, 15
    s_mul_i32 s32, s46, 143360
    buffer_load_dwordx4 v[168:171], v240, s[4:7], s32 offen sc1
    s_cmp_lg_u32 s28, 3
    s_cbranch_scc1 L_x1
    s_mov_b32 s32, 0
    buffer_load_dwordx4 v[176:179], v242, s[4:7], s32 offen sc1
    s_mov_b32 s32, 143360
    buffer_load_dwordx4 v[180:183], v242, s[4:7], s32 offen sc1
    s_mov_b32 s32, 286720
    buffer_load_dwordx4 v[184:187], v242, s[4:7], s32 offen sc1
    s_mov_b32 s32, 430080
    buffer_load_dwordx4 v[188:191], v242, s[4:7], s32 offen sc1
    s_mov_b32 s32, 573440
    buffer_load_dwordx4 v[192:195], v242, s[4:7], s32 offen sc1
    s_mov_b32 s32, 716800
    buffer_load_dwordx4 v[196:199], v242, s[4:7], s32 offen sc1
    s_mov_b32 s32, 860160
    buffer_load_dwordx4 v[200:203], v242, s[4:7], s32 offen sc1
    s_mov_b32 s32, 1003520
    buffer_load_dwordx4 v[204:207], v242, s[4:7], s32 offen sc1
    s_mov_b32 s32, 1146880
    buffer_load_dwordx4 v[208:211], v242, s[4:7], s32 offen sc1
    s_mov_b32 s32, 1290240
    buffer_load_dwordx4 v[212:215], v242, s[4:7], s32 offen sc1
    s_mov_b32 s32, 1433600
    buffer_load_dwordx4 v[216:219], v242, s[4:7], s32 offen sc1
    s_mov_b32 s32, 1576960
    buffer_load_dwordx4 v[220:223], v242, s[4:7], s32 offen sc1
    s_mov_b32 s32, 1720320
    buffer_load_dwordx4 v[224:227], v242, s[4:7], s32 offen sc1
    s_mov_b32 s32, 1863680
    buffer_load_dwordx4 v[228:231], v242, s[4:7], s32 offen sc1
    s_mov_b32 s32, 2007040
    buffer_load_dwordx4 v[232:235], v242, s[4:7], s32 offen sc1
    s_mov_b32 s32, 2150400
    buffer_load_dwordx4 v[236:239], v242, s[4:7], s32 offen sc1
L_x1:
    s_cmp_eq_u32 s51, 1
    s_cbranch_scc1 L_x3
    s_cmp_lg_u32 s28, 0
    s_cbranch_scc1 L_pw1_bar
    s_mov_b32 s42, 20000
L_pw1:
    buffer_load_dwordx2 v[250:251], v248, s[96:99], s41 offen sc1
    s_waitcnt vmcnt(0)
    v_subrev_co_u32 v252, vcc, s78, v250
    s_nop 1
    v_subb_co_u32 v253, vcc, v251, v249, vcc
    v_lshrrev_b32 v252, 24, v252
    v_or_b32 v252, v252, v253
    v_cmp_eq_u32 vcc, 0, v252
    s_nop 4
    s_or_b32 s44, vcc_lo, s43
    s_and_b32 s45, s44, 0xffff0000
    s_cmp_eq_u32 s45, 0xffff0000
    s_cbranch_scc1 L_pw1_ok
    s_sub_u32 s42, s42, 1
    s_cmp_eq_u32 s42, 0
    s_cbranch_scc1 L_pw1_ok
    s_sleep 4
    s_branch L_pw1
L_pw1_ok:
    v_mov_b32 v252, s44
    v_mov_b32 v253, 12292
    ds_write_b32 v253, v252
    s_waitcnt lgkmcnt(0)
L_pw1_bar:
    s_barrier
    v_mov_b32 v253, 12292
    ds_read_b32 v252, v253
    s_waitcnt lgkmcnt(0)
    v_readfirstlane_b32 s44, v252
    s_nop 3
L_x3:
    s_cmp_ge_u32 s47, 60
    s_cbranch_scc1 L_x4
    s_add_u32 s46, s60, 1
    s_and_b32 s46, s46, 15
    s_mul_i32 s32, s46, 143360
    buffer_load_dwordx4 v[32:35], v254, s[4:7], s32 offen sc1
    s_add_u32 s46, s60, 2
    s_and_b32 s46, s46, 15
    s_mul_i32 s32, s46, 143360
    buffer_load_dwordx4 v[36:39], v254, s[4:7], s32 offen sc1
    s_add_u32 s46, s60, 3
    s_and_b32 s46, s46, 15
    s_mul_i32 s32, s46, 143360
    buffer_load_dwordx4 v[40:43], v254, s[4:7], s32 offen sc1
    s_add_u32 s46, s60, 4
    s_and_b32 s46, s46, 15
    s_mul_i32 s32, s46, 143360
    buffer_load_dwordx4 v[44:47], v254, s[4:7], s32 offen sc1
    s_add_u32 s46, s60, 5
    s_and_b32 s46, s46, 15
    s_mul_i32 s32, s46, 143360
    buffer_load_dwordx4 v[48:51], v254, s[4:7], s32 offen sc1
    s_add_u32 s46, s60, 6
    s_and_b32 s46, s46, 15
    s_mul_i32 s32, s46, 143360
    buffer_load_dwordx4 v[52:55], v254, s[4:7], s32 offen sc1
    s_add_u32 s46, s60, 7
    s_and_b32 s46, s46, 15
    s_mul_i32 s32, s46, 143360
    buffer_load_dwordx4 v[56:59], v254, s[4:7], s32 offen sc1
    s_add_u32 s46, s60, 8
    s_and_b32 s46, s46, 15
    s_mul_i32 s32, s46, 143360
    buffer_load_dwordx4 v[60:63], v254, s[4:7], s32 offen sc1
    s_add_u32 s46, s60, 9
    s_and_b32 s46, s46, 15
    s_mul_i32 s32, s46, 143360
    buffer_load_dwordx4 v[88:91], v254, s[4:7], s32 offen sc1
    s_add_u32 s46, s60, 10
    s_and_b32 s46, s46, 15
    s_mul_i32 s32, s46, 143360
    buffer_load_dwordx4 v[92:95], v254, s[4:7], s32 offen sc1
    s_add_u32 s46, s60, 11
    s_and_b32 s46, s46, 15
    s_mul_i32 s32, s46, 143360
    buffer_load_dwordx4 v[96:99], v254, s[4:7], s32 offen sc1
    s_add_u32 s46, s60, 12
    s_and_b32 s46, s46, 15
    s_mul_i32 s32, s46, 143360
    buffer_load_dwordx4 v[100:103], v254, s[4:7], s32 offen sc1
    s_add_u32 s46, s60, 13
    s_and_b32 s46, s46, 15
    s_mul_i32 s32, s46, 143360
    buffer_load_dwordx4 v[104:107], v254, s[4:7], s32 offen sc1
    s_add_u32 s46, s60, 14
    s_and_b32 s46, s46, 15
    s_mul_i32 s32, s46, 143360
    buffer_load_dwordx4 v[108:111], v254, s[4:7], s32 offen sc1
    s_add_u32 s46, s60, 15
    s_and_b32 s46, s46, 15
    s_mul_i32 s32, s46, 143360
    buffer_load_dwordx4 v[172:175], v254, s[4:7], s32 offen sc1
L_x4:
    s_cmp_ge_u32 s47, 60
    s_cbranch_scc1 L_x1d
    s_waitcnt vmcnt(15)
    s_branch L_x1f
L_x1d:
    s_waitcnt vmcnt(0)
L_x1f:
    v_lshlrev_b32 v64, 16, v21
    v_and_b32 v65, 0xffff0000, v21
    v_lshlrev_b32 v66, 16, v22
    v_and_b32 v67, 0xffff0000, v22
    v_lshlrev_b32 v68, 16, v23
    v_and_b32 v69, 0xffff0000, v23
    v_lshlrev_b32 v70, 16, v24
    v_and_b32 v71, 0xffff0000, v24
    v_lshlrev_b32 v72, 16, v112
    v_and_b32 v73, 0xffff0000, v112
    v_add_f32 v64, v64, v72
    v_add_f32 v65, v65, v73
    v_lshlrev_b32 v74, 16, v113
    v_and_b32 v75, 0xffff0000, v113
    v_add_f32 v66, v66, v74
    v_add_f32 v67, v67, v75
    v_lshlrev_b32 v72, 16, v114
    v_and_b32 v73, 0xffff0000, v114
    v_add_f32 v68, v68, v72
    v_add_f32 v69, v69, v73
    v_lshlrev_b32 v74, 16, v115
    v_and_b32 v75, 0xffff0000, v115
    v_add_f32 v70, v70, v74
    v_add_f32 v71, v71, v75
    v_lshlrev_b32 v72, 16, v116
    v_and_b32 v73, 0xffff0000, v116
    v_add_f32 v64, v64, v72
    v_add_f32 v65, v65, v73
    v_lshlrev_b32 v74, 16, v117
    v_and_b32 v75, 0xffff0000, v117
    v_add_f32 v66, v66, v74
    v_add_f32 v67, v67, v75
    v_lshlrev_b32 v72, 16, v118
    v_and_b32 v73, 0xffff0000, v118
    v_add_f32 v68, v68, v72
    v_add_f32 v69, v69, v73
    v_lshlrev_b32 v74, 16, v119
    v_and_b32 v75, 0xffff0000, v119
    v_add_f32 v70, v70, v74
    v_add_f32 v71, v71, v75
    v_lshlrev_b32 v72, 16, v120
    v_and_b32 v73, 0xffff0000, v120
    v_add_f32 v64, v64, v72
    v_add_f32 v65, v65, v73
    v_lshlrev_b32 v74, 16, v121
    v_and_b32 v75, 0xffff0000, v121
    v_add_f32 v66, v66, v74
    v_add_f32 v67, v67, v75
    v_lshlrev_b32 v72, 16, v122
    v_and_b32 v73, 0xffff0000, v122
    v_add_f32 v68, v68, v72
    v_add_f32 v69, v69, v73
    v_lshlrev_b32 v74, 16, v123
    v_and_b32 v75, 0xffff0000, v123
    v_add_f32 v70, v70, v74
    v_add_f32 v71, v71, v75
    v_lshlrev_b32 v72, 16, v124
    v_and_b32 v73, 0xffff0000, v124
    v_add_f32 v64, v64, v72
    v_add_f32 v65, v65, v73
    v_lshlrev_b32 v74, 16, v125
    v_and_b32 v75, 0xffff0000, v125
    v_add_f32 v66, v66, v74
    v_add_f32 v67, v67, v75
    v_lshlrev_b32 v72, 16, v126
    v_and_b32 v73, 0xffff0000, v126
    v_add_f32 v68, v68, v72
    v_add_f32 v69, v69, v73
    v_lshlrev_b32 v74, 16, v127
    v_and_b32 v75, 0xffff0000, v127
    v_add_f32 v70, v70, v74
    v_add_f32 v71, v71, v75
    v_lshlrev_b32 v72, 16, v128
    v_and_b32 v73, 0xffff0000, v128
    v_add_f32 v64, v64, v72
    v_add_f32 v65, v65, v73
    v_lshlrev_b32 v74, 16, v129
    v_and_b32 v75, 0xffff0000, v129
    v_add_f32 v66, v66, v74
    v_add_f32 v67, v67, v75
    v_lshlrev_b32 v72, 16, v130
    v_and_b32 v73, 0xffff0000, v130
    v_add_f32 v68, v68, v72
    v_add_f32 v69, v69, v73
    v_lshlrev_b32 v74, 16, v131
    v_and_b32 v75, 0xffff0000, v131
    v_add_f32 v70, v70, v74
    v_add_f32 v71, v71, v75
    v_lshlrev_b32 v72, 16, v132
    v_and_b32 v73, 0xffff0000, v132
    v_add_f32 v64, v64, v72
    v_add_f32 v65, v65, v73
    v_lshlrev_b32 v74, 16, v133
    v_and_b32 v75, 0xffff0000, v133
    v_add_f32 v66, v66, v74
    v_add_f32 v67, v67, v75
    v_lshlrev_b32 v72, 16, v134
    v_and_b32 v73, 0xffff0000, v134
    v_add_f32 v68, v68, v72
    v_add_f32 v69, v69, v73
    v_lshlrev_b32 v74, 16, v135
    v_and_b32 v75, 0xffff0000, v135
    v_add_f32 v70, v70, v74
    v_add_f32 v71, v71, v75
    v_lshlrev_b32 v72, 16, v136
    v_and_b32 v73, 0xffff0000, v136
    v_add_f32 v64, v64, v72
    v_add_f32 v65, v65, v73
    v_lshlrev_b32 v74, 16, v137
    v_and_b32 v75, 0xffff0000, v137
    v_add_f32 v66, v66, v74
    v_add_f32 v67, v67, v75
    v_lshlrev_b32 v72, 16, v138
    v_and_b32 v73, 0xffff0000, v138
    v_add_f32 v68, v68, v72
    v_add_f32 v69, v69, v73
    v_lshlrev_b32 v74, 16, v139
    v_and_b32 v75, 0xffff0000, v139
    v_add_f32 v70, v70, v74
    v_add_f32 v71, v71, v75
    v_lshlrev_b32 v72, 16, v140
    v_and_b32 v73, 0xffff0000, v140
    v_add_f32 v64, v64, v72
    v_add_f32 v65, v65, v73
    v_lshlrev_b32 v74, 16, v141
    v_and_b32 v75, 0xffff0000, v141
    v_add_f32 v66, v66, v74
    v_add_f32 v67, v67, v75
    v_lshlrev_b32 v72, 16, v142
    v_and_b32 v73, 0xffff0000, v142
    v_add_f32 v68, v68, v72
    v_add_f32 v69, v69, v73
    v_lshlrev_b32 v74, 16, v143
    v_and_b32 v75, 0xffff0000, v143
    v_add_f32 v70, v70, v74
    v_add_f32 v71, v71, v75
    v_lshlrev_b32 v72, 16, v144
    v_and_b32 v73, 0xffff0000, v144
    v_add_f32 v64, v64, v72
    v_add_f32 v65, v65, v73
    v_lshlrev_b32 v74, 16, v145
    v_and_b32 v75, 0xffff0000, v145
    v_add_f32 v66, v66, v74
    v_add_f32 v67, v67, v75
    v_lshlrev_b32 v72, 16, v146
    v_and_b32 v73, 0xffff0000, v146
    v_add_f32 v68, v68, v72
    v_add_f32 v69, v69, v73
    v_lshlrev_b32 v74, 16, v147
    v_and_b32 v75, 0xffff0000, v147
    v_add_f32 v70, v70, v74
    v_add_f32 v71, v71, v75
    v_lshlrev_b32 v72, 16, v148
    v_and_b32 v73, 0xffff0000, v148
    v_add_f32 v64, v64, v72
    v_add_f32 v65, v65, v73
    v_lshlrev_b32 v74, 16, v149
    v_and_b32 v75, 0xffff0000, v149
    v_add_f32 v66, v66, v74
    v_add_f32 v67, v67, v75
    v_lshlrev_b32 v72, 16, v150
    v_and_b32 v73, 0xffff0000, v150
    v_add_f32 v68, v68, v72
    v_add_f32 v69, v69, v73
    v_lshlrev_b32 v74, 16, v151
    v_and_b32 v75, 0xffff0000, v151
    v_add_f32 v70, v70, v74
    v_add_f32 v71, v71, v75
    v_lshlrev_b32 v72, 16, v152
    v_and_b32 v73, 0xffff0000, v152
    v_add_f32 v64, v64, v72
    v_add_f32 v65, v65, v73
    v_lshlrev_b32 v74, 16, v153
    v_and_b32 v75, 0xffff0000, v153
    v_add_f32 v66, v66, v74
    v_add_f32 v67, v67, v75
    v_lshlrev_b32 v72, 16, v154
    v_and_b32 v73, 0xffff0000, v154
    v_add_f32 v68, v68, v72
    v_add_f32 v69, v69, v73
    v_lshlrev_b32 v74, 16, v155
    v_and_b32 v75, 0xffff0000, v155
    v_add_f32 v70, v70, v74
    v_add_f32 v71, v71, v75
    v_lshlrev_b32 v72, 16, v156
    v_and_b32 v73, 0xffff0000, v156
    v_add_f32 v64, v64, v72
    v_add_f32 v65, v65, v73
    v_lshlrev_b32 v74, 16, v157
    v_and_b32 v75, 0xffff0000, v157
    v_add_f32 v66, v66, v74
    v_add_f32 v67, v67, v75
    v_lshlrev_b32 v72, 16, v158
    v_and_b32 v73, 0xffff0000, v158
    v_add_f32 v68, v68, v72
    v_add_f32 v69, v69, v73
    v_lshlrev_b32 v74, 16, v159
    v_and_b32 v75, 0xffff0000, v159
    v_add_f32 v70, v70, v74
    v_add_f32 v71, v71, v75
    v_lshlrev_b32 v72, 16, v160
    v_and_b32 v73, 0xffff0000, v160
    v_add_f32 v64, v64, v72
    v_add_f32 v65, v65, v73
    v_lshlrev_b32 v74, 16, v161
    v_and_b32 v75, 0xffff0000, v161
    v_add_f32 v66, v66, v74
    v_add_f32 v67, v67, v75
    v_lshlrev_b32 v72, 16, v162
    v_and_b32 v73, 0xffff0000, v162
    v_add_f32 v68, v68, v72
    v_add_f32 v69, v69, v73
    v_lshlrev_b32 v74, 16, v163
    v_and_b32 v75, 0xffff0000, v163
    v_add_f32 v70, v70, v74
    v_add_f32 v71, v71, v75
    v_lshlrev_b32 v72, 16, v164
    v_and_b32 v73, 0xffff0000, v164
    v_add_f32 v64, v64, v72
    v_add_f32 v65, v65, v73
    v_lshlrev_b32 v74, 16, v165
    v_and_b32 v75, 0xffff0000, v165
    v_add_f32 v66, v66, v74
    v_add_f32 v67, v67, v75
    v_lshlrev_b32 v72, 16, v166
    v_and_b32 v73, 0xffff0000, v166
    v_add_f32 v68, v68, v72
    v_add_f32 v69, v69, v73
    v_lshlrev_b32 v74, 16, v167
    v_and_b32 v75, 0xffff0000, v167
    v_add_f32 v70, v70, v74
    v_add_f32 v71, v71, v75
    v_lshlrev_b32 v72, 16, v168
    v_and_b32 v73, 0xffff0000, v168
    v_add_f32 v64, v64, v72
    v_add_f32 v65, v65, v73
    v_lshlrev_b32 v74, 16, v169
    v_and_b32 v75, 0xffff0000, v169
    v_add_f32 v66, v66, v74
    v_add_f32 v67, v67, v75
    v_lshlrev_b32 v72, 16, v170
    v_and_b32 v73, 0xffff0000, v170
    v_add_f32 v68, v68, v72
    v_add_f32 v69, v69, v73
    v_lshlrev_b32 v74, 16, v171
    v_and_b32 v75, 0xffff0000, v171
    v_add_f32 v70, v70, v74
    v_add_f32 v71, v71, v75
    v_cvt_pk_bf16_f32 v76, v64, v65
    v_cvt_pk_bf16_f32 v77, v66, v67
    v_cvt_pk_bf16_f32 v78, v68, v69
    v_cvt_pk_bf16_f32 v79, v70, v71
    s_nop 0
    v_permlane16_swap_b32 v76, v78
    v_permlane16_swap_b32 v77, v79
    buffer_store_dwordx4 v[76:79], v241, s[8:11], 0 offen
    s_cmp_lg_u32 s28, 3
    s_cbranch_scc1 L_x2
    v_lshlrev_b32 v64, 16, v176
    v_and_b32 v65, 0xffff0000, v176
    v_lshlrev_b32 v66, 16, v177
    v_and_b32 v67, 0xffff0000, v177
    v_lshlrev_b32 v68, 16, v178
    v_and_b32 v69, 0xffff0000, v178
    v_lshlrev_b32 v70, 16, v179
    v_and_b32 v71, 0xffff0000, v179
    v_lshlrev_b32 v72, 16, v180
    v_and_b32 v73, 0xffff0000, v180
    v_add_f32 v64, v64, v72
    v_add_f32 v65, v65, v73
    v_lshlrev_b32 v74, 16, v181
    v_and_b32 v75, 0xffff0000, v181
    v_add_f32 v66, v66, v74
    v_add_f32 v67, v67, v75
    v_lshlrev_b32 v72, 16, v182
    v_and_b32 v73, 0xffff0000, v182
    v_add_f32 v68, v68, v72
    v_add_f32 v69, v69, v73
    v_lshlrev_b32 v74, 16, v183
    v_and_b32 v75, 0xffff0000, v183
    v_add_f32 v70, v70, v74
    v_add_f32 v71, v71, v75
    v_lshlrev_b32 v72, 16, v184
    v_and_b32 v73, 0xffff0000, v184
    v_add_f32 v64, v64, v72
    v_add_f32 v65, v65, v73
    v_lshlrev_b32 v74, 16, v185
    v_and_b32 v75, 0xffff0000, v185
    v_add_f32 v66, v66, v74
    v_add_f32 v67, v67, v75
    v_lshlrev_b32 v72, 16, v186
    v_and_b32 v73, 0xffff0000, v186
    v_add_f32 v68, v68, v72
    v_add_f32 v69, v69, v73
    v_lshlrev_b32 v74, 16, v187
    v_and_b32 v75, 0xffff0000, v187
    v_add_f32 v70, v70, v74
    v_add_f32 v71, v71, v75
    v_lshlrev_b32 v72, 16, v188
    v_and_b32 v73, 0xffff0000, v188
    v_add_f32 v64, v64, v72
    v_add_f32 v65, v65, v73
    v_lshlrev_b32 v74, 16, v189
    v_and_b32 v75, 0xffff0000, v189
    v_add_f32 v66, v66, v74
    v_add_f32 v67, v67, v75
    v_lshlrev_b32 v72, 16, v190
    v_and_b32 v73, 0xffff0000, v190
    v_add_f32 v68, v68, v72
    v_add_f32 v69, v69, v73
    v_lshlrev_b32 v74, 16, v191
    v_and_b32 v75, 0xffff0000, v191
    v_add_f32 v70, v70, v74
    v_add_f32 v71, v71, v75
    v_lshlrev_b32 v72, 16, v192
    v_and_b32 v73, 0xffff0000, v192
    v_add_f32 v64, v64, v72
    v_add_f32 v65, v65, v73
    v_lshlrev_b32 v74, 16, v193
    v_and_b32 v75, 0xffff0000, v193
    v_add_f32 v66, v66, v74
    v_add_f32 v67, v67, v75
    v_lshlrev_b32 v72, 16, v194
    v_and_b32 v73, 0xffff0000, v194
    v_add_f32 v68, v68, v72
    v_add_f32 v69, v69, v73
    v_lshlrev_b32 v74, 16, v195
    v_and_b32 v75, 0xffff0000, v195
    v_add_f32 v70, v70, v74
    v_add_f32 v71, v71, v75
    v_lshlrev_b32 v72, 16, v196
    v_and_b32 v73, 0xffff0000, v196
    v_add_f32 v64, v64, v72
    v_add_f32 v65, v65, v73
    v_lshlrev_b32 v74, 16, v197
    v_and_b32 v75, 0xffff0000, v197
    v_add_f32 v66, v66, v74
    v_add_f32 v67, v67, v75
    v_lshlrev_b32 v72, 16, v198
    v_and_b32 v73, 0xffff0000, v198
    v_add_f32 v68, v68, v72
    v_add_f32 v69, v69, v73
    v_lshlrev_b32 v74, 16, v199
    v_and_b32 v75, 0xffff0000, v199
    v_add_f32 v70, v70, v74
    v_add_f32 v71, v71, v75
    v_lshlrev_b32 v72, 16, v200
    v_and_b32 v73, 0xffff0000, v200
    v_add_f32 v64, v64, v72
    v_add_f32 v65, v65, v73
    v_lshlrev_b32 v74, 16, v201
    v_and_b32 v75, 0xffff0000, v201
    v_add_f32 v66, v66, v74
    v_add_f32 v67, v67, v75
    v_lshlrev_b32 v72, 16, v202
    v_and_b32 v73, 0xffff0000, v202
    v_add_f32 v68, v68, v72
    v_add_f32 v69, v69, v73
    v_lshlrev_b32 v74, 16, v203
    v_and_b32 v75, 0xffff0000, v203
    v_add_f32 v70, v70, v74
    v_add_f32 v71, v71, v75
    v_lshlrev_b32 v72, 16, v204
    v_and_b32 v73, 0xffff0000, v204
    v_add_f32 v64, v64, v72
    v_add_f32 v65, v65, v73
    v_lshlrev_b32 v74, 16, v205
    v_and_b32 v75, 0xffff0000, v205
    v_add_f32 v66, v66, v74
    v_add_f32 v67, v67, v75
    v_lshlrev_b32 v72, 16, v206
    v_and_b32 v73, 0xffff0000, v206
    v_add_f32 v68, v68, v72
    v_add_f32 v69, v69, v73
    v_lshlrev_b32 v74, 16, v207
    v_and_b32 v75, 0xffff0000, v207
    v_add_f32 v70, v70, v74
    v_add_f32 v71, v71, v75
    v_lshlrev_b32 v72, 16, v208
    v_and_b32 v73, 0xffff0000, v208
    v_add_f32 v64, v64, v72
    v_add_f32 v65, v65, v73
    v_lshlrev_b32 v74, 16, v209
    v_and_b32 v75, 0xffff0000, v209
    v_add_f32 v66, v66, v74
    v_add_f32 v67, v67, v75
    v_lshlrev_b32 v72, 16, v210
    v_and_b32 v73, 0xffff0000, v210
    v_add_f32 v68, v68, v72
    v_add_f32 v69, v69, v73
    v_lshlrev_b32 v74, 16, v211
    v_and_b32 v75, 0xffff0000, v211
    v_add_f32 v70, v70, v74
    v_add_f32 v71, v71, v75
    v_lshlrev_b32 v72, 16, v212
    v_and_b32 v73, 0xffff0000, v212
    v_add_f32 v64, v64, v72
    v_add_f32 v65, v65, v73
    v_lshlrev_b32 v74, 16, v213
    v_and_b32 v75, 0xffff0000, v213
    v_add_f32 v66, v66, v74
    v_add_f32 v67, v67, v75
    v_lshlrev_b32 v72, 16, v214
    v_and_b32 v73, 0xffff0000, v214
    v_add_f32 v68, v68, v72
    v_add_f32 v69, v69, v73
    v_lshlrev_b32 v74, 16, v215
    v_and_b32 v75, 0xffff0000, v215
    v_add_f32 v70, v70, v74
    v_add_f32 v71, v71, v75
    v_lshlrev_b32 v72, 16, v216
    v_and_b32 v73, 0xffff0000, v216
    v_add_f32 v64, v64, v72
    v_add_f32 v65, v65, v73
    v_lshlrev_b32 v74, 16, v217
    v_and_b32 v75, 0xffff0000, v217
    v_add_f32 v66, v66, v74
    v_add_f32 v67, v67, v75
    v_lshlrev_b32 v72, 16, v218
    v_and_b32 v73, 0xffff0000, v218
    v_add_f32 v68, v68, v72
    v_add_f32 v69, v69, v73
    v_lshlrev_b32 v74, 16, v219
    v_and_b32 v75, 0xffff0000, v219
    v_add_f32 v70, v70, v74
    v_add_f32 v71, v71, v75
    v_lshlrev_b32 v72, 16, v220
    v_and_b32 v73, 0xffff0000, v220
    v_add_f32 v64, v64, v72
    v_add_f32 v65, v65, v73
    v_lshlrev_b32 v74, 16, v221
    v_and_b32 v75, 0xffff0000, v221
    v_add_f32 v66, v66, v74
    v_add_f32 v67, v67, v75
    v_lshlrev_b32 v72, 16, v222
    v_and_b32 v73, 0xffff0000, v222
    v_add_f32 v68, v68, v72
    v_add_f32 v69, v69, v73
    v_lshlrev_b32 v74, 16, v223
    v_and_b32 v75, 0xffff0000, v223
    v_add_f32 v70, v70, v74
    v_add_f32 v71, v71, v75
    v_lshlrev_b32 v72, 16, v224
    v_and_b32 v73, 0xffff0000, v224
    v_add_f32 v64, v64, v72
    v_add_f32 v65, v65, v73
    v_lshlrev_b32 v74, 16, v225
    v_and_b32 v75, 0xffff0000, v225
    v_add_f32 v66, v66, v74
    v_add_f32 v67, v67, v75
    v_lshlrev_b32 v72, 16, v226
    v_and_b32 v73, 0xffff0000, v226
    v_add_f32 v68, v68, v72
    v_add_f32 v69, v69, v73
    v_lshlrev_b32 v74, 16, v227
    v_and_b32 v75, 0xffff0000, v227
    v_add_f32 v70, v70, v74
    v_add_f32 v71, v71, v75
    v_lshlrev_b32 v72, 16, v228
    v_and_b32 v73, 0xffff0000, v228
    v_add_f32 v64, v64, v72
    v_add_f32 v65, v65, v73
    v_lshlrev_b32 v74, 16, v229
    v_and_b32 v75, 0xffff0000, v229
    v_add_f32 v66, v66, v74
    v_add_f32 v67, v67, v75
    v_lshlrev_b32 v72, 16, v230
    v_and_b32 v73, 0xffff0000, v230
    v_add_f32 v68, v68, v72
    v_add_f32 v69, v69, v73
    v_lshlrev_b32 v74, 16, v231
    v_and_b32 v75, 0xffff0000, v231
    v_add_f32 v70, v70, v74
    v_add_f32 v71, v71, v75
    v_lshlrev_b32 v72, 16, v232
    v_and_b32 v73, 0xffff0000, v232
    v_add_f32 v64, v64, v72
    v_add_f32 v65, v65, v73
    v_lshlrev_b32 v74, 16, v233
    v_and_b32 v75, 0xffff0000, v233
    v_add_f32 v66, v66, v74
    v_add_f32 v67, v67, v75
    v_lshlrev_b32 v72, 16, v234
    v_and_b32 v73, 0xffff0000, v234
    v_add_f32 v68, v68, v72
    v_add_f32 v69, v69, v73
    v_lshlrev_b32 v74, 16, v235
    v_and_b32 v75, 0xffff0000, v235
    v_add_f32 v70, v70, v74
    v_add_f32 v71, v71, v75
    v_lshlrev_b32 v72, 16, v236
    v_and_b32 v73, 0xffff0000, v236
    v_add_f32 v64, v64, v72
    v_add_f32 v65, v65, v73
    v_lshlrev_b32 v74, 16, v237
    v_and_b32 v75, 0xffff0000, v237
    v_add_f32 v66, v66, v74
    v_add_f32 v67, v67, v75
    v_lshlrev_b32 v72, 16, v238
    v_and_b32 v73, 0xffff0000, v238
    v_add_f32 v68, v68, v72
    v_add_f32 v69, v69, v73
    v_lshlrev_b32 v74, 16, v239
    v_and_b32 v75, 0xffff0000, v239
    v_add_f32 v70, v70, v74
    v_add_f32 v71, v71, v75
    v_cvt_pk_bf16_f32 v80, v64, v65
    v_cvt_pk_bf16_f32 v81, v66, v67
    v_cvt_pk_bf16_f32 v82, v68, v69
    v_cvt_pk_bf16_f32 v83, v70, v71
    s_nop 0
    v_permlane16_swap_b32 v80, v82
    v_permlane16_swap_b32 v81, v83
    buffer_store_dwordx4 v[80:83], v243, s[8:11], 0 offen
L_x2:
    s_cmp_ge_u32 s47, 60
    s_cbranch_scc1 L_x5
    v_lshlrev_b32 v64, 16, v25
    v_and_b32 v65, 0xffff0000, v25
    v_lshlrev_b32 v66, 16, v26
    v_and_b32 v67, 0xffff0000, v26
    v_lshlrev_b32 v68, 16, v27
    v_and_b32 v69, 0xffff0000, v27
    v_lshlrev_b32 v70, 16, v28
    v_and_b32 v71, 0xffff0000, v28
    s_waitcnt vmcnt(13)
    v_lshlrev_b32 v72, 16, v32
    v_and_b32 v73, 0xffff0000, v32
    v_add_f32 v64, v64, v72
    v_add_f32 v65, v65, v73
    v_lshlrev_b32 v74, 16, v33
    v_and_b32 v75, 0xffff0000, v33
    v_add_f32 v66, v66, v74
    v_add_f32 v67, v67, v75
    v_lshlrev_b32 v72, 16, v34
    v_and_b32 v73, 0xffff0000, v34
    v_add_f32 v68, v68, v72
    v_add_f32 v69, v69, v73
    v_lshlrev_b32 v74, 16, v35
    v_and_b32 v75, 0xffff0000, v35
    v_add_f32 v70, v70, v74
    v_add_f32 v71, v71, v75
    v_lshlrev_b32 v72, 16, v36
    v_and_b32 v73, 0xffff0000, v36
    v_add_f32 v64, v64, v72
    v_add_f32 v65, v65, v73
    v_lshlrev_b32 v74, 16, v37
    v_and_b32 v75, 0xffff0000, v37
    v_add_f32 v66, v66, v74
    v_add_f32 v67, v67, v75
    v_lshlrev_b32 v72, 16, v38
    v_and_b32 v73, 0xffff0000, v38
    v_add_f32 v68, v68, v72
    v_add_f32 v69, v69, v73
    v_lshlrev_b32 v74, 16, v39
    v_and_b32 v75, 0xffff0000, v39
    v_add_f32 v70, v70, v74
    v_add_f32 v71, v71, v75
    s_waitcnt vmcnt(11)
    v_lshlrev_b32 v72, 16, v40
    v_and_b32 v73, 0xffff0000, v40
    v_add_f32 v64, v64, v72
    v_add_f32 v65, v65, v73
    v_lshlrev_b32 v74, 16, v41
    v_and_b32 v75, 0xffff0000, v41
    v_add_f32 v66, v66, v74
    v_add_f32 v67, v67, v75
    v_lshlrev_b32 v72, 16, v42
    v_and_b32 v73, 0xffff0000, v42
    v_add_f32 v68, v68, v72
    v_add_f32 v69, v69, v73
    v_lshlrev_b32 v74, 16, v43
    v_and_b32 v75, 0xffff0000, v43
    v_add_f32 v70, v70, v74
    v_add_f32 v71, v71, v75
    v_lshlrev_b32 v72, 16, v44
    v_and_b32 v73, 0xffff0000, v44
    v_add_f32 v64, v64, v72
    v_add_f32 v65, v65, v73
    v_lshlrev_b32 v74, 16, v45
    v_and_b32 v75, 0xffff0000, v45
    v_add_f32 v66, v66, v74
    v_add_f32 v67, v67, v75
    v_lshlrev_b32 v72, 16, v46
    v_and_b32 v73, 0xffff0000, v46
    v_add_f32 v68, v68, v72
    v_add_f32 v69, v69, v73
    v_lshlrev_b32 v74, 16, v47
    v_and_b32 v75, 0xffff0000, v47
    v_add_f32 v70, v70, v74
    v_add_f32 v71, v71, v75
    s_waitcnt vmcnt(9)
    v_lshlrev_b32 v72, 16, v48
    v_and_b32 v73, 0xffff0000, v48
    v_add_f32 v64, v64, v72
    v_add_f32 v65, v65, v73
    v_lshlrev_b32 v74, 16, v49
    v_and_b32 v75, 0xffff0000, v49
    v_add_f32 v66, v66, v74
    v_add_f32 v67, v67, v75
    v_lshlrev_b32 v72, 16, v50
    v_and_b32 v73, 0xffff0000, v50
    v_add_f32 v68, v68, v72
    v_add_f32 v69, v69, v73
    v_lshlrev_b32 v74, 16, v51
    v_and_b32 v75, 0xffff0000, v51
    v_add_f32 v70, v70, v74
    v_add_f32 v71, v71, v75
    v_lshlrev_b32 v72, 16, v52
    v_and_b32 v73, 0xffff0000, v52
    v_add_f32 v64, v64, v72
    v_add_f32 v65, v65, v73
    v_lshlrev_b32 v74, 16, v53
    v_and_b32 v75, 0xffff0000, v53
    v_add_f32 v66, v66, v74
    v_add_f32 v67, v67, v75
    v_lshlrev_b32 v72, 16, v54
    v_and_b32 v73, 0xffff0000, v54
    v_add_f32 v68, v68, v72
    v_add_f32 v69, v69, v73
    v_lshlrev_b32 v74, 16, v55
    v_and_b32 v75, 0xffff0000, v55
    v_add_f32 v70, v70, v74
    v_add_f32 v71, v71, v75
    s_waitcnt vmcnt(7)
    v_lshlrev_b32 v72, 16, v56
    v_and_b32 v73, 0xffff0000, v56
    v_add_f32 v64, v64, v72
    v_add_f32 v65, v65, v73
    v_lshlrev_b32 v74, 16, v57
    v_and_b32 v75, 0xffff0000, v57
    v_add_f32 v66, v66, v74
    v_add_f32 v67, v67, v75
    v_lshlrev_b32 v72, 16, v58
    v_and_b32 v73, 0xffff0000, v58
    v_add_f32 v68, v68, v72
    v_add_f32 v69, v69, v73
    v_lshlrev_b32 v74, 16, v59
    v_and_b32 v75, 0xffff0000, v59
    v_add_f32 v70, v70, v74
    v_add_f32 v71, v71, v75
    v_lshlrev_b32 v72, 16, v60
    v_and_b32 v73, 0xffff0000, v60
    v_add_f32 v64, v64, v72
    v_add_f32 v65, v65, v73
    v_lshlrev_b32 v74, 16, v61
    v_and_b32 v75, 0xffff0000, v61
    v_add_f32 v66, v66, v74
    v_add_f32 v67, v67, v75
    v_lshlrev_b32 v72, 16, v62
    v_and_b32 v73, 0xffff0000, v62
    v_add_f32 v68, v68, v72
    v_add_f32 v69, v69, v73
    v_lshlrev_b32 v74, 16, v63
    v_and_b32 v75, 0xffff0000, v63
    v_add_f32 v70, v70, v74
    v_add_f32 v71, v71, v75
    s_waitcnt vmcnt(5)
    v_lshlrev_b32 v72, 16, v88
    v_and_b32 v73, 0xffff0000, v88
    v_add_f32 v64, v64, v72
    v_add_f32 v65, v65, v73
    v_lshlrev_b32 v74, 16, v89
    v_and_b32 v75, 0xffff0000, v89
    v_add_f32 v66, v66, v74
    v_add_f32 v67, v67, v75
    v_lshlrev_b32 v72, 16, v90
    v_and_b32 v73, 0xffff0000, v90
    v_add_f32 v68, v68, v72
    v_add_f32 v69, v69, v73
    v_lshlrev_b32 v74, 16, v91
    v_and_b32 v75, 0xffff0000, v91
    v_add_f32 v70, v70, v74
    v_add_f32 v71, v71, v75
    v_lshlrev_b32 v72, 16, v92
    v_and_b32 v73, 0xffff0000, v92
    v_add_f32 v64, v64, v72
    v_add_f32 v65, v65, v73
    v_lshlrev_b32 v74, 16, v93
    v_and_b32 v75, 0xffff0000, v93
    v_add_f32 v66, v66, v74
    v_add_f32 v67, v67, v75
    v_lshlrev_b32 v72, 16, v94
    v_and_b32 v73, 0xffff0000, v94
    v_add_f32 v68, v68, v72
    v_add_f32 v69, v69, v73
    v_lshlrev_b32 v74, 16, v95
    v_and_b32 v75, 0xffff0000, v95
    v_add_f32 v70, v70, v74
    v_add_f32 v71, v71, v75
    s_waitcnt vmcnt(3)
    v_lshlrev_b32 v72, 16, v96
    v_and_b32 v73, 0xffff0000, v96
    v_add_f32 v64, v64, v72
    v_add_f32 v65, v65, v73
    v_lshlrev_b32 v74, 16, v97
    v_and_b32 v75, 0xffff0000, v97
    v_add_f32 v66, v66, v74
    v_add_f32 v67, v67, v75
    v_lshlrev_b32 v72, 16, v98
    v_and_b32 v73, 0xffff0000, v98
    v_add_f32 v68, v68, v72
    v_add_f32 v69, v69, v73
    v_lshlrev_b32 v74, 16, v99
    v_and_b32 v75, 0xffff0000, v99
    v_add_f32 v70, v70, v74
    v_add_f32 v71, v71, v75
    v_lshlrev_b32 v72, 16, v100
    v_and_b32 v73, 0xffff0000, v100
    v_add_f32 v64, v64, v72
    v_add_f32 v65, v65, v73
    v_lshlrev_b32 v74, 16, v101
    v_and_b32 v75, 0xffff0000, v101
    v_add_f32 v66, v66, v74
    v_add_f32 v67, v67, v75
    v_lshlrev_b32 v72, 16, v102
    v_and_b32 v73, 0xffff0000, v102
    v_add_f32 v68, v68, v72
    v_add_f32 v69, v69, v73
    v_lshlrev_b32 v74, 16, v103
    v_and_b32 v75, 0xffff0000, v103
    v_add_f32 v70, v70, v74
    v_add_f32 v71, v71, v75
    s_waitcnt vmcnt(1)
    v_lshlrev_b32 v72, 16, v104
    v_and_b32 v73, 0xffff0000, v104
    v_add_f32 v64, v64, v72
    v_add_f32 v65, v65, v73
    v_lshlrev_b32 v74, 16, v105
    v_and_b32 v75, 0xffff0000, v105
    v_add_f32 v66, v66, v74
    v_add_f32 v67, v67, v75
    v_lshlrev_b32 v72, 16, v106
    v_and_b32 v73, 0xffff0000, v106
    v_add_f32 v68, v68, v72
    v_add_f32 v69, v69, v73
    v_lshlrev_b32 v74, 16, v107
    v_and_b32 v75, 0xffff0000, v107
    v_add_f32 v70, v70, v74
    v_add_f32 v71, v71, v75
    v_lshlrev_b32 v72, 16, v108
    v_and_b32 v73, 0xffff0000, v108
    v_add_f32 v64, v64, v72
    v_add_f32 v65, v65, v73
    v_lshlrev_b32 v74, 16, v109
    v_and_b32 v75, 0xffff0000, v109
    v_add_f32 v66, v66, v74
    v_add_f32 v67, v67, v75
    v_lshlrev_b32 v72, 16, v110
    v_and_b32 v73, 0xffff0000, v110
    v_add_f32 v68, v68, v72
    v_add_f32 v69, v69, v73
    v_lshlrev_b32 v74, 16, v111
    v_and_b32 v75, 0xffff0000, v111
    v_add_f32 v70, v70, v74
    v_add_f32 v71, v71, v75
    s_waitcnt vmcnt(0)
    v_lshlrev_b32 v72, 16, v172
    v_and_b32 v73, 0xffff0000, v172
    v_add_f32 v64, v64, v72
    v_add_f32 v65, v65, v73
    v_lshlrev_b32 v74, 16, v173
    v_and_b32 v75, 0xffff0000, v173
    v_add_f32 v66, v66, v74
    v_add_f32 v67, v67, v75
    v_lshlrev_b32 v72, 16, v174
    v_and_b32 v73, 0xffff0000, v174
    v_add_f32 v68, v68, v72
    v_add_f32 v69, v69, v73
    v_lshlrev_b32 v74, 16, v175
    v_and_b32 v75, 0xffff0000, v175
    v_add_f32 v70, v70, v74
    v_add_f32 v71, v71, v75
    v_cvt_pk_bf16_f32 v84, v64, v65
    v_cvt_pk_bf16_f32 v85, v66, v67
    v_cvt_pk_bf16_f32 v86, v68, v69
    v_cvt_pk_bf16_f32 v87, v70, v71
    s_nop 0
    v_permlane16_swap_b32 v84, v86
    v_permlane16_swap_b32 v85, v87
    buffer_store_dwordx4 v[84:87], v255, s[8:11], 0 offen
L_x5:
    s_endpgm
L_fallback:
    s_waitcnt vmcnt(0) lgkmcnt(0)
    s_barrier
    s_mov_b32 s35, 1
    s_branch L_restart
L_k1_end:
    s_endpgm
.section .rodata,"a"
.p2align 6
.amdhsa_kernel concat_heads__mha_block_cached__mha_block_cached__near_ridge_kernel
  .amdhsa_next_free_vgpr 512
  .amdhsa_next_free_sgpr 102
  .amdhsa_accum_offset 256
  .amdhsa_group_segment_fixed_size 0
  .amdhsa_kernarg_size 104
  .amdhsa_user_sgpr_count 2
  .amdhsa_user_sgpr_kernarg_segment_ptr 1
  .amdhsa_system_sgpr_workgroup_id_x 1
.end_amdhsa_kernel
```
